```python
import torch

def _softmax(x, axis=-1):
    return torch.softmax(x, dim=axis)
def _gelu(x):
    return torch.nn.functional.gelu(x, approximate="tanh")
def _silu(x):
    return torch.nn.functional.silu(x)
def _sigmoid(x):
    return torch.sigmoid(x)
def _layernorm(x, axis=-1, eps=1e-5):
    m = x.mean(dim=axis, keepdim=True)
    v = x.var(dim=axis, keepdim=True, unbiased=False)
    return (x - m) / torch.sqrt(v + eps)
def _scatter_add(tgt, idx, src, axis=0):
    return tgt.clone().index_add_(axis, idx, src)
def _segment_sum(src, seg, n):
    out = torch.zeros((n,) + src.shape[1:], dtype=src.dtype)
    return out.index_add_(0, seg, src)
def _pad(x, pw):
    flat = tuple(v for pair in reversed(pw) for v in pair)
    return torch.nn.functional.pad(x, flat)

kernel_name = 'interleave_layers__gqa_block_cached__mixer_token_mlp__decode'

def setup_inputs():

    _w = (lambda a: (lambda t: t.to(torch.bfloat16) if t.is_floating_point() else t)(torch.as_tensor(a)))
    def _A_setup():
        B, Sq, D = 2, 1, 576
        Hq, Hkv, Sk, Dh = 32, 16, 16384, 128
        assert Hq % Hkv == 0, (Hq, Hkv)
        return {
            "x": _w((lambda *s: torch.randn(*s, dtype=torch.bfloat16) * 0.1)(B, Sq, D)),
            "k_cache": _w((lambda *s: torch.randn(*s, dtype=torch.bfloat16) * 0.8)(B, Hkv, Sk, Dh)),
            "v_cache": _w((lambda *s: torch.randn(*s, dtype=torch.bfloat16) * 3.2)(B, Hkv, Sk, Dh)),
            "wq": _w((lambda *s: torch.randn(*s, dtype=torch.bfloat16) * 0.8)(D, Hq * Dh) * (D ** -0.5)),
            "wo": _w((lambda *s: torch.randn(*s, dtype=torch.bfloat16) * 3.2)(Hq * Dh, D) * ((Hq * Dh) ** -0.5)),
        }
    _A_in = _A_setup()

    def _B_setup():
        B, S, D, F = 2, 1, 576, 4608
        return {
            "x": _w((lambda *s: torch.randn(*s, dtype=torch.bfloat16) * 0.1)(B, S, D)),
            "w1": _w((lambda *s: torch.randn(*s, dtype=torch.bfloat16) * 0.8)(S, F) * (S ** -0.5)),
            "b1": _w((lambda *s: torch.randn(*s, dtype=torch.bfloat16) * 0.8)(F) * 0.02),
            "w2": _w((lambda *s: torch.randn(*s, dtype=torch.bfloat16) * 0.4)(F, S) * (F ** -0.5)),
            "b2": _w((lambda *s: torch.randn(*s, dtype=torch.bfloat16) * 0.4)(S) * 0.02),
        }
    _B_in = _B_setup()

    return {
        "A_x": _A_in["x"],
        "A_k_cache": _A_in["k_cache"],
        "A_v_cache": _A_in["v_cache"],
        "A_wq": _A_in["wq"],
        "A_wo": _A_in["wo"],
        "B_x": _B_in["x"],
        "B_w1": _B_in["w1"],
        "B_b1": _B_in["b1"],
        "B_w2": _B_in["w2"],
        "B_b2": _B_in["b2"],
    }

def reference(A_x, A_k_cache, A_v_cache, A_wq, A_wo, B_x, B_w1, B_b1, B_w2, B_b2):
    def _A_ref(x, k_cache, v_cache, wq, wo):
        B, Sq, D = x.shape
        Hq, Dh = 32, 128
        Hkv = k_cache.shape[1]
        rep = Hq // Hkv
        q = (lambda x, *d: x.permute(*d))((x @ wq).reshape(B, Sq, Hq, Dh), 0, 2, 1, 3)
        k = (lambda x, n, axis: torch.repeat_interleave(x, n, dim=axis))(k_cache, rep, axis=1)
        v = (lambda x, n, axis: torch.repeat_interleave(x, n, dim=axis))(v_cache, rep, axis=1)
        scores = torch.einsum("bhqd,bhkd->bhqk", q, k) * (Dh ** -0.5)
        p = _softmax(scores, axis=-1)
        o = torch.einsum("bhqk,bhkd->bhqd", p, v)
        return (lambda x, *d: x.permute(*d))(o, 0, 2, 1, 3).reshape(B, Sq, Hq * Dh) @ wo

    def _B_ref(x, w1, b1, w2, b2):
        B, S, D = x.shape
        h = _layernorm(x, axis=-1)
        u = torch.einsum("bsd,sf->bdf", h, w1) + b1
        u = _gelu(u)
        y = torch.einsum("bdf,fs->bds", u, w2) + b2
        return (lambda x, *d: x.permute(*d))(y, 0, 2, 1)

    x = A_x
    x = x + _A_ref(_layernorm(x, axis=-1), A_k_cache, A_v_cache, A_wq, A_wo)
    x = x + _B_ref(_layernorm(x, axis=-1), B_w1, B_b1, B_w2, B_b2)
    x = x + _A_ref(_layernorm(x, axis=-1), A_k_cache, A_v_cache, A_wq, A_wo)
    x = x + _B_ref(_layernorm(x, axis=-1), B_w1, B_b1, B_w2, B_b2)
    return x
```

```asm
; @launch grid=(256,1,1) block=(256,1,1) lds=163840
.amdgcn_target "amdgcn-amd-amdhsa--gfx950"
.text
.globl interleave_layers__gqa_block_cached__mixer_token_mlp__decode_kernel
.p2align 8
.type interleave_layers__gqa_block_cached__mixer_token_mlp__decode_kernel,@function
interleave_layers__gqa_block_cached__mixer_token_mlp__decode_kernel:
    s_cmp_ge_u32 s2, 256
    s_cbranch_scc1 L_end
    s_load_dwordx16 s[32:47], s[0:1], 0
    s_load_dwordx8 s[48:55], s[0:1], 64
    s_load_dwordx2 s[56:57], s[0:1], 96
    v_lshrrev_b32 v12, 6, v0
    v_and_b32 v0, 63, v0
    s_and_b32 s25, s2, 15
    v_readfirstlane_b32 s24, v12
    s_lshr_b32 s26, s2, 4
    v_lshrrev_b32 v13, 4, v0
    v_and_b32 v14, 15, v0
    v_lshlrev_b32 v3, 2, v0
    v_lshlrev_b32 v8, 4, v0
    v_lshrrev_b32 v1, 1, v14
    v_lshlrev_b32 v1, 8, v1
    v_and_b32 v15, 1, v0
    v_lshl_add_u32 v1, v15, 6, v1
    v_lshl_add_u32 v1, v13, 4, v1
    v_lshlrev_b32 v2, 9, v13
    v_lshl_add_u32 v2, v14, 4, v2
    s_lshl_b32 s58, s25, 22
    s_lshl_b32 s29, s26, 18
    s_add_u32 s58, s58, s29
    s_lshl_b32 s29, s24, 12
    s_add_u32 s58, s58, s29
    s_lshl_b32 s72, s25, 12
    s_lshl_b32 s29, s26, 8
    s_add_u32 s72, s72, s29
    s_lshl_b32 s29, s24, 6
    s_add_u32 s72, s72, s29
    s_mul_i32 s71, s24, 36864
    s_add_u32 s71, s71, 16384
    s_waitcnt lgkmcnt(0)
    s_mov_b32 s16, s38
    s_and_b32 s17, s39, 0xffff
    s_mov_b32 s18, 0x480000
    s_mov_b32 s19, 0x00020000
    s_mov_b32 s4, s34
    s_and_b32 s5, s35, 0xffff
    s_mov_b32 s6, 0x8000000
    s_mov_b32 s7, 0x00020000
    s_mov_b32 s8, s36
    s_and_b32 s9, s37, 0xffff
    s_mov_b32 s10, 0x8000000
    s_mov_b32 s11, 0x00020000
    s_add_u32 s29, s58, 0x0
    buffer_load_dwordx4 v[208:211], v1, s[4:7], s29 offen offset:0 nt
    buffer_load_dwordx4 v[212:215], v1, s[4:7], s29 offen offset:128 nt
    buffer_load_dwordx4 v[216:219], v1, s[4:7], s29 offen offset:2048 nt
    buffer_load_dwordx4 v[220:223], v1, s[4:7], s29 offen offset:2176 nt
    buffer_load_dwordx4 v[224:227], v2, s[8:11], s29 offen offset:0 nt
    buffer_load_dwordx4 v[228:231], v2, s[8:11], s29 offen offset:256 nt
    buffer_load_dwordx4 v[232:235], v2, s[8:11], s29 offen offset:2048 nt
    buffer_load_dwordx4 v[236:239], v2, s[8:11], s29 offen offset:2304 nt
    s_add_u32 s29, s58, 0x4000
    buffer_load_dwordx4 a[0:3], v1, s[4:7], s29 offen offset:0 nt
    buffer_load_dwordx4 a[4:7], v1, s[4:7], s29 offen offset:128 nt
    buffer_load_dwordx4 a[8:11], v1, s[4:7], s29 offen offset:2048 nt
    buffer_load_dwordx4 a[12:15], v1, s[4:7], s29 offen offset:2176 nt
    buffer_load_dwordx4 a[16:19], v2, s[8:11], s29 offen offset:0 nt
    buffer_load_dwordx4 a[20:23], v2, s[8:11], s29 offen offset:256 nt
    buffer_load_dwordx4 a[24:27], v2, s[8:11], s29 offen offset:2048 nt
    buffer_load_dwordx4 a[28:31], v2, s[8:11], s29 offen offset:2304 nt
    s_load_dword s68, s[50:51], 0
    s_getpc_b64 s[98:99]
L_pc:
    s_sub_u32 s98, s98, L_pc-interleave_layers__gqa_block_cached__mixer_token_mlp__decode_kernel
    s_subb_u32 s99, s99, 0
    s_lshr_b32 s29, s2, 3
    s_lshl_b32 s29, s29, 2
    s_add_u32 s29, s29, s24
    s_and_b32 s29, s29, 63
    s_lshl_b32 s29, s29, 10
    v_add_u32 v240, s29, v8
    v_min_u32 v240, L_codeend-interleave_layers__gqa_block_cached__mixer_token_mlp__decode_kernel-16, v240
    global_load_dwordx4 v[240:243], v240, s[98:99]
    v_lshlrev_b32 v134, 3, v0
    v_lshlrev_b32 v135, 1, v0
    global_load_dwordx2 v[128:129], v134, s[32:33] offset:0
    global_load_dwordx2 v[130:131], v134, s[32:33] offset:512
    global_load_ushort v132, v135, s[32:33] offset:1024
    v_lshlrev_b32 v142, 3, v0
    v_lshlrev_b32 v143, 1, v0
    global_load_dwordx2 v[136:137], v142, s[32:33] offset:1152
    global_load_dwordx2 v[138:139], v142, s[32:33] offset:1664
    global_load_ushort v140, v143, s[32:33] offset:2176
    v_lshrrev_b32 v12, 3, v0
    v_lshlrev_b32 v12, 13, v12
    v_and_b32 v15, 7, v0
    v_lshl_add_u32 v12, v15, 4, v12
    s_lshr_b32 s29, s26, 2
    s_lshl_b32 s29, s29, 2
    s_add_u32 s29, s29, s24
    s_mul_i32 s29, s29, 393216
    s_lshl_b32 s59, s25, 9
    s_add_u32 s29, s29, s59
    s_and_b32 s59, s26, 3
    s_lshl_b32 s59, s59, 7
    s_add_u32 s29, s29, s59
    s_mul_i32 s59, s24, 6144
    s_add_u32 m0, s59, 16384
    s_nop 0
    buffer_load_dwordx4 v12, s[16:19], s29 offen nt lds
    s_add_u32 s29, s29, 65536
    s_add_u32 m0, s59, 17408
    s_nop 0
    buffer_load_dwordx4 v12, s[16:19], s29 offen nt lds
    s_add_u32 s29, s29, 65536
    s_add_u32 m0, s59, 18432
    s_nop 0
    buffer_load_dwordx4 v12, s[16:19], s29 offen nt lds
    s_add_u32 s29, s29, 65536
    s_add_u32 m0, s59, 19456
    s_nop 0
    buffer_load_dwordx4 v12, s[16:19], s29 offen nt lds
    s_add_u32 s29, s29, 65536
    s_add_u32 m0, s59, 20480
    s_nop 0
    buffer_load_dwordx4 v12, s[16:19], s29 offen nt lds
    s_add_u32 s29, s29, 65536
    s_add_u32 m0, s59, 21504
    s_nop 0
    buffer_load_dwordx4 v12, s[16:19], s29 offen nt lds
    s_mov_b32 s12, s56
    s_and_b32 s13, s57, 0xffff
    s_mov_b32 s14, 0x288000
    s_mov_b32 s15, 0x00020000
    s_mov_b32 s20, s40
    s_and_b32 s21, s41, 0xffff
    s_mov_b32 s22, 0x480000
    s_mov_b32 s23, 0x00020000
    s_mov_b32 s27, 0x3e0293ee
    s_mov_b32 s28, 0x20000
    s_mov_b32 s86, 0
    s_mov_b32 s89, 0
    s_mov_b32 s90, 0x3727c5ac
    s_mov_b32 s60, s26
    s_min_u32 s61, s2, 191
    s_cmp_lt_u32 s2, 192
    s_cselect_b32 s62, 1, 0
    s_mov_b32 s96, 0x11111111
    s_mov_b32 s97, 0x11111111
    s_mov_b32 s74, 0x00ff00ff
    s_mov_b32 s75, 0xff00ff00
    s_mov_b32 s66, 0xbdd2d3e8
    s_mov_b32 s67, 0xbdd2d3e8
    s_lshr_b32 s100, s26, 2
    s_mul_i32 s100, s100, 384
    s_lshl_b32 s78, s25, 14
    s_lshl_b32 s29, s24, 8
    s_add_u32 s78, s78, s29
    s_add_u32 s78, s78, 0x80000
    s_lshl_b32 s79, s25, 8
    s_lshr_b32 s29, s24, 1
    s_lshl_b32 s29, s29, 7
    s_add_u32 s79, s79, s29
    s_add_u32 s79, s79, 0x40000
    s_lshl_b32 s80, s25, 8
    s_lshl_b32 s29, s24, 6
    s_add_u32 s80, s80, s29
    s_mul_i32 s80, s80, 1152
    s_lshl_b32 s29, s60, 7
    s_add_u32 s80, s80, s29
    s_cmp_ge_u32 s60, 9
    s_cselect_b32 s80, 0x40000000, s80
    v_lshrrev_b32 v13, 4, v0
    v_bfe_u32 v9, v0, 3, 1
    v_lshlrev_b32 v9, 8, v9
    v_lshl_add_u32 v9, v13, 4, v9
    v_add_u32 v10, s71, v8
    v_and_b32 v14, 1, v0
    v_lshl_add_u32 v9, v14, 6, v9
    v_lshlrev_b32 v14, 4, v14
    v_mov_b32 v15, 0xffff
    v_lshlrev_b32 v15, v14, v15
    v_bfe_u32 v14, v0, 1, 2
    v_cmp_eq_u32 vcc, 0, v14
    s_nop 1
    v_cndmask_b32 v4, 0, v15, vcc
    v_cmp_eq_u32 vcc, 1, v14
    s_nop 1
    v_cndmask_b32 v5, 0, v15, vcc
    v_cmp_eq_u32 vcc, 2, v14
    s_nop 1
    v_cndmask_b32 v6, 0, v15, vcc
    v_cmp_eq_u32 vcc, 3, v14
    s_nop 1
    v_cndmask_b32 v7, 0, v15, vcc
    v_mov_b32 v244, -1
    v_mov_b32 v245, -1
    v_mov_b32 v246, -1
    v_mov_b32 v247, -1
    s_mul_i32 s29, s2, 768
    s_lshl_b32 s59, s24, 8
    s_add_u32 s29, s29, s59
    s_add_u32 s29, s29, 0x40000
    s_cmp_eq_u32 s24, 3
    s_cselect_b32 s29, 0x7fff0000, s29
    s_lshl_b32 s59, s26, 10
    s_add_u32 s59, s59, s78
    v_bfe_u32 v248, v0, 2, 1
    v_lshlrev_b32 v248, 16, v248
    v_and_b32 v249, 48, v8
    v_add_u32 v248, v248, v249
    s_add_u32 s73, s72, 0x20000
    s_mov_b64 exec, 0xffff
    buffer_store_dwordx4 v[244:247], v8, s[12:15], s29 offen sc1
    buffer_store_dwordx4 v[244:247], v8, s[12:15], s59 offen sc1
    s_mov_b64 exec, -1
    s_mov_b64 exec, 0xff
    buffer_store_dwordx4 v[244:247], v248, s[12:15], s73 offen sc1
    s_mov_b64 exec, -1
    s_cmp_lt_u32 s2, 192
    s_cbranch_scc1 SF_1
    s_nop 1
    v_mov_b32 v244, -1
    v_mov_b32 v245, -1
    v_mov_b32 v246, -1
    v_mov_b32 v247, -1
    v_lshrrev_b32 v248, 4, v0
    v_lshlrev_b32 v248, 18, v248
    v_and_b32 v249, 0xf0, v8
    v_add_u32 v248, v248, v249
    s_lshl_b32 s59, s26, 10
    s_add_u32 s59, s59, s78
    s_add_u32 s59, s59, 0x40000
    s_mov_b32 exec_hi, 0xffff
    s_cmp_eq_u32 s89, 0
    s_cbranch_scc1 FS_2
    buffer_store_dwordx4 v[244:247], v248, s[12:15], s59 offen
FS_3:
    s_mov_b64 exec, -1
SF_1:
    s_add_u32 s29, s58, 0x8000
    buffer_load_dwordx4 a[32:35], v1, s[4:7], s29 offen offset:0 nt
    buffer_load_dwordx4 a[36:39], v1, s[4:7], s29 offen offset:128 nt
    buffer_load_dwordx4 a[40:43], v1, s[4:7], s29 offen offset:2048 nt
    buffer_load_dwordx4 a[44:47], v1, s[4:7], s29 offen offset:2176 nt
    buffer_load_dwordx4 a[48:51], v2, s[8:11], s29 offen offset:0 nt
    buffer_load_dwordx4 a[52:55], v2, s[8:11], s29 offen offset:256 nt
    buffer_load_dwordx4 a[56:59], v2, s[8:11], s29 offen offset:2048 nt
    buffer_load_dwordx4 a[60:63], v2, s[8:11], s29 offen offset:2304 nt
    s_waitcnt vmcnt(11)
    s_barrier
    v_bfe_u32 v12, v0, 2, 2
    v_lshrrev_b32 v13, 4, v0
    v_lshl_add_u32 v14, v13, 2, v12
    v_lshl_add_u32 v12, v13, 3, v12
    v_and_b32 v13, 3, v0
    s_lshl_b32 s29, s24, 5
    v_lshl_add_u32 v13, v13, 3, s29
    v_lshl_add_u32 v12, v12, 7, v13
    v_lshl_add_u32 v14, v14, 7, v13
    ds_read_b64_tr_b16 v[60:61], v12 offset:16384
    ds_read_b64_tr_b16 v[62:63], v12 offset:16896
    ds_read_b64_tr_b16 v[64:65], v12 offset:20480
    ds_read_b64_tr_b16 v[66:67], v12 offset:20992
    ds_read_b64_tr_b16 v[68:69], v12 offset:24576
    ds_read_b64_tr_b16 v[70:71], v12 offset:25088
    ds_read_b64_tr_b16 v[72:73], v12 offset:28672
    ds_read_b64_tr_b16 v[74:75], v12 offset:29184
    ds_read_b64_tr_b16 v[76:77], v12 offset:32768
    ds_read_b64_tr_b16 v[78:79], v12 offset:33280
    ds_read_b64_tr_b16 v[40:41], v12 offset:36864
    ds_read_b64_tr_b16 v[42:43], v12 offset:37376
    s_mov_b32 s28, 0
    v_lshlrev_b32 v80, 16, v128
    v_and_b32 v81, 0xffff0000, v128
    v_lshlrev_b32 v82, 16, v129
    v_and_b32 v83, 0xffff0000, v129
    v_lshlrev_b32 v84, 16, v130
    v_and_b32 v85, 0xffff0000, v130
    v_lshlrev_b32 v86, 16, v131
    v_and_b32 v87, 0xffff0000, v131
    v_lshlrev_b32 v88, 16, v132
    s_mov_b32 s83, 9216
    s_mov_b32 s84, 0x0
    s_mov_b32 s85, 14848
    v_add_u32 v12, s83, v8
    v_add_u32 v13, s83, v3
    ds_write_b128 v12, v[80:83]
    ds_write_b128 v12, v[84:87] offset:1024
    ds_write_b32 v13, v88 offset:2048
    s_call_b64 s[30:31], F_qstage
    s_add_u32 s29, s58, 0xc000
    buffer_load_dwordx4 a[64:67], v1, s[4:7], s29 offen offset:0 nt
    buffer_load_dwordx4 a[68:71], v1, s[4:7], s29 offen offset:128 nt
    buffer_load_dwordx4 a[72:75], v1, s[4:7], s29 offen offset:2048 nt
    buffer_load_dwordx4 a[76:79], v1, s[4:7], s29 offen offset:2176 nt
    buffer_load_dwordx4 a[80:83], v2, s[8:11], s29 offen offset:0 nt
    buffer_load_dwordx4 a[84:87], v2, s[8:11], s29 offen offset:256 nt
    buffer_load_dwordx4 a[88:91], v2, s[8:11], s29 offen offset:2048 nt
    buffer_load_dwordx4 a[92:95], v2, s[8:11], s29 offen offset:2304 nt
    v_lshlrev_b32 v80, 16, v136
    v_and_b32 v81, 0xffff0000, v136
    v_lshlrev_b32 v82, 16, v137
    v_and_b32 v83, 0xffff0000, v137
    v_lshlrev_b32 v84, 16, v138
    v_and_b32 v85, 0xffff0000, v138
    v_lshlrev_b32 v86, 16, v139
    v_and_b32 v87, 0xffff0000, v139
    v_lshlrev_b32 v88, 16, v140
    s_mov_b32 s83, 11520
    s_mov_b32 s84, 0x10000
    s_mov_b32 s85, 40960
    v_add_u32 v12, s83, v8
    v_add_u32 v13, s83, v3
    ds_write_b128 v12, v[80:83]
    ds_write_b128 v12, v[84:87] offset:1024
    ds_write_b32 v13, v88 offset:2048
    s_call_b64 s[30:31], F_qstage
    s_add_u32 s29, s58, 0x10000
    buffer_load_dwordx4 a[96:99], v1, s[4:7], s29 offen offset:0 nt
    buffer_load_dwordx4 a[100:103], v1, s[4:7], s29 offen offset:128 nt
    buffer_load_dwordx4 a[104:107], v1, s[4:7], s29 offen offset:2048 nt
    buffer_load_dwordx4 a[108:111], v1, s[4:7], s29 offen offset:2176 nt
    buffer_load_dwordx4 a[112:115], v2, s[8:11], s29 offen offset:0 nt
    buffer_load_dwordx4 a[116:119], v2, s[8:11], s29 offen offset:256 nt
    buffer_load_dwordx4 a[120:123], v2, s[8:11], s29 offen offset:2048 nt
    buffer_load_dwordx4 a[124:127], v2, s[8:11], s29 offen offset:2304 nt
    s_lshl_b32 s68, s68, 16
    s_mov_b32 s28, 0x20000
    s_waitcnt vmcnt(8)
    s_barrier
    s_cmp_lg_u32 s24, 0
    s_cbranch_scc1 SG_9
    s_getreg_b32 s29, hwreg(HW_REG_XCC_ID)
    s_and_b32 s29, s29, 7
    s_lshl_b32 s29, s29, 3
    s_lshl_b64 s[98:99], 1, s29
    s_lshl_b32 s29, s25, 3
    v_mov_b32 v14, s29
    v_mov_b32 v12, s98
    v_mov_b32 v13, s99
    s_mov_b64 exec, 1
    global_atomic_add_x2 v14, v[12:13], s[54:55]
    s_mov_b64 exec, -1
SG_9:
    s_add_u32 s29, s58, 0x14000
    buffer_load_dwordx4 a[128:131], v1, s[4:7], s29 offen offset:0 nt
    buffer_load_dwordx4 a[132:135], v1, s[4:7], s29 offen offset:128 nt
    buffer_load_dwordx4 a[136:139], v1, s[4:7], s29 offen offset:2048 nt
    buffer_load_dwordx4 a[140:143], v1, s[4:7], s29 offen offset:2176 nt
    buffer_load_dwordx4 a[144:147], v2, s[8:11], s29 offen offset:0 nt
    buffer_load_dwordx4 a[148:151], v2, s[8:11], s29 offen offset:256 nt
    buffer_load_dwordx4 a[152:155], v2, s[8:11], s29 offen offset:2048 nt
    buffer_load_dwordx4 a[156:159], v2, s[8:11], s29 offen offset:2304 nt
    s_add_u32 s29, s58, 0x18000
    buffer_load_dwordx4 a[160:163], v1, s[4:7], s29 offen offset:0 nt
    buffer_load_dwordx4 a[164:167], v1, s[4:7], s29 offen offset:128 nt
    buffer_load_dwordx4 a[168:171], v1, s[4:7], s29 offen offset:2048 nt
    buffer_load_dwordx4 a[172:175], v1, s[4:7], s29 offen offset:2176 nt
    buffer_load_dwordx4 a[176:179], v2, s[8:11], s29 offen offset:0 nt
    buffer_load_dwordx4 a[180:183], v2, s[8:11], s29 offen offset:256 nt
    buffer_load_dwordx4 a[184:187], v2, s[8:11], s29 offen offset:2048 nt
    buffer_load_dwordx4 a[188:191], v2, s[8:11], s29 offen offset:2304 nt
    s_add_u32 s29, s58, 0x1c000
    s_add_u32 m0, s71, 0
    s_nop 0
    buffer_load_dwordx4 v1, s[4:7], s29 offen offset:0 nt lds
    s_add_u32 m0, s71, 896
    s_nop 0
    buffer_load_dwordx4 v1, s[4:7], s29 offen offset:128 nt lds
    s_add_u32 m0, s71, 0
    s_nop 0
    buffer_load_dwordx4 v1, s[4:7], s29 offen offset:2048 nt lds
    s_add_u32 m0, s71, 896
    s_nop 0
    buffer_load_dwordx4 v1, s[4:7], s29 offen offset:2176 nt lds
    s_add_u32 m0, s71, 4096
    s_nop 0
    buffer_load_dwordx4 v2, s[8:11], s29 offen offset:0 nt lds
    s_add_u32 m0, s71, 4864
    s_nop 0
    buffer_load_dwordx4 v2, s[8:11], s29 offen offset:256 nt lds
    s_add_u32 m0, s71, 4096
    s_nop 0
    buffer_load_dwordx4 v2, s[8:11], s29 offen offset:2048 nt lds
    s_add_u32 m0, s71, 4864
    s_nop 0
    buffer_load_dwordx4 v2, s[8:11], s29 offen offset:2304 nt lds
    s_add_u32 s29, s58, 0x20000
    s_add_u32 m0, s71, 8192
    s_nop 0
    buffer_load_dwordx4 v1, s[4:7], s29 offen offset:0 nt lds
    s_add_u32 m0, s71, 9088
    s_nop 0
    buffer_load_dwordx4 v1, s[4:7], s29 offen offset:128 nt lds
    s_add_u32 m0, s71, 8192
    s_nop 0
    buffer_load_dwordx4 v1, s[4:7], s29 offen offset:2048 nt lds
    s_add_u32 m0, s71, 9088
    s_nop 0
    buffer_load_dwordx4 v1, s[4:7], s29 offen offset:2176 nt lds
    s_add_u32 m0, s71, 12288
    s_nop 0
    buffer_load_dwordx4 v2, s[8:11], s29 offen offset:0 nt lds
    s_add_u32 m0, s71, 13056
    s_nop 0
    buffer_load_dwordx4 v2, s[8:11], s29 offen offset:256 nt lds
    s_add_u32 m0, s71, 12288
    s_nop 0
    buffer_load_dwordx4 v2, s[8:11], s29 offen offset:2048 nt lds
    s_add_u32 m0, s71, 13056
    s_nop 0
    buffer_load_dwordx4 v2, s[8:11], s29 offen offset:2304 nt lds
    s_lshl_b32 s29, s25, 3
    v_mov_b32 v50, s29
    global_load_dwordx2 v[48:49], v50, s[54:55] sc1
    s_add_u32 s29, s58, 0x24000
    s_add_u32 m0, s71, 16384
    s_nop 0
    buffer_load_dwordx4 v1, s[4:7], s29 offen offset:0 nt lds
    s_add_u32 m0, s71, 17280
    s_nop 0
    buffer_load_dwordx4 v1, s[4:7], s29 offen offset:128 nt lds
    s_add_u32 m0, s71, 16384
    s_nop 0
    buffer_load_dwordx4 v1, s[4:7], s29 offen offset:2048 nt lds
    s_add_u32 m0, s71, 17280
    s_nop 0
    buffer_load_dwordx4 v1, s[4:7], s29 offen offset:2176 nt lds
    s_add_u32 m0, s71, 20480
    s_nop 0
    buffer_load_dwordx4 v2, s[8:11], s29 offen offset:0 nt lds
    s_add_u32 m0, s71, 21248
    s_nop 0
    buffer_load_dwordx4 v2, s[8:11], s29 offen offset:256 nt lds
    s_add_u32 m0, s71, 20480
    s_nop 0
    buffer_load_dwordx4 v2, s[8:11], s29 offen offset:2048 nt lds
    s_add_u32 m0, s71, 21248
    s_nop 0
    buffer_load_dwordx4 v2, s[8:11], s29 offen offset:2304 nt lds
    s_waitcnt vmcnt(8)
CK_10:
    v_sad_u8 v51, v48, 0, 0
    v_sad_u8 v51, v49, 0, v51
    v_cmp_gt_u32 vcc, 16, v51
    s_cbranch_vccnz RT_11
CT_12:
    v_or_b32 v48, v48, v49
    v_and_b32 v48, 0x10101010, v48
    v_cmp_eq_u32 vcc, 16, v51
    s_nop 1
    v_cndmask_b32 v48, 0, v48, vcc
    s_nop 0
    v_readfirstlane_b32 s89, v48
    s_mov_b32 s84, 0x0
    s_call_b64 s[30:31], F_qgi
    s_add_u32 s70, s69, 65536
    buffer_load_dwordx4 v[80:83], v8, s[12:15], s70 offen offset:0 sc1
    buffer_load_dwordx4 v[84:87], v8, s[12:15], s70 offen offset:1024 sc1
    buffer_load_dwordx4 v[88:91], v8, s[12:15], s70 offen offset:2048 sc1
    s_add_u32 s29, s58, 0x28000
    s_add_u32 m0, s71, 24576
    s_nop 0
    buffer_load_dwordx4 v1, s[4:7], s29 offen offset:0 nt lds
    s_add_u32 m0, s71, 25472
    s_nop 0
    buffer_load_dwordx4 v1, s[4:7], s29 offen offset:128 nt lds
    s_add_u32 m0, s71, 24576
    s_nop 0
    buffer_load_dwordx4 v1, s[4:7], s29 offen offset:2048 nt lds
    s_add_u32 m0, s71, 25472
    s_nop 0
    buffer_load_dwordx4 v1, s[4:7], s29 offen offset:2176 nt lds
    s_add_u32 m0, s71, 28672
    s_nop 0
    buffer_load_dwordx4 v2, s[8:11], s29 offen offset:0 nt lds
    s_add_u32 m0, s71, 29440
    s_nop 0
    buffer_load_dwordx4 v2, s[8:11], s29 offen offset:256 nt lds
    s_add_u32 m0, s71, 28672
    s_nop 0
    buffer_load_dwordx4 v2, s[8:11], s29 offen offset:2048 nt lds
    s_add_u32 m0, s71, 29440
    s_nop 0
    buffer_load_dwordx4 v2, s[8:11], s29 offen offset:2304 nt lds
    s_waitcnt vmcnt(8)
    s_mov_b32 s101, 14336
    v_lshl_add_u32 v14, v0, 3, s101
    v_pk_add_f32 v[80:81], v[80:81], v[84:85]
    v_pk_add_f32 v[82:83], v[82:83], v[86:87]
    v_pk_add_f32 v[80:81], v[80:81], v[88:89]
    v_pk_add_f32 v[82:83], v[82:83], v[90:91]
    v_cvt_pk_bf16_f32 v12, v80, v81
    v_cvt_pk_bf16_f32 v13, v82, v83
    ds_write_b64 v14, v[12:13]
    s_mov_b32 s101, 13824
    s_call_b64 s[30:31], F_qgf
    v_and_b32 v98, 15, v0
    v_lshlrev_b32 v98, 3, v98
    global_load_dwordx2 v[96:97], v98, s[54:55] sc1
    s_add_u32 s29, s58, 0x2c000
    s_add_u32 m0, s71, 32768
    s_nop 0
    buffer_load_dwordx4 v1, s[4:7], s29 offen offset:0 nt lds
    s_add_u32 m0, s71, 33664
    s_nop 0
    buffer_load_dwordx4 v1, s[4:7], s29 offen offset:128 nt lds
    s_add_u32 m0, s71, 32768
    s_nop 0
    buffer_load_dwordx4 v1, s[4:7], s29 offen offset:2048 nt lds
    s_add_u32 m0, s71, 33664
    s_nop 0
    buffer_load_dwordx4 v1, s[4:7], s29 offen offset:2176 nt lds
    buffer_load_dwordx4 v[240:243], v2, s[8:11], s29 offen offset:0 nt
    buffer_load_dwordx4 v[244:247], v2, s[8:11], s29 offen offset:256 nt
    buffer_load_dwordx4 v[248:251], v2, s[8:11], s29 offen offset:2048 nt
    buffer_load_dwordx4 v[252:255], v2, s[8:11], s29 offen offset:2304 nt
    s_call_b64 s[30:31], U_v208_v224
    s_call_b64 s[30:31], U_a0_a16
    s_call_b64 s[30:31], U_a32_a48
    s_call_b64 s[30:31], U_a64_a80
    s_add_u32 s29, s58, 0x30000
    buffer_load_dwordx4 v[176:179], v1, s[4:7], s29 offen offset:0 nt
    buffer_load_dwordx4 v[180:183], v1, s[4:7], s29 offen offset:128 nt
    buffer_load_dwordx4 v[184:187], v1, s[4:7], s29 offen offset:2048 nt
    buffer_load_dwordx4 v[188:191], v1, s[4:7], s29 offen offset:2176 nt
    buffer_load_dwordx4 v[192:195], v2, s[8:11], s29 offen offset:0 nt
    buffer_load_dwordx4 v[196:199], v2, s[8:11], s29 offen offset:256 nt
    buffer_load_dwordx4 v[200:203], v2, s[8:11], s29 offen offset:2048 nt
    buffer_load_dwordx4 v[204:207], v2, s[8:11], s29 offen offset:2304 nt
    s_call_b64 s[30:31], U_a96_a112
    s_call_b64 s[30:31], U_a128_a144
    s_call_b64 s[30:31], U_a160_a176
    ds_read_b128 a[192:195], v10 offset:0
    ds_read_b128 a[196:199], v10 offset:1024
    ds_read_b128 a[200:203], v10 offset:2048
    ds_read_b128 a[204:207], v10 offset:3072
    ds_read_b128 a[208:211], v10 offset:4096
    ds_read_b128 a[212:215], v10 offset:5120
    ds_read_b128 a[216:219], v10 offset:6144
    ds_read_b128 a[220:223], v10 offset:7168
    s_waitcnt lgkmcnt(0)
    s_call_b64 s[30:31], U_a192_a208
    s_add_u32 s29, s58, 0x34000
    buffer_load_dwordx4 v[144:147], v1, s[4:7], s29 offen offset:0
    buffer_load_dwordx4 v[148:151], v1, s[4:7], s29 offen offset:128
    buffer_load_dwordx4 v[152:155], v1, s[4:7], s29 offen offset:2048
    buffer_load_dwordx4 v[156:159], v1, s[4:7], s29 offen offset:2176
    buffer_load_dwordx4 v[160:163], v2, s[8:11], s29 offen offset:0
    buffer_load_dwordx4 v[164:167], v2, s[8:11], s29 offen offset:256
    buffer_load_dwordx4 v[168:171], v2, s[8:11], s29 offen offset:2048
    buffer_load_dwordx4 v[172:175], v2, s[8:11], s29 offen offset:2304
    ds_read_b128 a[224:227], v10 offset:8192
    ds_read_b128 a[228:231], v10 offset:9216
    ds_read_b128 a[232:235], v10 offset:10240
    ds_read_b128 a[236:239], v10 offset:11264
    ds_read_b128 a[240:243], v10 offset:12288
    ds_read_b128 a[244:247], v10 offset:13312
    ds_read_b128 a[248:251], v10 offset:14336
    ds_read_b128 a[252:255], v10 offset:15360
    s_waitcnt lgkmcnt(0)
    s_call_b64 s[30:31], U_a224_a240
    s_waitcnt vmcnt(24)
CK_34:
    v_sad_u8 v99, v96, 0, 0
    v_sad_u8 v99, v97, 0, v99
    v_cmp_gt_u32 vcc, 16, v99
    s_cbranch_vccnz RT_35
CT_36:
    s_lshl_b32 s29, s26, 10
    s_add_u32 s29, s29, s78
    buffer_load_dword v100, v3, s[12:15], s29 offen sc1
    v_and_b32 v101, 3, v0
    v_lshlrev_b32 v101, 12, v101
    buffer_load_dword v100, v101, s[12:15], s79 offen sc1
    v_and_b32 v102, 1, v0
    v_lshlrev_b32 v102, 16, v102
    s_add_u32 s29, s72, 0x20000
    buffer_load_dword v100, v102, s[12:15], s29 offen sc1
    ds_read_b128 a[192:195], v10 offset:16384
    ds_read_b128 a[196:199], v10 offset:17408
    ds_read_b128 a[200:203], v10 offset:18432
    ds_read_b128 a[204:207], v10 offset:19456
    ds_read_b128 a[208:211], v10 offset:20480
    ds_read_b128 a[212:215], v10 offset:21504
    ds_read_b128 a[216:219], v10 offset:22528
    ds_read_b128 a[220:223], v10 offset:23552
    s_waitcnt lgkmcnt(0)
    s_call_b64 s[30:31], U_a192_a208
    ds_read_b128 a[224:227], v10 offset:24576
    ds_read_b128 a[228:231], v10 offset:25600
    ds_read_b128 a[232:235], v10 offset:26624
    ds_read_b128 a[236:239], v10 offset:27648
    ds_read_b128 a[240:243], v10 offset:28672
    ds_read_b128 a[244:247], v10 offset:29696
    ds_read_b128 a[248:251], v10 offset:30720
    ds_read_b128 a[252:255], v10 offset:31744
    s_waitcnt lgkmcnt(0)
    s_call_b64 s[30:31], U_a224_a240
    s_waitcnt vmcnt(19)
    ds_read_b128 a[192:195], v10 offset:32768
    ds_read_b128 a[196:199], v10 offset:33792
    ds_read_b128 a[200:203], v10 offset:34816
    ds_read_b128 a[204:207], v10 offset:35840
    s_waitcnt lgkmcnt(0)
    s_call_b64 s[30:31], U_a192_v240
    s_add_u32 s29, s58, 0x38000
    buffer_load_dwordx4 a[192:195], v1, s[4:7], s29 offen offset:0 nt
    buffer_load_dwordx4 a[196:199], v1, s[4:7], s29 offen offset:128 nt
    buffer_load_dwordx4 a[200:203], v1, s[4:7], s29 offen offset:2048 nt
    buffer_load_dwordx4 a[204:207], v1, s[4:7], s29 offen offset:2176 nt
    buffer_load_dwordx4 a[208:211], v2, s[8:11], s29 offen offset:0 nt
    buffer_load_dwordx4 a[212:215], v2, s[8:11], s29 offen offset:256 nt
    buffer_load_dwordx4 a[216:219], v2, s[8:11], s29 offen offset:2048 nt
    buffer_load_dwordx4 a[220:223], v2, s[8:11], s29 offen offset:2304 nt
    s_waitcnt vmcnt(19)
    s_call_b64 s[30:31], U_v176_v192
    s_add_u32 s29, s58, 0x3c000
    buffer_load_dwordx4 a[224:227], v1, s[4:7], s29 offen offset:0 nt
    buffer_load_dwordx4 a[228:231], v1, s[4:7], s29 offen offset:128 nt
    buffer_load_dwordx4 a[232:235], v1, s[4:7], s29 offen offset:2048 nt
    buffer_load_dwordx4 a[236:239], v1, s[4:7], s29 offen offset:2176 nt
    buffer_load_dwordx4 a[240:243], v2, s[8:11], s29 offen offset:0 nt
    buffer_load_dwordx4 a[244:247], v2, s[8:11], s29 offen offset:256 nt
    buffer_load_dwordx4 a[248:251], v2, s[8:11], s29 offen offset:2048 nt
    buffer_load_dwordx4 a[252:255], v2, s[8:11], s29 offen offset:2304 nt
    s_waitcnt vmcnt(19)
    s_call_b64 s[30:31], U_v144_v160
    s_waitcnt vmcnt(8)
    s_call_b64 s[30:31], U_a192_a208
    s_call_b64 s[30:31], F_wow
    s_waitcnt vmcnt(8)
    s_call_b64 s[30:31], U_a224_a240
    s_mov_b32 s81, 0
    s_mov_b32 s82, 0
    s_mov_b32 s83, 9216
    s_mov_b32 s84, 0x20000
    s_mov_b32 s85, 14848
    s_mov_b32 s101, 13824
    s_call_b64 s[30:31], F_comb
    s_cmp_ge_u32 s2, 192
    s_cbranch_scc1 L_free
    s_sleep 4
    s_call_b64 s[30:31], F_woi
    s_waitcnt vmcnt(0)
    s_call_b64 s[30:31], F_wof
    v_mov_b32 v48, -1
    v_mov_b32 v49, -1
    v_mov_b32 v50, -1
    v_mov_b32 v51, -1
    v_lshrrev_b32 v52, 4, v0
    v_lshlrev_b32 v52, 18, v52
    v_and_b32 v53, 0xf0, v8
    v_add_u32 v52, v52, v53
    s_lshl_b32 s59, s26, 10
    s_add_u32 s59, s59, s78
    s_add_u32 s59, s59, 0x40000
    s_mov_b32 exec_hi, 0xffff
    s_cmp_eq_u32 s89, 0
    s_cbranch_scc1 FS_52
    buffer_store_dwordx4 v[48:51], v52, s[12:15], s59 offen
FS_53:
    s_mov_b64 exec, -1
    s_sleep 16
    s_call_b64 s[30:31], F_g4i
    s_waitcnt vmcnt(13)
    s_call_b64 s[30:31], F_up
    s_waitcnt vmcnt(0)
    s_call_b64 s[30:31], F_xc
    s_mul_i32 s73, s61, 12
    v_and_b32 v14, 12, v3
    v_add_u32 v14, s73, v14
    v_add_u32 v15, s83, v14
    ds_read_b32 v58, v15
    s_waitcnt lgkmcnt(0)
    s_barrier
    ds_read_b32 v143, v14 offset:0
    ds_read_b32 v12, v14 offset:2304
    ds_read_b32 v13, v14 offset:4608
    ds_read_b32 v15, v14 offset:6912
    ds_read_b128 v[80:83], v8 offset:0
    ds_read_b128 v[84:87], v8 offset:1024
    ds_read_b32 v112, v3 offset:2048
    ds_read_b128 v[88:91], v8 offset:2304
    ds_read_b128 v[92:95], v8 offset:3328
    ds_read_b32 v113, v3 offset:4352
    ds_read_b128 v[96:99], v8 offset:4608
    ds_read_b128 v[100:103], v8 offset:5632
    ds_read_b32 v114, v3 offset:6656
    ds_read_b128 v[104:107], v8 offset:6912
    ds_read_b128 v[108:111], v8 offset:7936
    ds_read_b32 v115, v3 offset:8960
    s_waitcnt lgkmcnt(12)
    v_add_f32 v143, v143, v12
    v_add_f32 v13, v13, v15
    v_add_f32 v143, v143, v13
    v_cvt_pk_bf16_f32 v12, v143, v143
    v_lshlrev_b32 v143, 16, v12
    v_add_f32 v143, v143, v58
    v_cvt_pk_bf16_f32 v12, v143, v143
    v_lshlrev_b32 v143, 16, v12
    s_waitcnt lgkmcnt(6)
    v_pk_add_f32 v[48:49], v[48:49], v[80:81]
    v_pk_add_f32 v[50:51], v[50:51], v[82:83]
    v_pk_add_f32 v[52:53], v[52:53], v[84:85]
    v_pk_add_f32 v[54:55], v[54:55], v[86:87]
    v_pk_add_f32 v[48:49], v[48:49], v[88:89]
    v_pk_add_f32 v[50:51], v[50:51], v[90:91]
    v_pk_add_f32 v[52:53], v[52:53], v[92:93]
    v_pk_add_f32 v[54:55], v[54:55], v[94:95]
    s_waitcnt lgkmcnt(0)
    v_pk_add_f32 v[96:97], v[96:97], v[104:105]
    v_pk_add_f32 v[98:99], v[98:99], v[106:107]
    v_pk_add_f32 v[100:101], v[100:101], v[108:109]
    v_pk_add_f32 v[102:103], v[102:103], v[110:111]
    v_pk_add_f32 v[112:113], v[112:113], v[114:115]
    v_pk_add_f32 v[48:49], v[48:49], v[96:97]
    v_pk_add_f32 v[50:51], v[50:51], v[98:99]
    v_pk_add_f32 v[52:53], v[52:53], v[100:101]
    v_pk_add_f32 v[54:55], v[54:55], v[102:103]
    v_add_f32 v56, v56, v112
    v_add_f32 v56, v56, v113
    v_pk_add_f32 v[100:101], v[48:49], v[50:51]
    v_pk_add_f32 v[80:81], v[52:53], v[54:55]
    s_add_u32 s91, s58, 0x4000000
    buffer_load_dwordx4 v[144:147], v1, s[4:7], s91 offen offset:0 nt
    buffer_load_dwordx4 v[148:151], v1, s[4:7], s91 offen offset:128 nt
    v_pk_add_f32 v[100:101], v[100:101], v[80:81]
    v_add_f32 v100, v100, v56
    v_add_f32 v100, v100, v101
    s_nop 1
    v_add_f32_dpp v100, v100, v100 row_ror:8 row_mask:0xf bank_mask:0xf
    s_nop 1
    v_add_f32_dpp v100, v100, v100 row_ror:4 row_mask:0xf bank_mask:0xf
    s_nop 1
    v_add_f32_dpp v100, v100, v100 row_ror:2 row_mask:0xf bank_mask:0xf
    s_nop 1
    v_add_f32_dpp v100, v100, v100 row_ror:1 row_mask:0xf bank_mask:0xf
    v_mov_b32 v12, v100
    s_nop 1
    v_permlane16_swap_b32 v100, v12
    v_add_f32 v100, v100, v12
    v_mov_b32 v12, v100
    s_nop 1
    v_permlane32_swap_b32 v100, v12
    v_add_f32 v100, v100, v12
    v_mul_f32 v100, 0x3ae38e39, v100
    v_pk_add_f32 v[80:81], v[48:49], v[100:101] op_sel_hi:[1,0] neg_lo:[0,1] neg_hi:[0,1]
    v_pk_add_f32 v[82:83], v[50:51], v[100:101] op_sel_hi:[1,0] neg_lo:[0,1] neg_hi:[0,1]
    v_pk_add_f32 v[84:85], v[52:53], v[100:101] op_sel_hi:[1,0] neg_lo:[0,1] neg_hi:[0,1]
    v_pk_add_f32 v[86:87], v[54:55], v[100:101] op_sel_hi:[1,0] neg_lo:[0,1] neg_hi:[0,1]
    v_sub_f32 v88, v56, v100
    v_pk_mul_f32 v[80:81], v[80:81], v[80:81]
    v_mul_f32 v101, v88, v88
    v_pk_fma_f32 v[80:81], v[82:83], v[82:83], v[80:81]
    v_pk_fma_f32 v[80:81], v[84:85], v[84:85], v[80:81]
    v_pk_fma_f32 v[80:81], v[86:87], v[86:87], v[80:81]
    v_add_f32 v101, v101, v80
    v_add_f32 v101, v101, v81
    s_nop 1
    v_add_f32_dpp v101, v101, v101 row_ror:8 row_mask:0xf bank_mask:0xf
    s_nop 1
    v_add_f32_dpp v101, v101, v101 row_ror:4 row_mask:0xf bank_mask:0xf
    s_nop 1
    v_add_f32_dpp v101, v101, v101 row_ror:2 row_mask:0xf bank_mask:0xf
    s_nop 1
    v_add_f32_dpp v101, v101, v101 row_ror:1 row_mask:0xf bank_mask:0xf
    v_mov_b32 v12, v101
    s_nop 1
    v_permlane16_swap_b32 v101, v12
    v_add_f32 v101, v101, v12
    v_mov_b32 v12, v101
    s_nop 1
    v_permlane32_swap_b32 v101, v12
    v_add_f32 v101, v101, v12
    v_mul_f32 v101, 0x3ae38e39, v101
    v_cvt_pk_bf16_f32 v12, v100, v101
    v_lshlrev_b32 v80, 16, v12
    v_and_b32 v81, 0xffff0000, v12
    v_add_f32 v81, s90, v81
    v_sub_f32 v13, v143, v80
    v_cvt_pk_bf16_f32 v12, v81, v13
    v_lshlrev_b32 v81, 16, v12
    v_and_b32 v13, 0xffff0000, v12
    v_sqrt_f32 v81, v81
    v_sub_f32 v82, v100, v80
    v_cvt_pk_bf16_f32 v12, v81, v81
    v_lshlrev_b32 v81, 16, v12
    v_rcp_f32 v81, v81
    s_nop 0
    v_mul_f32 v101, v101, v81
    v_mul_f32 v82, v82, v81
    v_mul_f32 v101, v101, v81
    v_mul_f32 v13, v13, v81
    v_cvt_pk_bf16_f32 v12, v82, v101
    v_lshlrev_b32 v82, 16, v12
    v_and_b32 v101, 0xffff0000, v12
    v_add_f32 v101, s90, v101
    v_cvt_pk_bf16_f32 v12, v13, v101
    v_lshlrev_b32 v13, 16, v12
    v_and_b32 v101, 0xffff0000, v12
    v_sqrt_f32 v101, v101
    v_sub_f32 v13, v13, v82
    v_cvt_pk_bf16_f32 v12, v13, v101
    v_lshlrev_b32 v13, 16, v12
    v_and_b32 v101, 0xffff0000, v12
    v_rcp_f32 v101, v101
    s_nop 0
    v_mul_f32 v13, v13, v101
    v_cvt_pk_bf16_f32 v12, v13, v13
    v_lshlrev_b32 v13, 16, v12
    v_mov_b32 v108, 0xc0135761
    s_nop 0
    buffer_load_dwordx4 v[152:155], v1, s[4:7], s91 offen offset:2048 nt
    buffer_load_dwordx4 v[156:159], v1, s[4:7], s91 offen offset:2176 nt
    v_mov_b32_dpp v102, v13 quad_perm:[0,0,0,0] row_mask:0xf bank_mask:0xf
    v_mov_b32_dpp v104, v13 quad_perm:[1,1,1,1] row_mask:0xf bank_mask:0xf
    v_mov_b32_dpp v106, v13 quad_perm:[2,2,2,2] row_mask:0xf bank_mask:0xf
    v_pk_fma_f32 v[86:87], v[102:103], v[116:117], v[124:125] op_sel_hi:[0,1,1]
    v_pk_fma_f32 v[88:89], v[104:105], v[116:117], v[124:125] op_sel_hi:[0,1,1]
    v_pk_fma_f32 v[90:91], v[106:107], v[116:117], v[124:125] op_sel_hi:[0,1,1]
    v_pk_mul_f32 v[92:93], v[86:87], v[86:87]
    v_pk_mul_f32 v[94:95], v[88:89], v[88:89]
    v_pk_mul_f32 v[96:97], v[90:91], v[90:91]
    v_pk_fma_f32 v[92:93], v[92:93], s[66:67], v[108:109] op_sel_hi:[1,1,0]
    v_pk_fma_f32 v[94:95], v[94:95], s[66:67], v[108:109] op_sel_hi:[1,1,0]
    v_pk_fma_f32 v[96:97], v[96:97], s[66:67], v[108:109] op_sel_hi:[1,1,0]
    v_pk_mul_f32 v[92:93], v[92:93], v[86:87]
    v_pk_mul_f32 v[94:95], v[94:95], v[88:89]
    v_pk_mul_f32 v[96:97], v[96:97], v[90:91]
    v_exp_f32 v92, v92
    v_exp_f32 v93, v93
    v_exp_f32 v94, v94
    v_exp_f32 v95, v95
    v_exp_f32 v96, v96
    v_exp_f32 v97, v97
    v_pk_mul_f32 v[86:87], v[86:87], v[132:133]
    v_pk_mul_f32 v[88:89], v[88:89], v[132:133]
    v_pk_mul_f32 v[90:91], v[90:91], v[132:133]
    v_pk_add_f32 v[92:93], v[92:93], 1.0 op_sel_hi:[1,0]
    v_pk_add_f32 v[94:95], v[94:95], 1.0 op_sel_hi:[1,0]
    v_pk_add_f32 v[96:97], v[96:97], 1.0 op_sel_hi:[1,0]
    v_rcp_f32 v92, v92
    v_rcp_f32 v93, v93
    v_rcp_f32 v94, v94
    v_rcp_f32 v95, v95
    v_rcp_f32 v96, v96
    v_rcp_f32 v97, v97
    v_pk_mul_f32 v[110:111], v[86:87], v[92:93]
    v_pk_mul_f32 v[112:113], v[88:89], v[94:95]
    v_pk_mul_f32 v[114:115], v[90:91], v[96:97]
    v_pk_fma_f32 v[86:87], v[102:103], v[118:119], v[126:127] op_sel_hi:[0,1,1]
    v_pk_fma_f32 v[88:89], v[104:105], v[118:119], v[126:127] op_sel_hi:[0,1,1]
    v_pk_fma_f32 v[90:91], v[106:107], v[118:119], v[126:127] op_sel_hi:[0,1,1]
    v_pk_mul_f32 v[92:93], v[86:87], v[86:87]
    v_pk_mul_f32 v[94:95], v[88:89], v[88:89]
    v_pk_mul_f32 v[96:97], v[90:91], v[90:91]
    v_pk_fma_f32 v[92:93], v[92:93], s[66:67], v[108:109] op_sel_hi:[1,1,0]
    v_pk_fma_f32 v[94:95], v[94:95], s[66:67], v[108:109] op_sel_hi:[1,1,0]
    v_pk_fma_f32 v[96:97], v[96:97], s[66:67], v[108:109] op_sel_hi:[1,1,0]
    v_pk_mul_f32 v[92:93], v[92:93], v[86:87]
    v_pk_mul_f32 v[94:95], v[94:95], v[88:89]
    v_pk_mul_f32 v[96:97], v[96:97], v[90:91]
    v_exp_f32 v92, v92
    v_exp_f32 v93, v93
    v_exp_f32 v94, v94
    v_exp_f32 v95, v95
    v_exp_f32 v96, v96
    v_exp_f32 v97, v97
    v_pk_mul_f32 v[86:87], v[86:87], v[134:135]
    v_pk_mul_f32 v[88:89], v[88:89], v[134:135]
    v_pk_mul_f32 v[90:91], v[90:91], v[134:135]
    v_pk_add_f32 v[92:93], v[92:93], 1.0 op_sel_hi:[1,0]
    v_pk_add_f32 v[94:95], v[94:95], 1.0 op_sel_hi:[1,0]
    v_pk_add_f32 v[96:97], v[96:97], 1.0 op_sel_hi:[1,0]
    v_rcp_f32 v92, v92
    v_rcp_f32 v93, v93
    v_rcp_f32 v94, v94
    v_rcp_f32 v95, v95
    v_rcp_f32 v96, v96
    v_rcp_f32 v97, v97
    v_pk_fma_f32 v[110:111], v[86:87], v[92:93], v[110:111]
    v_pk_fma_f32 v[112:113], v[88:89], v[94:95], v[112:113]
    v_pk_fma_f32 v[114:115], v[90:91], v[96:97], v[114:115]
    v_and_b32 v84, 0xffff0000, v136
    v_and_b32 v85, 0xffff0000, v137
    v_pk_fma_f32 v[86:87], v[102:103], v[120:121], v[128:129] op_sel_hi:[0,1,1]
    v_pk_fma_f32 v[88:89], v[104:105], v[120:121], v[128:129] op_sel_hi:[0,1,1]
    v_pk_fma_f32 v[90:91], v[106:107], v[120:121], v[128:129] op_sel_hi:[0,1,1]
    v_pk_mul_f32 v[92:93], v[86:87], v[86:87]
    v_pk_mul_f32 v[94:95], v[88:89], v[88:89]
    buffer_load_dwordx4 v[160:163], v2, s[8:11], s91 offen offset:0 nt
    buffer_load_dwordx4 v[164:167], v2, s[8:11], s91 offen offset:256 nt
    v_pk_mul_f32 v[96:97], v[90:91], v[90:91]
    v_pk_fma_f32 v[92:93], v[92:93], s[66:67], v[108:109] op_sel_hi:[1,1,0]
    v_pk_fma_f32 v[94:95], v[94:95], s[66:67], v[108:109] op_sel_hi:[1,1,0]
    v_pk_fma_f32 v[96:97], v[96:97], s[66:67], v[108:109] op_sel_hi:[1,1,0]
    v_pk_mul_f32 v[92:93], v[92:93], v[86:87]
    v_pk_mul_f32 v[94:95], v[94:95], v[88:89]
    v_pk_mul_f32 v[96:97], v[96:97], v[90:91]
    v_exp_f32 v92, v92
    v_exp_f32 v93, v93
    v_exp_f32 v94, v94
    v_exp_f32 v95, v95
    v_exp_f32 v96, v96
    v_exp_f32 v97, v97
    v_pk_mul_f32 v[86:87], v[86:87], v[84:85]
    v_pk_mul_f32 v[88:89], v[88:89], v[84:85]
    v_pk_mul_f32 v[90:91], v[90:91], v[84:85]
    v_pk_add_f32 v[92:93], v[92:93], 1.0 op_sel_hi:[1,0]
    v_pk_add_f32 v[94:95], v[94:95], 1.0 op_sel_hi:[1,0]
    v_pk_add_f32 v[96:97], v[96:97], 1.0 op_sel_hi:[1,0]
    v_rcp_f32 v92, v92
    v_rcp_f32 v93, v93
    v_rcp_f32 v94, v94
    v_rcp_f32 v95, v95
    v_rcp_f32 v96, v96
    v_rcp_f32 v97, v97
    v_pk_fma_f32 v[110:111], v[86:87], v[92:93], v[110:111]
    v_pk_fma_f32 v[112:113], v[88:89], v[94:95], v[112:113]
    v_pk_fma_f32 v[114:115], v[90:91], v[96:97], v[114:115]
    v_and_b32 v84, 0xffff0000, v138
    v_and_b32 v85, 0xffff0000, v139
    v_pk_fma_f32 v[86:87], v[102:103], v[122:123], v[130:131] op_sel_hi:[0,1,1]
    v_pk_fma_f32 v[88:89], v[104:105], v[122:123], v[130:131] op_sel_hi:[0,1,1]
    v_pk_fma_f32 v[90:91], v[106:107], v[122:123], v[130:131] op_sel_hi:[0,1,1]
    v_pk_mul_f32 v[92:93], v[86:87], v[86:87]
    v_pk_mul_f32 v[94:95], v[88:89], v[88:89]
    v_pk_mul_f32 v[96:97], v[90:91], v[90:91]
    v_pk_fma_f32 v[92:93], v[92:93], s[66:67], v[108:109] op_sel_hi:[1,1,0]
    v_pk_fma_f32 v[94:95], v[94:95], s[66:67], v[108:109] op_sel_hi:[1,1,0]
    v_pk_fma_f32 v[96:97], v[96:97], s[66:67], v[108:109] op_sel_hi:[1,1,0]
    v_pk_mul_f32 v[92:93], v[92:93], v[86:87]
    v_pk_mul_f32 v[94:95], v[94:95], v[88:89]
    v_pk_mul_f32 v[96:97], v[96:97], v[90:91]
    v_exp_f32 v92, v92
    v_exp_f32 v93, v93
    v_exp_f32 v94, v94
    v_exp_f32 v95, v95
    v_exp_f32 v96, v96
    v_exp_f32 v97, v97
    v_pk_mul_f32 v[86:87], v[86:87], v[84:85]
    v_pk_mul_f32 v[88:89], v[88:89], v[84:85]
    v_pk_mul_f32 v[90:91], v[90:91], v[84:85]
    v_pk_add_f32 v[92:93], v[92:93], 1.0 op_sel_hi:[1,0]
    v_pk_add_f32 v[94:95], v[94:95], 1.0 op_sel_hi:[1,0]
    v_pk_add_f32 v[96:97], v[96:97], 1.0 op_sel_hi:[1,0]
    v_rcp_f32 v92, v92
    v_rcp_f32 v93, v93
    v_rcp_f32 v94, v94
    v_rcp_f32 v95, v95
    v_rcp_f32 v96, v96
    v_rcp_f32 v97, v97
    v_pk_fma_f32 v[110:111], v[86:87], v[92:93], v[110:111]
    v_pk_fma_f32 v[112:113], v[88:89], v[94:95], v[112:113]
    v_pk_fma_f32 v[114:115], v[90:91], v[96:97], v[114:115]
    v_pk_fma_f32 v[86:87], v[102:103], v[16:17], v[24:25] op_sel_hi:[0,1,1]
    v_pk_fma_f32 v[88:89], v[104:105], v[16:17], v[24:25] op_sel_hi:[0,1,1]
    v_pk_fma_f32 v[90:91], v[106:107], v[16:17], v[24:25] op_sel_hi:[0,1,1]
    v_pk_mul_f32 v[92:93], v[86:87], v[86:87]
    v_pk_mul_f32 v[94:95], v[88:89], v[88:89]
    v_pk_mul_f32 v[96:97], v[90:91], v[90:91]
    v_pk_fma_f32 v[92:93], v[92:93], s[66:67], v[108:109] op_sel_hi:[1,1,0]
    v_pk_fma_f32 v[94:95], v[94:95], s[66:67], v[108:109] op_sel_hi:[1,1,0]
    v_pk_fma_f32 v[96:97], v[96:97], s[66:67], v[108:109] op_sel_hi:[1,1,0]
    v_pk_mul_f32 v[92:93], v[92:93], v[86:87]
    v_pk_mul_f32 v[94:95], v[94:95], v[88:89]
    v_pk_mul_f32 v[96:97], v[96:97], v[90:91]
    v_exp_f32 v92, v92
    buffer_load_dwordx4 v[168:171], v2, s[8:11], s91 offen offset:2048 nt
    buffer_load_dwordx4 v[172:175], v2, s[8:11], s91 offen offset:2304 nt
    v_exp_f32 v93, v93
    v_exp_f32 v94, v94
    v_exp_f32 v95, v95
    v_exp_f32 v96, v96
    v_exp_f32 v97, v97
    v_pk_mul_f32 v[86:87], v[86:87], v[44:45]
    v_pk_mul_f32 v[88:89], v[88:89], v[44:45]
    v_pk_mul_f32 v[90:91], v[90:91], v[44:45]
    v_pk_add_f32 v[92:93], v[92:93], 1.0 op_sel_hi:[1,0]
    v_pk_add_f32 v[94:95], v[94:95], 1.0 op_sel_hi:[1,0]
    v_pk_add_f32 v[96:97], v[96:97], 1.0 op_sel_hi:[1,0]
    v_rcp_f32 v92, v92
    v_rcp_f32 v93, v93
    v_rcp_f32 v94, v94
    v_rcp_f32 v95, v95
    v_rcp_f32 v96, v96
    v_rcp_f32 v97, v97
    v_pk_fma_f32 v[110:111], v[86:87], v[92:93], v[110:111]
    v_pk_fma_f32 v[112:113], v[88:89], v[94:95], v[112:113]
    v_pk_fma_f32 v[114:115], v[90:91], v[96:97], v[114:115]
    v_pk_fma_f32 v[86:87], v[102:103], v[18:19], v[26:27] op_sel_hi:[0,1,1]
    v_pk_fma_f32 v[88:89], v[104:105], v[18:19], v[26:27] op_sel_hi:[0,1,1]
    v_pk_fma_f32 v[90:91], v[106:107], v[18:19], v[26:27] op_sel_hi:[0,1,1]
    v_pk_mul_f32 v[92:93], v[86:87], v[86:87]
    v_pk_mul_f32 v[94:95], v[88:89], v[88:89]
    v_pk_mul_f32 v[96:97], v[90:91], v[90:91]
    v_pk_fma_f32 v[92:93], v[92:93], s[66:67], v[108:109] op_sel_hi:[1,1,0]
    v_pk_fma_f32 v[94:95], v[94:95], s[66:67], v[108:109] op_sel_hi:[1,1,0]
    v_pk_fma_f32 v[96:97], v[96:97], s[66:67], v[108:109] op_sel_hi:[1,1,0]
    v_pk_mul_f32 v[92:93], v[92:93], v[86:87]
    v_pk_mul_f32 v[94:95], v[94:95], v[88:89]
    v_pk_mul_f32 v[96:97], v[96:97], v[90:91]
    v_exp_f32 v92, v92
    v_exp_f32 v93, v93
    v_exp_f32 v94, v94
    v_exp_f32 v95, v95
    v_exp_f32 v96, v96
    v_exp_f32 v97, v97
    v_pk_mul_f32 v[86:87], v[86:87], v[46:47]
    v_pk_mul_f32 v[88:89], v[88:89], v[46:47]
    v_pk_mul_f32 v[90:91], v[90:91], v[46:47]
    v_pk_add_f32 v[92:93], v[92:93], 1.0 op_sel_hi:[1,0]
    v_pk_add_f32 v[94:95], v[94:95], 1.0 op_sel_hi:[1,0]
    v_pk_add_f32 v[96:97], v[96:97], 1.0 op_sel_hi:[1,0]
    v_rcp_f32 v92, v92
    v_rcp_f32 v93, v93
    v_rcp_f32 v94, v94
    v_rcp_f32 v95, v95
    v_rcp_f32 v96, v96
    v_rcp_f32 v97, v97
    v_pk_fma_f32 v[110:111], v[86:87], v[92:93], v[110:111]
    v_pk_fma_f32 v[112:113], v[88:89], v[94:95], v[112:113]
    v_pk_fma_f32 v[114:115], v[90:91], v[96:97], v[114:115]
    v_lshlrev_b32 v84, 16, v136
    v_lshlrev_b32 v85, 16, v137
    v_pk_fma_f32 v[86:87], v[102:103], v[20:21], v[28:29] op_sel_hi:[0,1,1]
    v_pk_fma_f32 v[88:89], v[104:105], v[20:21], v[28:29] op_sel_hi:[0,1,1]
    v_pk_fma_f32 v[90:91], v[106:107], v[20:21], v[28:29] op_sel_hi:[0,1,1]
    v_pk_mul_f32 v[92:93], v[86:87], v[86:87]
    v_pk_mul_f32 v[94:95], v[88:89], v[88:89]
    v_pk_mul_f32 v[96:97], v[90:91], v[90:91]
    v_pk_fma_f32 v[92:93], v[92:93], s[66:67], v[108:109] op_sel_hi:[1,1,0]
    v_pk_fma_f32 v[94:95], v[94:95], s[66:67], v[108:109] op_sel_hi:[1,1,0]
    v_pk_fma_f32 v[96:97], v[96:97], s[66:67], v[108:109] op_sel_hi:[1,1,0]
    v_pk_mul_f32 v[92:93], v[92:93], v[86:87]
    v_pk_mul_f32 v[94:95], v[94:95], v[88:89]
    v_pk_mul_f32 v[96:97], v[96:97], v[90:91]
    v_exp_f32 v92, v92
    v_exp_f32 v93, v93
    v_exp_f32 v94, v94
    v_exp_f32 v95, v95
    v_exp_f32 v96, v96
    v_exp_f32 v97, v97
    v_pk_mul_f32 v[86:87], v[86:87], v[84:85]
    v_pk_mul_f32 v[88:89], v[88:89], v[84:85]
    v_pk_mul_f32 v[90:91], v[90:91], v[84:85]
    v_pk_add_f32 v[92:93], v[92:93], 1.0 op_sel_hi:[1,0]
    v_pk_add_f32 v[94:95], v[94:95], 1.0 op_sel_hi:[1,0]
    v_pk_add_f32 v[96:97], v[96:97], 1.0 op_sel_hi:[1,0]
    v_rcp_f32 v92, v92
    v_rcp_f32 v93, v93
    v_rcp_f32 v94, v94
    v_rcp_f32 v95, v95
    v_rcp_f32 v96, v96
    v_rcp_f32 v97, v97
    v_pk_fma_f32 v[110:111], v[86:87], v[92:93], v[110:111]
    v_pk_fma_f32 v[112:113], v[88:89], v[94:95], v[112:113]
    v_pk_fma_f32 v[114:115], v[90:91], v[96:97], v[114:115]
    v_lshlrev_b32 v84, 16, v138
    v_lshlrev_b32 v85, 16, v139
    v_pk_fma_f32 v[86:87], v[102:103], v[22:23], v[30:31] op_sel_hi:[0,1,1]
    v_pk_fma_f32 v[88:89], v[104:105], v[22:23], v[30:31] op_sel_hi:[0,1,1]
    v_pk_fma_f32 v[90:91], v[106:107], v[22:23], v[30:31] op_sel_hi:[0,1,1]
    v_pk_mul_f32 v[92:93], v[86:87], v[86:87]
    v_pk_mul_f32 v[94:95], v[88:89], v[88:89]
    v_pk_mul_f32 v[96:97], v[90:91], v[90:91]
    v_pk_fma_f32 v[92:93], v[92:93], s[66:67], v[108:109] op_sel_hi:[1,1,0]
    v_pk_fma_f32 v[94:95], v[94:95], s[66:67], v[108:109] op_sel_hi:[1,1,0]
    v_pk_fma_f32 v[96:97], v[96:97], s[66:67], v[108:109] op_sel_hi:[1,1,0]
    v_pk_mul_f32 v[92:93], v[92:93], v[86:87]
    v_pk_mul_f32 v[94:95], v[94:95], v[88:89]
    v_pk_mul_f32 v[96:97], v[96:97], v[90:91]
    v_exp_f32 v92, v92
    v_exp_f32 v93, v93
    v_exp_f32 v94, v94
    v_exp_f32 v95, v95
    v_exp_f32 v96, v96
    v_exp_f32 v97, v97
    v_pk_mul_f32 v[86:87], v[86:87], v[84:85]
    v_pk_mul_f32 v[88:89], v[88:89], v[84:85]
    v_pk_mul_f32 v[90:91], v[90:91], v[84:85]
    v_pk_add_f32 v[92:93], v[92:93], 1.0 op_sel_hi:[1,0]
    v_pk_add_f32 v[94:95], v[94:95], 1.0 op_sel_hi:[1,0]
    v_pk_add_f32 v[96:97], v[96:97], 1.0 op_sel_hi:[1,0]
    v_rcp_f32 v92, v92
    v_rcp_f32 v93, v93
    v_rcp_f32 v94, v94
    v_rcp_f32 v95, v95
    v_rcp_f32 v96, v96
    v_rcp_f32 v97, v97
    v_pk_fma_f32 v[110:111], v[86:87], v[92:93], v[110:111]
    v_pk_fma_f32 v[112:113], v[88:89], v[94:95], v[112:113]
    v_pk_fma_f32 v[114:115], v[90:91], v[96:97], v[114:115]
    v_lshlrev_b32 v80, 16, v140
    v_and_b32 v81, 0xffff0000, v140
    v_lshlrev_b32 v82, 16, v141
    v_and_b32 v83, 0xffff0000, v141
    v_lshlrev_b32 v84, 16, v142
    v_and_b32 v85, 0xffff0000, v142
    v_pk_fma_f32 v[86:87], v[102:103], v[80:81], v[82:83] op_sel_hi:[0,1,1]
    v_pk_fma_f32 v[88:89], v[104:105], v[80:81], v[82:83] op_sel_hi:[0,1,1]
    v_pk_fma_f32 v[90:91], v[106:107], v[80:81], v[82:83] op_sel_hi:[0,1,1]
    v_pk_mul_f32 v[92:93], v[86:87], v[86:87]
    v_pk_mul_f32 v[94:95], v[88:89], v[88:89]
    v_pk_mul_f32 v[96:97], v[90:91], v[90:91]
    v_pk_fma_f32 v[92:93], v[92:93], s[66:67], v[108:109] op_sel_hi:[1,1,0]
    v_pk_fma_f32 v[94:95], v[94:95], s[66:67], v[108:109] op_sel_hi:[1,1,0]
    v_pk_fma_f32 v[96:97], v[96:97], s[66:67], v[108:109] op_sel_hi:[1,1,0]
    v_pk_mul_f32 v[92:93], v[92:93], v[86:87]
    v_pk_mul_f32 v[94:95], v[94:95], v[88:89]
    v_pk_mul_f32 v[96:97], v[96:97], v[90:91]
    v_exp_f32 v92, v92
    v_exp_f32 v93, v93
    v_exp_f32 v94, v94
    v_exp_f32 v95, v95
    v_exp_f32 v96, v96
    v_exp_f32 v97, v97
    v_pk_mul_f32 v[86:87], v[86:87], v[84:85]
    v_pk_mul_f32 v[88:89], v[88:89], v[84:85]
    v_pk_mul_f32 v[90:91], v[90:91], v[84:85]
    v_pk_add_f32 v[92:93], v[92:93], 1.0 op_sel_hi:[1,0]
    v_pk_add_f32 v[94:95], v[94:95], 1.0 op_sel_hi:[1,0]
    v_pk_add_f32 v[96:97], v[96:97], 1.0 op_sel_hi:[1,0]
    v_rcp_f32 v92, v92
    v_rcp_f32 v93, v93
    v_rcp_f32 v94, v94
    v_rcp_f32 v95, v95
    v_rcp_f32 v96, v96
    v_rcp_f32 v97, v97
    v_pk_fma_f32 v[110:111], v[86:87], v[92:93], v[110:111]
    v_pk_fma_f32 v[112:113], v[88:89], v[94:95], v[112:113]
    v_pk_fma_f32 v[114:115], v[90:91], v[96:97], v[114:115]
    v_add_f32 v110, v110, v111
    v_add_f32 v112, v112, v113
    v_add_f32 v114, v114, v115
    v_add_f32_dpp v110, v110, v110 row_ror:8 row_mask:0xf bank_mask:0xf
    v_add_f32_dpp v112, v112, v112 row_ror:8 row_mask:0xf bank_mask:0xf
    v_add_f32_dpp v114, v114, v114 row_ror:8 row_mask:0xf bank_mask:0xf
    v_add_f32_dpp v110, v110, v110 row_ror:4 row_mask:0xf bank_mask:0xf
    v_add_f32_dpp v112, v112, v112 row_ror:4 row_mask:0xf bank_mask:0xf
    v_add_f32_dpp v114, v114, v114 row_ror:4 row_mask:0xf bank_mask:0xf
    v_add_f32_dpp v110, v110, v110 row_ror:2 row_mask:0xf bank_mask:0xf
    v_add_f32_dpp v112, v112, v112 row_ror:2 row_mask:0xf bank_mask:0xf
    v_add_f32_dpp v114, v114, v114 row_ror:2 row_mask:0xf bank_mask:0xf
    v_add_f32_dpp v110, v110, v110 row_ror:1 row_mask:0xf bank_mask:0xf
    v_add_f32_dpp v112, v112, v112 row_ror:1 row_mask:0xf bank_mask:0xf
    v_add_f32_dpp v114, v114, v114 row_ror:1 row_mask:0xf bank_mask:0xf
    s_lshl_b32 s29, s24, 4
    v_lshrrev_b32 v12, 4, v0
    v_lshl_add_u32 v12, v12, 2, s29
    ds_write_b32 v12, v110 offset:14848
    ds_write_b32 v12, v112 offset:14912
    ds_write_b32 v12, v114 offset:14976
    v_and_b32 v13, 3, v0
    v_lshlrev_b32 v13, 6, v13
    s_waitcnt lgkmcnt(0)
    s_barrier
    s_cmp_lg_u32 s24, 0
    s_cbranch_scc1 XD_57
    s_cmp_eq_u32 s62, 0
    s_cbranch_scc1 XD_57
    ds_read_b128 v[80:83], v13 offset:14848
    ds_read_b128 v[84:87], v13 offset:14864
    ds_read_b128 v[88:91], v13 offset:14880
    ds_read_b128 v[92:95], v13 offset:14896
    s_mul_i32 s29, s82, 2304
    s_add_u32 s59, s29, 0x68000
    v_add_u32 v15, s29, v14
    v_lshrrev_b32 v15, 1, v15
    s_waitcnt lgkmcnt(0)
    v_pk_add_f32 v[80:81], v[80:81], v[88:89]
    v_pk_add_f32 v[82:83], v[82:83], v[90:91]
    v_pk_add_f32 v[84:85], v[84:85], v[92:93]
    v_pk_add_f32 v[86:87], v[86:87], v[94:95]
    v_pk_add_f32 v[80:81], v[80:81], v[84:85]
    v_pk_add_f32 v[82:83], v[82:83], v[86:87]
    v_pk_add_f32 v[80:81], v[80:81], v[82:83]
    v_add_f32 v80, v80, v81
    v_cvt_pk_bf16_f32 v12, v80, v80
    v_lshlrev_b32 v80, 16, v12
    v_add_f32 v80, s68, v80
    v_cvt_pk_bf16_f32 v12, v80, v80
    v_lshlrev_b32 v80, 16, v12
    v_add_f32 v80, v80, v143
    v_cvt_pk_bf16_f32 v80, v80, v80
    s_mov_b64 exec, 7
    s_cmp_ge_u32 s81, 2
    s_cbranch_scc1 XF_58
    v_and_b32 v80, 0xffff0000, v80
    buffer_store_dword v80, v14, s[12:15], s59 offen sc1
    s_branch XR_59
XF_58:
    global_store_short v15, v80, s[52:53]
XR_59:
    s_mov_b64 exec, -1
XD_57:
    s_sleep 22
    s_call_b64 s[30:31], F_yi
    s_waitcnt vmcnt(0)
    s_call_b64 s[30:31], F_qstage
    v_add_u32 v12, s83, v8
    v_add_u32 v13, s83, v3
    ds_write_b128 v12, v[80:83]
    ds_write_b128 v12, v[84:87] offset:1024
    ds_write_b32 v13, v88 offset:2048
    s_call_b64 s[30:31], F_qgi
    s_add_u32 s29, s58, 0x34000
    buffer_load_dwordx4 v[80:83], v1, s[4:7], s29 offen offset:0 nt
    buffer_load_dwordx4 v[84:87], v1, s[4:7], s29 offen offset:128 nt
    buffer_load_dwordx4 v[88:91], v1, s[4:7], s29 offen offset:2048 nt
    buffer_load_dwordx4 v[92:95], v1, s[4:7], s29 offen offset:2176 nt
    buffer_load_dwordx4 v[96:99], v2, s[8:11], s29 offen offset:0 nt
    buffer_load_dwordx4 v[100:103], v2, s[8:11], s29 offen offset:256 nt
    buffer_load_dwordx4 v[104:107], v2, s[8:11], s29 offen offset:2048 nt
    buffer_load_dwordx4 v[108:111], v2, s[8:11], s29 offen offset:2304 nt
    s_waitcnt vmcnt(8)
    s_call_b64 s[30:31], F_qgf
    v_mfma_f32_16x16x32_bf16 v[48:51], a[160:163], v[16:19], 0
    v_mfma_f32_16x16x32_bf16 v[52:55], a[168:171], v[16:19], 0
    v_mfma_f32_16x16x32_bf16 v[48:51], a[164:167], v[20:23], v[48:51]
    v_mfma_f32_16x16x32_bf16 v[52:55], a[172:175], v[20:23], v[52:55]
    s_nop 7
    v_mov_b32_dpp v48, v48 quad_perm:[0,0,2,2] row_mask:0xf bank_mask:0xf
    v_mov_b32_dpp v50, v50 quad_perm:[0,0,2,2] row_mask:0xf bank_mask:0xf
    v_mov_b32_dpp v52, v52 quad_perm:[0,0,2,2] row_mask:0xf bank_mask:0xf
    v_mov_b32_dpp v54, v54 quad_perm:[0,0,2,2] row_mask:0xf bank_mask:0xf
    v_add_f32_dpp v48, v49, v48 quad_perm:[1,1,3,3] row_mask:0xf bank_mask:0xf
    v_add_f32_dpp v50, v51, v50 quad_perm:[1,1,3,3] row_mask:0xf bank_mask:0xf
    v_add_f32_dpp v52, v53, v52 quad_perm:[1,1,3,3] row_mask:0xf bank_mask:0xf
    v_add_f32_dpp v54, v55, v54 quad_perm:[1,1,3,3] row_mask:0xf bank_mask:0xf
    v_max3_f32 v12, v48, v50, v52
    v_max_f32 v12, v12, v54
    v_cmp_gt_f32 vcc, v12, v36
    s_cbranch_vccnz RS_60
RC_61:
    v_fma_f32 v48, v48, s27, -v37
    v_fma_f32 v50, v50, s27, -v37
    v_fma_f32 v52, v52, s27, -v37
    v_fma_f32 v54, v54, s27, -v37
    v_mfma_f32_16x16x32_bf16 v[24:27], a[128:131], v[16:19], 0
    v_mfma_f32_16x16x32_bf16 v[28:31], a[136:139], v[16:19], 0
    v_exp_f32 v48, v48
    v_exp_f32 v50, v50
    v_mfma_f32_16x16x32_bf16 v[24:27], a[132:135], v[20:23], v[24:27]
    v_exp_f32 v52, v52
    v_exp_f32 v54, v54
    v_mfma_f32_16x16x32_bf16 v[28:31], a[140:143], v[20:23], v[28:31]
    v_cvt_pk_bf16_f32 v13, v48, v48
    v_and_b32 v56, v13, v4
    v_and_b32 v57, v13, v5
    v_and_b32 v58, v13, v6
    v_and_b32 v59, v13, v7
    v_add_f32 v38, v38, v48
    v_cvt_pk_bf16_f32 v13, v50, v50
    v_mfma_f32_16x16x32_bf16 v[32:35], a[176:179], v[56:59], v[32:35]
    v_and_b32 v56, v13, v4
    v_and_b32 v57, v13, v5
    v_and_b32 v58, v13, v6
    v_and_b32 v59, v13, v7
    v_add_f32 v38, v38, v50
    v_cvt_pk_bf16_f32 v13, v52, v52
    v_mfma_f32_16x16x32_bf16 v[32:35], a[180:183], v[56:59], v[32:35]
    v_and_b32 v56, v13, v4
    v_and_b32 v57, v13, v5
    v_and_b32 v58, v13, v6
    v_and_b32 v59, v13, v7
    v_add_f32 v38, v38, v52
    v_cvt_pk_bf16_f32 v13, v54, v54
    v_mfma_f32_16x16x32_bf16 v[32:35], a[184:187], v[56:59], v[32:35]
    v_and_b32 v56, v13, v4
    v_and_b32 v57, v13, v5
    v_and_b32 v58, v13, v6
    v_and_b32 v59, v13, v7
    v_add_f32 v38, v38, v54
    s_nop 0
    v_mfma_f32_16x16x32_bf16 v[32:35], a[188:191], v[56:59], v[32:35]
    v_mov_b32_dpp v24, v24 quad_perm:[0,0,2,2] row_mask:0xf bank_mask:0xf
    s_add_u32 s92, s58, 0x4004000
    buffer_load_dwordx4 a[160:163], v1, s[4:7], s92 offen offset:0 nt
    buffer_load_dwordx4 a[164:167], v1, s[4:7], s92 offen offset:128 nt
    buffer_load_dwordx4 a[168:171], v1, s[4:7], s92 offen offset:2048 nt
    buffer_load_dwordx4 a[172:175], v1, s[4:7], s92 offen offset:2176 nt
    buffer_load_dwordx4 a[176:179], v2, s[8:11], s92 offen offset:0 nt
    buffer_load_dwordx4 a[180:183], v2, s[8:11], s92 offen offset:256 nt
    buffer_load_dwordx4 a[184:187], v2, s[8:11], s92 offen offset:2048 nt
    buffer_load_dwordx4 a[188:191], v2, s[8:11], s92 offen offset:2304 nt
    v_mov_b32_dpp v26, v26 quad_perm:[0,0,2,2] row_mask:0xf bank_mask:0xf
    v_mov_b32_dpp v28, v28 quad_perm:[0,0,2,2] row_mask:0xf bank_mask:0xf
    v_mov_b32_dpp v30, v30 quad_perm:[0,0,2,2] row_mask:0xf bank_mask:0xf
    v_add_f32_dpp v24, v25, v24 quad_perm:[1,1,3,3] row_mask:0xf bank_mask:0xf
    v_add_f32_dpp v26, v27, v26 quad_perm:[1,1,3,3] row_mask:0xf bank_mask:0xf
    v_add_f32_dpp v28, v29, v28 quad_perm:[1,1,3,3] row_mask:0xf bank_mask:0xf
    v_add_f32_dpp v30, v31, v30 quad_perm:[1,1,3,3] row_mask:0xf bank_mask:0xf
    v_max3_f32 v12, v24, v26, v28
    v_max_f32 v12, v12, v30
    v_cmp_gt_f32 vcc, v12, v36
    s_cbranch_vccnz RS_62
RC_63:
    v_fma_f32 v24, v24, s27, -v37
    v_fma_f32 v26, v26, s27, -v37
    v_fma_f32 v28, v28, s27, -v37
    v_fma_f32 v30, v30, s27, -v37
    v_mfma_f32_16x16x32_bf16 v[48:51], a[96:99], v[16:19], 0
    v_mfma_f32_16x16x32_bf16 v[52:55], a[104:107], v[16:19], 0
    v_exp_f32 v24, v24
    v_exp_f32 v26, v26
    v_mfma_f32_16x16x32_bf16 v[48:51], a[100:103], v[20:23], v[48:51]
    v_exp_f32 v28, v28
    v_exp_f32 v30, v30
    v_mfma_f32_16x16x32_bf16 v[52:55], a[108:111], v[20:23], v[52:55]
    v_cvt_pk_bf16_f32 v13, v24, v24
    v_and_b32 v56, v13, v4
    v_and_b32 v57, v13, v5
    v_and_b32 v58, v13, v6
    v_and_b32 v59, v13, v7
    v_add_f32 v38, v38, v24
    v_cvt_pk_bf16_f32 v13, v26, v26
    v_mfma_f32_16x16x32_bf16 v[32:35], a[144:147], v[56:59], v[32:35]
    v_and_b32 v56, v13, v4
    v_and_b32 v57, v13, v5
    v_and_b32 v58, v13, v6
    v_and_b32 v59, v13, v7
    v_add_f32 v38, v38, v26
    v_cvt_pk_bf16_f32 v13, v28, v28
    v_mfma_f32_16x16x32_bf16 v[32:35], a[148:151], v[56:59], v[32:35]
    v_and_b32 v56, v13, v4
    v_and_b32 v57, v13, v5
    v_and_b32 v58, v13, v6
    v_and_b32 v59, v13, v7
    v_add_f32 v38, v38, v28
    v_cvt_pk_bf16_f32 v13, v30, v30
    v_mfma_f32_16x16x32_bf16 v[32:35], a[152:155], v[56:59], v[32:35]
    v_and_b32 v56, v13, v4
    v_and_b32 v57, v13, v5
    v_and_b32 v58, v13, v6
    v_and_b32 v59, v13, v7
    v_add_f32 v38, v38, v30
    s_nop 0
    v_mfma_f32_16x16x32_bf16 v[32:35], a[156:159], v[56:59], v[32:35]
    v_mov_b32_dpp v48, v48 quad_perm:[0,0,2,2] row_mask:0xf bank_mask:0xf
    v_mov_b32_dpp v50, v50 quad_perm:[0,0,2,2] row_mask:0xf bank_mask:0xf
    v_mov_b32_dpp v52, v52 quad_perm:[0,0,2,2] row_mask:0xf bank_mask:0xf
    v_mov_b32_dpp v54, v54 quad_perm:[0,0,2,2] row_mask:0xf bank_mask:0xf
    v_add_f32_dpp v48, v49, v48 quad_perm:[1,1,3,3] row_mask:0xf bank_mask:0xf
    v_add_f32_dpp v50, v51, v50 quad_perm:[1,1,3,3] row_mask:0xf bank_mask:0xf
    v_add_f32_dpp v52, v53, v52 quad_perm:[1,1,3,3] row_mask:0xf bank_mask:0xf
    v_add_f32_dpp v54, v55, v54 quad_perm:[1,1,3,3] row_mask:0xf bank_mask:0xf
    v_max3_f32 v12, v48, v50, v52
    v_max_f32 v12, v12, v54
    v_cmp_gt_f32 vcc, v12, v36
    s_cbranch_vccnz RS_64
RC_65:
    v_fma_f32 v48, v48, s27, -v37
    v_fma_f32 v50, v50, s27, -v37
    v_fma_f32 v52, v52, s27, -v37
    v_fma_f32 v54, v54, s27, -v37
    v_mfma_f32_16x16x32_bf16 v[24:27], a[224:227], v[16:19], 0
    v_mfma_f32_16x16x32_bf16 v[28:31], a[232:235], v[16:19], 0
    v_exp_f32 v48, v48
    v_exp_f32 v50, v50
    v_mfma_f32_16x16x32_bf16 v[24:27], a[228:231], v[20:23], v[24:27]
    v_exp_f32 v52, v52
    v_exp_f32 v54, v54
    v_mfma_f32_16x16x32_bf16 v[28:31], a[236:239], v[20:23], v[28:31]
    v_cvt_pk_bf16_f32 v13, v48, v48
    v_and_b32 v56, v13, v4
    v_and_b32 v57, v13, v5
    v_and_b32 v58, v13, v6
    v_and_b32 v59, v13, v7
    v_add_f32 v38, v38, v48
    v_cvt_pk_bf16_f32 v13, v50, v50
    v_mfma_f32_16x16x32_bf16 v[32:35], a[112:115], v[56:59], v[32:35]
    v_and_b32 v56, v13, v4
    v_and_b32 v57, v13, v5
    v_and_b32 v58, v13, v6
    v_and_b32 v59, v13, v7
    v_add_f32 v38, v38, v50
    v_cvt_pk_bf16_f32 v13, v52, v52
    v_mfma_f32_16x16x32_bf16 v[32:35], a[116:119], v[56:59], v[32:35]
    v_and_b32 v56, v13, v4
    v_and_b32 v57, v13, v5
    v_and_b32 v58, v13, v6
    v_and_b32 v59, v13, v7
    v_add_f32 v38, v38, v52
    v_cvt_pk_bf16_f32 v13, v54, v54
    v_mfma_f32_16x16x32_bf16 v[32:35], a[120:123], v[56:59], v[32:35]
    v_and_b32 v56, v13, v4
    v_and_b32 v57, v13, v5
    v_and_b32 v58, v13, v6
    v_and_b32 v59, v13, v7
    v_add_f32 v38, v38, v54
    s_nop 0
    v_mfma_f32_16x16x32_bf16 v[32:35], a[124:127], v[56:59], v[32:35]
    ds_read_b128 a[224:227], v10 offset:0
    ds_read_b128 a[228:231], v10 offset:1024
    ds_read_b128 a[232:235], v10 offset:2048
    ds_read_b128 a[236:239], v10 offset:3072
    v_mov_b32_dpp v24, v24 quad_perm:[0,0,2,2] row_mask:0xf bank_mask:0xf
    v_mov_b32_dpp v26, v26 quad_perm:[0,0,2,2] row_mask:0xf bank_mask:0xf
    v_mov_b32_dpp v28, v28 quad_perm:[0,0,2,2] row_mask:0xf bank_mask:0xf
    v_mov_b32_dpp v30, v30 quad_perm:[0,0,2,2] row_mask:0xf bank_mask:0xf
    v_add_f32_dpp v24, v25, v24 quad_perm:[1,1,3,3] row_mask:0xf bank_mask:0xf
    v_add_f32_dpp v26, v27, v26 quad_perm:[1,1,3,3] row_mask:0xf bank_mask:0xf
    v_add_f32_dpp v28, v29, v28 quad_perm:[1,1,3,3] row_mask:0xf bank_mask:0xf
    v_add_f32_dpp v30, v31, v30 quad_perm:[1,1,3,3] row_mask:0xf bank_mask:0xf
    v_max3_f32 v12, v24, v26, v28
    v_max_f32 v12, v12, v30
    v_cmp_gt_f32 vcc, v12, v36
    s_cbranch_vccnz RS_66
RC_67:
    v_fma_f32 v24, v24, s27, -v37
    v_fma_f32 v26, v26, s27, -v37
    v_fma_f32 v28, v28, s27, -v37
    v_fma_f32 v30, v30, s27, -v37
    v_mfma_f32_16x16x32_bf16 v[48:51], a[192:195], v[16:19], 0
    v_mfma_f32_16x16x32_bf16 v[52:55], a[200:203], v[16:19], 0
    v_exp_f32 v24, v24
    v_exp_f32 v26, v26
    v_mfma_f32_16x16x32_bf16 v[48:51], a[196:199], v[20:23], v[48:51]
    v_exp_f32 v28, v28
    v_exp_f32 v30, v30
    v_mfma_f32_16x16x32_bf16 v[52:55], a[204:207], v[20:23], v[52:55]
    v_cvt_pk_bf16_f32 v13, v24, v24
    v_and_b32 v56, v13, v4
    v_and_b32 v57, v13, v5
    v_and_b32 v58, v13, v6
    v_and_b32 v59, v13, v7
    v_add_f32 v38, v38, v24
    v_cvt_pk_bf16_f32 v13, v26, v26
    v_mfma_f32_16x16x32_bf16 v[32:35], a[240:243], v[56:59], v[32:35]
    v_and_b32 v56, v13, v4
    v_and_b32 v57, v13, v5
    v_and_b32 v58, v13, v6
    v_and_b32 v59, v13, v7
    v_add_f32 v38, v38, v26
    v_cvt_pk_bf16_f32 v13, v28, v28
    v_mfma_f32_16x16x32_bf16 v[32:35], a[244:247], v[56:59], v[32:35]
    v_and_b32 v56, v13, v4
    v_and_b32 v57, v13, v5
    v_and_b32 v58, v13, v6
    v_and_b32 v59, v13, v7
    v_add_f32 v38, v38, v28
    v_cvt_pk_bf16_f32 v13, v30, v30
    v_mfma_f32_16x16x32_bf16 v[32:35], a[248:251], v[56:59], v[32:35]
    v_and_b32 v56, v13, v4
    v_and_b32 v57, v13, v5
    v_and_b32 v58, v13, v6
    v_and_b32 v59, v13, v7
    v_add_f32 v38, v38, v30
    s_nop 0
    v_mfma_f32_16x16x32_bf16 v[32:35], a[252:255], v[56:59], v[32:35]
    s_waitcnt lgkmcnt(0)
    ds_read_b128 a[192:195], v10 offset:8192
    ds_read_b128 a[196:199], v10 offset:9216
    ds_read_b128 a[200:203], v10 offset:10240
    ds_read_b128 a[204:207], v10 offset:11264
    ds_read_b128 a[240:243], v10 offset:4096
    ds_read_b128 a[244:247], v10 offset:5120
    ds_read_b128 a[248:251], v10 offset:6144
    ds_read_b128 a[252:255], v10 offset:7168
    v_mov_b32_dpp v48, v48 quad_perm:[0,0,2,2] row_mask:0xf bank_mask:0xf
    v_mov_b32_dpp v50, v50 quad_perm:[0,0,2,2] row_mask:0xf bank_mask:0xf
    v_mov_b32_dpp v52, v52 quad_perm:[0,0,2,2] row_mask:0xf bank_mask:0xf
    v_mov_b32_dpp v54, v54 quad_perm:[0,0,2,2] row_mask:0xf bank_mask:0xf
    v_add_f32_dpp v48, v49, v48 quad_perm:[1,1,3,3] row_mask:0xf bank_mask:0xf
    v_add_f32_dpp v50, v51, v50 quad_perm:[1,1,3,3] row_mask:0xf bank_mask:0xf
    v_add_f32_dpp v52, v53, v52 quad_perm:[1,1,3,3] row_mask:0xf bank_mask:0xf
    v_add_f32_dpp v54, v55, v54 quad_perm:[1,1,3,3] row_mask:0xf bank_mask:0xf
    v_max3_f32 v12, v48, v50, v52
    v_max_f32 v12, v12, v54
    v_cmp_gt_f32 vcc, v12, v36
    s_cbranch_vccnz RS_68
RC_69:
    v_fma_f32 v48, v48, s27, -v37
    v_fma_f32 v50, v50, s27, -v37
    v_fma_f32 v52, v52, s27, -v37
    v_fma_f32 v54, v54, s27, -v37
    v_mfma_f32_16x16x32_bf16 v[24:27], a[224:227], v[16:19], 0
    v_mfma_f32_16x16x32_bf16 v[28:31], a[232:235], v[16:19], 0
    v_exp_f32 v48, v48
    v_exp_f32 v50, v50
    v_mfma_f32_16x16x32_bf16 v[24:27], a[228:231], v[20:23], v[24:27]
    v_exp_f32 v52, v52
    v_exp_f32 v54, v54
    v_mfma_f32_16x16x32_bf16 v[28:31], a[236:239], v[20:23], v[28:31]
    v_cvt_pk_bf16_f32 v13, v48, v48
    v_and_b32 v56, v13, v4
    v_and_b32 v57, v13, v5
    v_and_b32 v58, v13, v6
    v_and_b32 v59, v13, v7
    v_add_f32 v38, v38, v48
    v_cvt_pk_bf16_f32 v13, v50, v50
    v_mfma_f32_16x16x32_bf16 v[32:35], a[208:211], v[56:59], v[32:35]
    v_and_b32 v56, v13, v4
    v_and_b32 v57, v13, v5
    v_and_b32 v58, v13, v6
    v_and_b32 v59, v13, v7
    v_add_f32 v38, v38, v50
    v_cvt_pk_bf16_f32 v13, v52, v52
    v_mfma_f32_16x16x32_bf16 v[32:35], a[212:215], v[56:59], v[32:35]
    v_and_b32 v56, v13, v4
    v_and_b32 v57, v13, v5
    v_and_b32 v58, v13, v6
    v_and_b32 v59, v13, v7
    v_add_f32 v38, v38, v52
    v_cvt_pk_bf16_f32 v13, v54, v54
    v_mfma_f32_16x16x32_bf16 v[32:35], a[216:219], v[56:59], v[32:35]
    v_and_b32 v56, v13, v4
    v_and_b32 v57, v13, v5
    v_and_b32 v58, v13, v6
    v_and_b32 v59, v13, v7
    v_add_f32 v38, v38, v54
    s_nop 0
    v_mfma_f32_16x16x32_bf16 v[32:35], a[220:223], v[56:59], v[32:35]
    s_waitcnt lgkmcnt(0)
    s_add_u32 s93, s58, 0x4008000
    buffer_load_dwordx4 a[128:131], v1, s[4:7], s93 offen offset:0 nt
    buffer_load_dwordx4 a[132:135], v1, s[4:7], s93 offen offset:128 nt
    buffer_load_dwordx4 a[136:139], v1, s[4:7], s93 offen offset:2048 nt
    buffer_load_dwordx4 a[140:143], v1, s[4:7], s93 offen offset:2176 nt
    buffer_load_dwordx4 a[144:147], v2, s[8:11], s93 offen offset:0 nt
    buffer_load_dwordx4 a[148:151], v2, s[8:11], s93 offen offset:256 nt
    buffer_load_dwordx4 a[152:155], v2, s[8:11], s93 offen offset:2048 nt
    buffer_load_dwordx4 a[156:159], v2, s[8:11], s93 offen offset:2304 nt
    ds_read_b128 a[224:227], v10 offset:16384
    ds_read_b128 a[228:231], v10 offset:17408
    ds_read_b128 a[232:235], v10 offset:18432
    ds_read_b128 a[236:239], v10 offset:19456
    ds_read_b128 a[208:211], v10 offset:12288
    ds_read_b128 a[212:215], v10 offset:13312
    ds_read_b128 a[216:219], v10 offset:14336
    ds_read_b128 a[220:223], v10 offset:15360
    v_mov_b32_dpp v24, v24 quad_perm:[0,0,2,2] row_mask:0xf bank_mask:0xf
    v_mov_b32_dpp v26, v26 quad_perm:[0,0,2,2] row_mask:0xf bank_mask:0xf
    v_mov_b32_dpp v28, v28 quad_perm:[0,0,2,2] row_mask:0xf bank_mask:0xf
    v_mov_b32_dpp v30, v30 quad_perm:[0,0,2,2] row_mask:0xf bank_mask:0xf
    v_add_f32_dpp v24, v25, v24 quad_perm:[1,1,3,3] row_mask:0xf bank_mask:0xf
    v_add_f32_dpp v26, v27, v26 quad_perm:[1,1,3,3] row_mask:0xf bank_mask:0xf
    v_add_f32_dpp v28, v29, v28 quad_perm:[1,1,3,3] row_mask:0xf bank_mask:0xf
    v_add_f32_dpp v30, v31, v30 quad_perm:[1,1,3,3] row_mask:0xf bank_mask:0xf
    v_max3_f32 v12, v24, v26, v28
    v_max_f32 v12, v12, v30
    v_cmp_gt_f32 vcc, v12, v36
    s_cbranch_vccnz RS_70
RC_71:
    v_fma_f32 v24, v24, s27, -v37
    v_fma_f32 v26, v26, s27, -v37
    v_fma_f32 v28, v28, s27, -v37
    v_fma_f32 v30, v30, s27, -v37
    v_mfma_f32_16x16x32_bf16 v[48:51], a[192:195], v[16:19], 0
    v_mfma_f32_16x16x32_bf16 v[52:55], a[200:203], v[16:19], 0
    v_exp_f32 v24, v24
    v_exp_f32 v26, v26
    v_mfma_f32_16x16x32_bf16 v[48:51], a[196:199], v[20:23], v[48:51]
    v_exp_f32 v28, v28
    v_exp_f32 v30, v30
    v_mfma_f32_16x16x32_bf16 v[52:55], a[204:207], v[20:23], v[52:55]
    v_cvt_pk_bf16_f32 v13, v24, v24
    v_and_b32 v56, v13, v4
    v_and_b32 v57, v13, v5
    v_and_b32 v58, v13, v6
    v_and_b32 v59, v13, v7
    v_add_f32 v38, v38, v24
    v_cvt_pk_bf16_f32 v13, v26, v26
    v_mfma_f32_16x16x32_bf16 v[32:35], a[240:243], v[56:59], v[32:35]
    v_and_b32 v56, v13, v4
    v_and_b32 v57, v13, v5
    v_and_b32 v58, v13, v6
    v_and_b32 v59, v13, v7
    v_add_f32 v38, v38, v26
    v_cvt_pk_bf16_f32 v13, v28, v28
    v_mfma_f32_16x16x32_bf16 v[32:35], a[244:247], v[56:59], v[32:35]
    v_and_b32 v56, v13, v4
    v_and_b32 v57, v13, v5
    v_and_b32 v58, v13, v6
    v_and_b32 v59, v13, v7
    v_add_f32 v38, v38, v28
    v_cvt_pk_bf16_f32 v13, v30, v30
    v_mfma_f32_16x16x32_bf16 v[32:35], a[248:251], v[56:59], v[32:35]
    v_and_b32 v56, v13, v4
    v_and_b32 v57, v13, v5
    v_and_b32 v58, v13, v6
    v_and_b32 v59, v13, v7
    v_add_f32 v38, v38, v30
    s_nop 0
    v_mfma_f32_16x16x32_bf16 v[32:35], a[252:255], v[56:59], v[32:35]
    s_waitcnt lgkmcnt(0)
    ds_read_b128 a[192:195], v10 offset:24576
    ds_read_b128 a[196:199], v10 offset:25600
    ds_read_b128 a[200:203], v10 offset:26624
    ds_read_b128 a[204:207], v10 offset:27648
    ds_read_b128 a[240:243], v10 offset:20480
    ds_read_b128 a[244:247], v10 offset:21504
    ds_read_b128 a[248:251], v10 offset:22528
    ds_read_b128 a[252:255], v10 offset:23552
    v_mov_b32_dpp v48, v48 quad_perm:[0,0,2,2] row_mask:0xf bank_mask:0xf
    v_mov_b32_dpp v50, v50 quad_perm:[0,0,2,2] row_mask:0xf bank_mask:0xf
    v_mov_b32_dpp v52, v52 quad_perm:[0,0,2,2] row_mask:0xf bank_mask:0xf
    v_mov_b32_dpp v54, v54 quad_perm:[0,0,2,2] row_mask:0xf bank_mask:0xf
    v_add_f32_dpp v48, v49, v48 quad_perm:[1,1,3,3] row_mask:0xf bank_mask:0xf
    v_add_f32_dpp v50, v51, v50 quad_perm:[1,1,3,3] row_mask:0xf bank_mask:0xf
    v_add_f32_dpp v52, v53, v52 quad_perm:[1,1,3,3] row_mask:0xf bank_mask:0xf
    v_add_f32_dpp v54, v55, v54 quad_perm:[1,1,3,3] row_mask:0xf bank_mask:0xf
    v_max3_f32 v12, v48, v50, v52
    v_max_f32 v12, v12, v54
    v_cmp_gt_f32 vcc, v12, v36
    s_cbranch_vccnz RS_72
RC_73:
    v_fma_f32 v48, v48, s27, -v37
    v_fma_f32 v50, v50, s27, -v37
    v_fma_f32 v52, v52, s27, -v37
    v_fma_f32 v54, v54, s27, -v37
    v_mfma_f32_16x16x32_bf16 v[24:27], a[224:227], v[16:19], 0
    v_mfma_f32_16x16x32_bf16 v[28:31], a[232:235], v[16:19], 0
    v_exp_f32 v48, v48
    v_exp_f32 v50, v50
    v_mfma_f32_16x16x32_bf16 v[24:27], a[228:231], v[20:23], v[24:27]
    v_exp_f32 v52, v52
    v_exp_f32 v54, v54
    v_mfma_f32_16x16x32_bf16 v[28:31], a[236:239], v[20:23], v[28:31]
    v_cvt_pk_bf16_f32 v13, v48, v48
    v_and_b32 v56, v13, v4
    v_and_b32 v57, v13, v5
    v_and_b32 v58, v13, v6
    v_and_b32 v59, v13, v7
    v_add_f32 v38, v38, v48
    v_cvt_pk_bf16_f32 v13, v50, v50
    v_mfma_f32_16x16x32_bf16 v[32:35], a[208:211], v[56:59], v[32:35]
    v_and_b32 v56, v13, v4
    v_and_b32 v57, v13, v5
    v_and_b32 v58, v13, v6
    v_and_b32 v59, v13, v7
    v_add_f32 v38, v38, v50
    v_cvt_pk_bf16_f32 v13, v52, v52
    v_mfma_f32_16x16x32_bf16 v[32:35], a[212:215], v[56:59], v[32:35]
    v_and_b32 v56, v13, v4
    v_and_b32 v57, v13, v5
    v_and_b32 v58, v13, v6
    v_and_b32 v59, v13, v7
    v_add_f32 v38, v38, v52
    v_cvt_pk_bf16_f32 v13, v54, v54
    v_mfma_f32_16x16x32_bf16 v[32:35], a[216:219], v[56:59], v[32:35]
    v_and_b32 v56, v13, v4
    v_and_b32 v57, v13, v5
    v_and_b32 v58, v13, v6
    v_and_b32 v59, v13, v7
    v_add_f32 v38, v38, v54
    s_nop 0
    v_mfma_f32_16x16x32_bf16 v[32:35], a[220:223], v[56:59], v[32:35]
    s_waitcnt lgkmcnt(0)
    ds_read_b128 a[224:227], v10 offset:32768
    ds_read_b128 a[228:231], v10 offset:33792
    ds_read_b128 a[232:235], v10 offset:34816
    ds_read_b128 a[236:239], v10 offset:35840
    ds_read_b128 a[208:211], v10 offset:28672
    ds_read_b128 a[212:215], v10 offset:29696
    ds_read_b128 a[216:219], v10 offset:30720
    ds_read_b128 a[220:223], v10 offset:31744
    v_mov_b32_dpp v24, v24 quad_perm:[0,0,2,2] row_mask:0xf bank_mask:0xf
    v_mov_b32_dpp v26, v26 quad_perm:[0,0,2,2] row_mask:0xf bank_mask:0xf
    v_mov_b32_dpp v28, v28 quad_perm:[0,0,2,2] row_mask:0xf bank_mask:0xf
    v_mov_b32_dpp v30, v30 quad_perm:[0,0,2,2] row_mask:0xf bank_mask:0xf
    v_add_f32_dpp v24, v25, v24 quad_perm:[1,1,3,3] row_mask:0xf bank_mask:0xf
    v_add_f32_dpp v26, v27, v26 quad_perm:[1,1,3,3] row_mask:0xf bank_mask:0xf
    v_add_f32_dpp v28, v29, v28 quad_perm:[1,1,3,3] row_mask:0xf bank_mask:0xf
    v_add_f32_dpp v30, v31, v30 quad_perm:[1,1,3,3] row_mask:0xf bank_mask:0xf
    v_max3_f32 v12, v24, v26, v28
    v_max_f32 v12, v12, v30
    v_cmp_gt_f32 vcc, v12, v36
    s_cbranch_vccnz RS_74
RC_75:
    v_fma_f32 v24, v24, s27, -v37
    v_fma_f32 v26, v26, s27, -v37
    v_fma_f32 v28, v28, s27, -v37
    v_fma_f32 v30, v30, s27, -v37
    v_mfma_f32_16x16x32_bf16 v[48:51], a[192:195], v[16:19], 0
    v_mfma_f32_16x16x32_bf16 v[52:55], a[200:203], v[16:19], 0
    v_exp_f32 v24, v24
    v_exp_f32 v26, v26
    v_mfma_f32_16x16x32_bf16 v[48:51], a[196:199], v[20:23], v[48:51]
    v_exp_f32 v28, v28
    v_exp_f32 v30, v30
    v_mfma_f32_16x16x32_bf16 v[52:55], a[204:207], v[20:23], v[52:55]
    v_cvt_pk_bf16_f32 v13, v24, v24
    v_and_b32 v56, v13, v4
    v_and_b32 v57, v13, v5
    v_and_b32 v58, v13, v6
    v_and_b32 v59, v13, v7
    v_add_f32 v38, v38, v24
    v_cvt_pk_bf16_f32 v13, v26, v26
    v_mfma_f32_16x16x32_bf16 v[32:35], a[240:243], v[56:59], v[32:35]
    v_and_b32 v56, v13, v4
    v_and_b32 v57, v13, v5
    v_and_b32 v58, v13, v6
    v_and_b32 v59, v13, v7
    v_add_f32 v38, v38, v26
    v_cvt_pk_bf16_f32 v13, v28, v28
    v_mfma_f32_16x16x32_bf16 v[32:35], a[244:247], v[56:59], v[32:35]
    v_and_b32 v56, v13, v4
    v_and_b32 v57, v13, v5
    v_and_b32 v58, v13, v6
    v_and_b32 v59, v13, v7
    v_add_f32 v38, v38, v28
    v_cvt_pk_bf16_f32 v13, v30, v30
    v_mfma_f32_16x16x32_bf16 v[32:35], a[248:251], v[56:59], v[32:35]
    v_and_b32 v56, v13, v4
    v_and_b32 v57, v13, v5
    v_and_b32 v58, v13, v6
    v_and_b32 v59, v13, v7
    v_add_f32 v38, v38, v30
    s_nop 0
    v_mfma_f32_16x16x32_bf16 v[32:35], a[252:255], v[56:59], v[32:35]
    s_waitcnt lgkmcnt(0)
    v_mov_b32_dpp v48, v48 quad_perm:[0,0,2,2] row_mask:0xf bank_mask:0xf
    v_mov_b32_dpp v50, v50 quad_perm:[0,0,2,2] row_mask:0xf bank_mask:0xf
    v_mov_b32_dpp v52, v52 quad_perm:[0,0,2,2] row_mask:0xf bank_mask:0xf
    v_mov_b32_dpp v54, v54 quad_perm:[0,0,2,2] row_mask:0xf bank_mask:0xf
    v_add_f32_dpp v48, v49, v48 quad_perm:[1,1,3,3] row_mask:0xf bank_mask:0xf
    v_add_f32_dpp v50, v51, v50 quad_perm:[1,1,3,3] row_mask:0xf bank_mask:0xf
    v_add_f32_dpp v52, v53, v52 quad_perm:[1,1,3,3] row_mask:0xf bank_mask:0xf
    v_add_f32_dpp v54, v55, v54 quad_perm:[1,1,3,3] row_mask:0xf bank_mask:0xf
    v_max3_f32 v12, v48, v50, v52
    v_max_f32 v12, v12, v54
    v_cmp_gt_f32 vcc, v12, v36
    s_cbranch_vccnz RS_76
RC_77:
    v_fma_f32 v48, v48, s27, -v37
    v_fma_f32 v50, v50, s27, -v37
    v_fma_f32 v52, v52, s27, -v37
    v_fma_f32 v54, v54, s27, -v37
    v_mfma_f32_16x16x32_bf16 v[24:27], a[224:227], v[16:19], 0
    v_mfma_f32_16x16x32_bf16 v[28:31], a[232:235], v[16:19], 0
    v_exp_f32 v48, v48
    v_exp_f32 v50, v50
    v_mfma_f32_16x16x32_bf16 v[24:27], a[228:231], v[20:23], v[24:27]
    v_exp_f32 v52, v52
    v_exp_f32 v54, v54
    v_mfma_f32_16x16x32_bf16 v[28:31], a[236:239], v[20:23], v[28:31]
    v_cvt_pk_bf16_f32 v13, v48, v48
    v_and_b32 v56, v13, v4
    v_and_b32 v57, v13, v5
    v_and_b32 v58, v13, v6
    v_and_b32 v59, v13, v7
    v_add_f32 v38, v38, v48
    v_cvt_pk_bf16_f32 v13, v50, v50
    v_mfma_f32_16x16x32_bf16 v[32:35], a[208:211], v[56:59], v[32:35]
    v_and_b32 v56, v13, v4
    v_and_b32 v57, v13, v5
    v_and_b32 v58, v13, v6
    v_and_b32 v59, v13, v7
    v_add_f32 v38, v38, v50
    s_add_u32 s91, s58, 0x400c000
    s_add_u32 m0, s71, 0
    s_nop 0
    buffer_load_dwordx4 v1, s[4:7], s91 offen offset:0 nt lds
    s_add_u32 m0, s71, 896
    s_nop 0
    buffer_load_dwordx4 v1, s[4:7], s91 offen offset:128 nt lds
    s_add_u32 m0, s71, 0
    s_nop 0
    buffer_load_dwordx4 v1, s[4:7], s91 offen offset:2048 nt lds
    s_add_u32 m0, s71, 896
    s_nop 0
    buffer_load_dwordx4 v1, s[4:7], s91 offen offset:2176 nt lds
    s_add_u32 m0, s71, 4096
    s_nop 0
    buffer_load_dwordx4 v2, s[8:11], s91 offen offset:0 nt lds
    s_add_u32 m0, s71, 4864
    s_nop 0
    buffer_load_dwordx4 v2, s[8:11], s91 offen offset:256 nt lds
    s_add_u32 m0, s71, 4096
    s_nop 0
    buffer_load_dwordx4 v2, s[8:11], s91 offen offset:2048 nt lds
    s_add_u32 m0, s71, 4864
    s_nop 0
    buffer_load_dwordx4 v2, s[8:11], s91 offen offset:2304 nt lds
    v_cvt_pk_bf16_f32 v13, v52, v52
    v_mfma_f32_16x16x32_bf16 v[32:35], a[212:215], v[56:59], v[32:35]
    v_and_b32 v56, v13, v4
    v_and_b32 v57, v13, v5
    v_and_b32 v58, v13, v6
    v_and_b32 v59, v13, v7
    v_add_f32 v38, v38, v52
    v_cvt_pk_bf16_f32 v13, v54, v54
    v_mfma_f32_16x16x32_bf16 v[32:35], a[216:219], v[56:59], v[32:35]
    v_and_b32 v56, v13, v4
    v_and_b32 v57, v13, v5
    v_and_b32 v58, v13, v6
    v_and_b32 v59, v13, v7
    v_add_f32 v38, v38, v54
    s_nop 0
    v_mfma_f32_16x16x32_bf16 v[32:35], a[220:223], v[56:59], v[32:35]
    v_mov_b32_dpp v24, v24 quad_perm:[0,0,2,2] row_mask:0xf bank_mask:0xf
    v_mov_b32_dpp v26, v26 quad_perm:[0,0,2,2] row_mask:0xf bank_mask:0xf
    v_mov_b32_dpp v28, v28 quad_perm:[0,0,2,2] row_mask:0xf bank_mask:0xf
    v_mov_b32_dpp v30, v30 quad_perm:[0,0,2,2] row_mask:0xf bank_mask:0xf
    v_add_f32_dpp v24, v25, v24 quad_perm:[1,1,3,3] row_mask:0xf bank_mask:0xf
    v_add_f32_dpp v26, v27, v26 quad_perm:[1,1,3,3] row_mask:0xf bank_mask:0xf
    v_add_f32_dpp v28, v29, v28 quad_perm:[1,1,3,3] row_mask:0xf bank_mask:0xf
    v_add_f32_dpp v30, v31, v30 quad_perm:[1,1,3,3] row_mask:0xf bank_mask:0xf
    v_max3_f32 v12, v24, v26, v28
    v_max_f32 v12, v12, v30
    v_cmp_gt_f32 vcc, v12, v36
    s_cbranch_vccnz RS_78
RC_79:
    v_fma_f32 v24, v24, s27, -v37
    v_fma_f32 v26, v26, s27, -v37
    v_fma_f32 v28, v28, s27, -v37
    v_fma_f32 v30, v30, s27, -v37
    v_mfma_f32_16x16x32_bf16 v[48:51], a[64:67], v[16:19], 0
    v_mfma_f32_16x16x32_bf16 v[52:55], a[72:75], v[16:19], 0
    v_exp_f32 v24, v24
    v_exp_f32 v26, v26
    v_mfma_f32_16x16x32_bf16 v[48:51], a[68:71], v[20:23], v[48:51]
    v_exp_f32 v28, v28
    v_exp_f32 v30, v30
    v_mfma_f32_16x16x32_bf16 v[52:55], a[76:79], v[20:23], v[52:55]
    v_cvt_pk_bf16_f32 v13, v24, v24
    v_and_b32 v56, v13, v4
    v_and_b32 v57, v13, v5
    v_and_b32 v58, v13, v6
    v_and_b32 v59, v13, v7
    v_add_f32 v38, v38, v24
    v_cvt_pk_bf16_f32 v13, v26, v26
    v_mfma_f32_16x16x32_bf16 v[32:35], v[240:243], v[56:59], v[32:35]
    v_and_b32 v56, v13, v4
    v_and_b32 v57, v13, v5
    v_and_b32 v58, v13, v6
    v_and_b32 v59, v13, v7
    v_add_f32 v38, v38, v26
    v_cvt_pk_bf16_f32 v13, v28, v28
    v_mfma_f32_16x16x32_bf16 v[32:35], v[244:247], v[56:59], v[32:35]
    v_and_b32 v56, v13, v4
    v_and_b32 v57, v13, v5
    v_and_b32 v58, v13, v6
    v_and_b32 v59, v13, v7
    v_add_f32 v38, v38, v28
    v_cvt_pk_bf16_f32 v13, v30, v30
    v_mfma_f32_16x16x32_bf16 v[32:35], v[248:251], v[56:59], v[32:35]
    v_and_b32 v56, v13, v4
    v_and_b32 v57, v13, v5
    v_and_b32 v58, v13, v6
    v_and_b32 v59, v13, v7
    v_add_f32 v38, v38, v30
    s_nop 0
    v_mfma_f32_16x16x32_bf16 v[32:35], v[252:255], v[56:59], v[32:35]
    v_mov_b32_dpp v48, v48 quad_perm:[0,0,2,2] row_mask:0xf bank_mask:0xf
    v_mov_b32_dpp v50, v50 quad_perm:[0,0,2,2] row_mask:0xf bank_mask:0xf
    v_mov_b32_dpp v52, v52 quad_perm:[0,0,2,2] row_mask:0xf bank_mask:0xf
    v_mov_b32_dpp v54, v54 quad_perm:[0,0,2,2] row_mask:0xf bank_mask:0xf
    v_add_f32_dpp v48, v49, v48 quad_perm:[1,1,3,3] row_mask:0xf bank_mask:0xf
    v_add_f32_dpp v50, v51, v50 quad_perm:[1,1,3,3] row_mask:0xf bank_mask:0xf
    v_add_f32_dpp v52, v53, v52 quad_perm:[1,1,3,3] row_mask:0xf bank_mask:0xf
    v_add_f32_dpp v54, v55, v54 quad_perm:[1,1,3,3] row_mask:0xf bank_mask:0xf
    v_max3_f32 v12, v48, v50, v52
    v_max_f32 v12, v12, v54
    v_cmp_gt_f32 vcc, v12, v36
    s_cbranch_vccnz RS_80
RC_81:
    v_fma_f32 v48, v48, s27, -v37
    v_fma_f32 v50, v50, s27, -v37
    v_fma_f32 v52, v52, s27, -v37
    v_fma_f32 v54, v54, s27, -v37
    v_mfma_f32_16x16x32_bf16 v[24:27], a[32:35], v[16:19], 0
    v_mfma_f32_16x16x32_bf16 v[28:31], a[40:43], v[16:19], 0
    v_exp_f32 v48, v48
    v_exp_f32 v50, v50
    v_mfma_f32_16x16x32_bf16 v[24:27], a[36:39], v[20:23], v[24:27]
    v_exp_f32 v52, v52
    v_exp_f32 v54, v54
    v_mfma_f32_16x16x32_bf16 v[28:31], a[44:47], v[20:23], v[28:31]
    v_cvt_pk_bf16_f32 v13, v48, v48
    v_and_b32 v56, v13, v4
    v_and_b32 v57, v13, v5
    v_and_b32 v58, v13, v6
    v_and_b32 v59, v13, v7
    v_add_f32 v38, v38, v48
    v_cvt_pk_bf16_f32 v13, v50, v50
    v_mfma_f32_16x16x32_bf16 v[32:35], a[80:83], v[56:59], v[32:35]
    v_and_b32 v56, v13, v4
    v_and_b32 v57, v13, v5
    v_and_b32 v58, v13, v6
    v_and_b32 v59, v13, v7
    v_add_f32 v38, v38, v50
    v_cvt_pk_bf16_f32 v13, v52, v52
    v_mfma_f32_16x16x32_bf16 v[32:35], a[84:87], v[56:59], v[32:35]
    v_and_b32 v56, v13, v4
    v_and_b32 v57, v13, v5
    v_and_b32 v58, v13, v6
    v_and_b32 v59, v13, v7
    v_add_f32 v38, v38, v52
    v_cvt_pk_bf16_f32 v13, v54, v54
    v_mfma_f32_16x16x32_bf16 v[32:35], a[88:91], v[56:59], v[32:35]
    v_and_b32 v56, v13, v4
    v_and_b32 v57, v13, v5
    v_and_b32 v58, v13, v6
    v_and_b32 v59, v13, v7
    v_add_f32 v38, v38, v54
    s_nop 0
    v_mfma_f32_16x16x32_bf16 v[32:35], a[92:95], v[56:59], v[32:35]
    v_mov_b32_dpp v24, v24 quad_perm:[0,0,2,2] row_mask:0xf bank_mask:0xf
    v_mov_b32_dpp v26, v26 quad_perm:[0,0,2,2] row_mask:0xf bank_mask:0xf
    v_mov_b32_dpp v28, v28 quad_perm:[0,0,2,2] row_mask:0xf bank_mask:0xf
    v_mov_b32_dpp v30, v30 quad_perm:[0,0,2,2] row_mask:0xf bank_mask:0xf
    v_add_f32_dpp v24, v25, v24 quad_perm:[1,1,3,3] row_mask:0xf bank_mask:0xf
    v_add_f32_dpp v26, v27, v26 quad_perm:[1,1,3,3] row_mask:0xf bank_mask:0xf
    v_add_f32_dpp v28, v29, v28 quad_perm:[1,1,3,3] row_mask:0xf bank_mask:0xf
    v_add_f32_dpp v30, v31, v30 quad_perm:[1,1,3,3] row_mask:0xf bank_mask:0xf
    v_max3_f32 v12, v24, v26, v28
    v_max_f32 v12, v12, v30
    v_cmp_gt_f32 vcc, v12, v36
    s_cbranch_vccnz RS_82
RC_83:
    v_fma_f32 v24, v24, s27, -v37
    v_fma_f32 v26, v26, s27, -v37
    v_fma_f32 v28, v28, s27, -v37
    v_fma_f32 v30, v30, s27, -v37
    v_mfma_f32_16x16x32_bf16 v[48:51], a[0:3], v[16:19], 0
    v_mfma_f32_16x16x32_bf16 v[52:55], a[8:11], v[16:19], 0
    v_exp_f32 v24, v24
    v_exp_f32 v26, v26
    v_mfma_f32_16x16x32_bf16 v[48:51], a[4:7], v[20:23], v[48:51]
    v_exp_f32 v28, v28
    v_exp_f32 v30, v30
    v_mfma_f32_16x16x32_bf16 v[52:55], a[12:15], v[20:23], v[52:55]
    v_cvt_pk_bf16_f32 v13, v24, v24
    v_and_b32 v56, v13, v4
    v_and_b32 v57, v13, v5
    v_and_b32 v58, v13, v6
    v_and_b32 v59, v13, v7
    v_add_f32 v38, v38, v24
    v_cvt_pk_bf16_f32 v13, v26, v26
    v_mfma_f32_16x16x32_bf16 v[32:35], a[48:51], v[56:59], v[32:35]
    v_and_b32 v56, v13, v4
    v_and_b32 v57, v13, v5
    v_and_b32 v58, v13, v6
    v_and_b32 v59, v13, v7
    v_add_f32 v38, v38, v26
    v_cvt_pk_bf16_f32 v13, v28, v28
    v_mfma_f32_16x16x32_bf16 v[32:35], a[52:55], v[56:59], v[32:35]
    v_and_b32 v56, v13, v4
    v_and_b32 v57, v13, v5
    v_and_b32 v58, v13, v6
    v_and_b32 v59, v13, v7
    v_add_f32 v38, v38, v28
    v_cvt_pk_bf16_f32 v13, v30, v30
    v_mfma_f32_16x16x32_bf16 v[32:35], a[56:59], v[56:59], v[32:35]
    v_and_b32 v56, v13, v4
    v_and_b32 v57, v13, v5
    v_and_b32 v58, v13, v6
    v_and_b32 v59, v13, v7
    v_add_f32 v38, v38, v30
    s_nop 0
    v_mfma_f32_16x16x32_bf16 v[32:35], a[60:63], v[56:59], v[32:35]
    v_mov_b32_dpp v48, v48 quad_perm:[0,0,2,2] row_mask:0xf bank_mask:0xf
    v_mov_b32_dpp v50, v50 quad_perm:[0,0,2,2] row_mask:0xf bank_mask:0xf
    v_mov_b32_dpp v52, v52 quad_perm:[0,0,2,2] row_mask:0xf bank_mask:0xf
    v_mov_b32_dpp v54, v54 quad_perm:[0,0,2,2] row_mask:0xf bank_mask:0xf
    v_add_f32_dpp v48, v49, v48 quad_perm:[1,1,3,3] row_mask:0xf bank_mask:0xf
    v_add_f32_dpp v50, v51, v50 quad_perm:[1,1,3,3] row_mask:0xf bank_mask:0xf
    v_add_f32_dpp v52, v53, v52 quad_perm:[1,1,3,3] row_mask:0xf bank_mask:0xf
    v_add_f32_dpp v54, v55, v54 quad_perm:[1,1,3,3] row_mask:0xf bank_mask:0xf
    v_max3_f32 v12, v48, v50, v52
    v_max_f32 v12, v12, v54
    v_cmp_gt_f32 vcc, v12, v36
    s_cbranch_vccnz RS_84
RC_85:
    v_fma_f32 v48, v48, s27, -v37
    s_add_u32 s92, s58, 0x4010000
    s_add_u32 m0, s71, 8192
    s_nop 0
    buffer_load_dwordx4 v1, s[4:7], s92 offen offset:0 nt lds
    s_add_u32 m0, s71, 9088
    s_nop 0
    buffer_load_dwordx4 v1, s[4:7], s92 offen offset:128 nt lds
    s_add_u32 m0, s71, 8192
    s_nop 0
    buffer_load_dwordx4 v1, s[4:7], s92 offen offset:2048 nt lds
    s_add_u32 m0, s71, 9088
    s_nop 0
    buffer_load_dwordx4 v1, s[4:7], s92 offen offset:2176 nt lds
    s_add_u32 m0, s71, 12288
    s_nop 0
    buffer_load_dwordx4 v2, s[8:11], s92 offen offset:0 nt lds
    s_add_u32 m0, s71, 13056
    s_nop 0
    buffer_load_dwordx4 v2, s[8:11], s92 offen offset:256 nt lds
    s_add_u32 m0, s71, 12288
    s_nop 0
    buffer_load_dwordx4 v2, s[8:11], s92 offen offset:2048 nt lds
    s_add_u32 m0, s71, 13056
    s_nop 0
    buffer_load_dwordx4 v2, s[8:11], s92 offen offset:2304 nt lds
    v_fma_f32 v50, v50, s27, -v37
    v_fma_f32 v52, v52, s27, -v37
    v_fma_f32 v54, v54, s27, -v37
    v_mfma_f32_16x16x32_bf16 v[24:27], v[176:179], v[16:19], 0
    v_mfma_f32_16x16x32_bf16 v[28:31], v[184:187], v[16:19], 0
    v_exp_f32 v48, v48
    v_exp_f32 v50, v50
    v_mfma_f32_16x16x32_bf16 v[24:27], v[180:183], v[20:23], v[24:27]
    v_exp_f32 v52, v52
    v_exp_f32 v54, v54
    v_mfma_f32_16x16x32_bf16 v[28:31], v[188:191], v[20:23], v[28:31]
    v_cvt_pk_bf16_f32 v13, v48, v48
    v_and_b32 v56, v13, v4
    v_and_b32 v57, v13, v5
    v_and_b32 v58, v13, v6
    v_and_b32 v59, v13, v7
    v_add_f32 v38, v38, v48
    v_cvt_pk_bf16_f32 v13, v50, v50
    v_mfma_f32_16x16x32_bf16 v[32:35], a[16:19], v[56:59], v[32:35]
    v_and_b32 v56, v13, v4
    v_and_b32 v57, v13, v5
    v_and_b32 v58, v13, v6
    v_and_b32 v59, v13, v7
    v_add_f32 v38, v38, v50
    v_cvt_pk_bf16_f32 v13, v52, v52
    v_mfma_f32_16x16x32_bf16 v[32:35], a[20:23], v[56:59], v[32:35]
    v_and_b32 v56, v13, v4
    v_and_b32 v57, v13, v5
    v_and_b32 v58, v13, v6
    v_and_b32 v59, v13, v7
    v_add_f32 v38, v38, v52
    v_cvt_pk_bf16_f32 v13, v54, v54
    v_mfma_f32_16x16x32_bf16 v[32:35], a[24:27], v[56:59], v[32:35]
    v_and_b32 v56, v13, v4
    v_and_b32 v57, v13, v5
    v_and_b32 v58, v13, v6
    v_and_b32 v59, v13, v7
    v_add_f32 v38, v38, v54
    s_nop 0
    v_mfma_f32_16x16x32_bf16 v[32:35], a[28:31], v[56:59], v[32:35]
    v_mov_b32_dpp v24, v24 quad_perm:[0,0,2,2] row_mask:0xf bank_mask:0xf
    v_mov_b32_dpp v26, v26 quad_perm:[0,0,2,2] row_mask:0xf bank_mask:0xf
    v_mov_b32_dpp v28, v28 quad_perm:[0,0,2,2] row_mask:0xf bank_mask:0xf
    v_mov_b32_dpp v30, v30 quad_perm:[0,0,2,2] row_mask:0xf bank_mask:0xf
    v_add_f32_dpp v24, v25, v24 quad_perm:[1,1,3,3] row_mask:0xf bank_mask:0xf
    v_add_f32_dpp v26, v27, v26 quad_perm:[1,1,3,3] row_mask:0xf bank_mask:0xf
    v_add_f32_dpp v28, v29, v28 quad_perm:[1,1,3,3] row_mask:0xf bank_mask:0xf
    v_add_f32_dpp v30, v31, v30 quad_perm:[1,1,3,3] row_mask:0xf bank_mask:0xf
    v_max3_f32 v12, v24, v26, v28
    v_max_f32 v12, v12, v30
    v_cmp_gt_f32 vcc, v12, v36
    s_cbranch_vccnz RS_86
RC_87:
    v_fma_f32 v24, v24, s27, -v37
    v_fma_f32 v26, v26, s27, -v37
    v_fma_f32 v28, v28, s27, -v37
    v_fma_f32 v30, v30, s27, -v37
    v_mfma_f32_16x16x32_bf16 v[48:51], v[208:211], v[16:19], 0
    v_mfma_f32_16x16x32_bf16 v[52:55], v[216:219], v[16:19], 0
    v_exp_f32 v24, v24
    v_exp_f32 v26, v26
    v_mfma_f32_16x16x32_bf16 v[48:51], v[212:215], v[20:23], v[48:51]
    v_exp_f32 v28, v28
    v_exp_f32 v30, v30
    v_mfma_f32_16x16x32_bf16 v[52:55], v[220:223], v[20:23], v[52:55]
    v_cvt_pk_bf16_f32 v13, v24, v24
    v_and_b32 v56, v13, v4
    v_and_b32 v57, v13, v5
    v_and_b32 v58, v13, v6
    v_and_b32 v59, v13, v7
    v_add_f32 v38, v38, v24
    v_cvt_pk_bf16_f32 v13, v26, v26
    v_mfma_f32_16x16x32_bf16 v[32:35], v[192:195], v[56:59], v[32:35]
    v_and_b32 v56, v13, v4
    v_and_b32 v57, v13, v5
    v_and_b32 v58, v13, v6
    v_and_b32 v59, v13, v7
    v_add_f32 v38, v38, v26
    v_cvt_pk_bf16_f32 v13, v28, v28
    v_mfma_f32_16x16x32_bf16 v[32:35], v[196:199], v[56:59], v[32:35]
    v_and_b32 v56, v13, v4
    v_and_b32 v57, v13, v5
    v_and_b32 v58, v13, v6
    v_and_b32 v59, v13, v7
    v_add_f32 v38, v38, v28
    v_cvt_pk_bf16_f32 v13, v30, v30
    v_mfma_f32_16x16x32_bf16 v[32:35], v[200:203], v[56:59], v[32:35]
    v_and_b32 v56, v13, v4
    v_and_b32 v57, v13, v5
    v_and_b32 v58, v13, v6
    v_and_b32 v59, v13, v7
    v_add_f32 v38, v38, v30
    s_nop 0
    v_mfma_f32_16x16x32_bf16 v[32:35], v[204:207], v[56:59], v[32:35]
    v_mov_b32_dpp v48, v48 quad_perm:[0,0,2,2] row_mask:0xf bank_mask:0xf
    v_mov_b32_dpp v50, v50 quad_perm:[0,0,2,2] row_mask:0xf bank_mask:0xf
    v_mov_b32_dpp v52, v52 quad_perm:[0,0,2,2] row_mask:0xf bank_mask:0xf
    v_mov_b32_dpp v54, v54 quad_perm:[0,0,2,2] row_mask:0xf bank_mask:0xf
    v_add_f32_dpp v48, v49, v48 quad_perm:[1,1,3,3] row_mask:0xf bank_mask:0xf
    v_add_f32_dpp v50, v51, v50 quad_perm:[1,1,3,3] row_mask:0xf bank_mask:0xf
    v_add_f32_dpp v52, v53, v52 quad_perm:[1,1,3,3] row_mask:0xf bank_mask:0xf
    v_add_f32_dpp v54, v55, v54 quad_perm:[1,1,3,3] row_mask:0xf bank_mask:0xf
    v_max3_f32 v12, v48, v50, v52
    v_max_f32 v12, v12, v54
    v_cmp_gt_f32 vcc, v12, v36
    s_cbranch_vccnz RS_88
RC_89:
    v_fma_f32 v48, v48, s27, -v37
    v_fma_f32 v50, v50, s27, -v37
    v_fma_f32 v52, v52, s27, -v37
    v_fma_f32 v54, v54, s27, -v37
    v_exp_f32 v48, v48
    v_exp_f32 v50, v50
    v_exp_f32 v52, v52
    v_exp_f32 v54, v54
    v_cvt_pk_bf16_f32 v13, v48, v48
    v_and_b32 v56, v13, v4
    v_and_b32 v57, v13, v5
    v_and_b32 v58, v13, v6
    v_and_b32 v59, v13, v7
    v_add_f32 v38, v38, v48
    v_cvt_pk_bf16_f32 v13, v50, v50
    v_mfma_f32_16x16x32_bf16 v[32:35], v[224:227], v[56:59], v[32:35]
    v_and_b32 v56, v13, v4
    v_and_b32 v57, v13, v5
    v_and_b32 v58, v13, v6
    v_and_b32 v59, v13, v7
    v_add_f32 v38, v38, v50
    v_cvt_pk_bf16_f32 v13, v52, v52
    v_mfma_f32_16x16x32_bf16 v[32:35], v[228:231], v[56:59], v[32:35]
    v_and_b32 v56, v13, v4
    v_and_b32 v57, v13, v5
    v_and_b32 v58, v13, v6
    v_and_b32 v59, v13, v7
    v_add_f32 v38, v38, v52
    v_cvt_pk_bf16_f32 v13, v54, v54
    v_mfma_f32_16x16x32_bf16 v[32:35], v[232:235], v[56:59], v[32:35]
    v_and_b32 v56, v13, v4
    v_and_b32 v57, v13, v5
    v_and_b32 v58, v13, v6
    v_and_b32 v59, v13, v7
    v_add_f32 v38, v38, v54
    s_nop 0
    v_mfma_f32_16x16x32_bf16 v[32:35], v[236:239], v[56:59], v[32:35]
    s_waitcnt vmcnt(32)
    s_call_b64 s[30:31], U_v80_v96
    s_add_u32 s93, s58, 0x4014000
    s_add_u32 m0, s71, 16384
    s_nop 0
    buffer_load_dwordx4 v1, s[4:7], s93 offen offset:0 nt lds
    s_add_u32 m0, s71, 17280
    s_nop 0
    buffer_load_dwordx4 v1, s[4:7], s93 offen offset:128 nt lds
    s_add_u32 m0, s71, 16384
    s_nop 0
    buffer_load_dwordx4 v1, s[4:7], s93 offen offset:2048 nt lds
    s_add_u32 m0, s71, 17280
    s_nop 0
    buffer_load_dwordx4 v1, s[4:7], s93 offen offset:2176 nt lds
    s_add_u32 m0, s71, 20480
    s_nop 0
    buffer_load_dwordx4 v2, s[8:11], s93 offen offset:0 nt lds
    s_add_u32 m0, s71, 21248
    s_nop 0
    buffer_load_dwordx4 v2, s[8:11], s93 offen offset:256 nt lds
    s_add_u32 m0, s71, 20480
    s_nop 0
    buffer_load_dwordx4 v2, s[8:11], s93 offen offset:2048 nt lds
    s_add_u32 m0, s71, 21248
    s_nop 0
    buffer_load_dwordx4 v2, s[8:11], s93 offen offset:2304 nt lds
    v_lshrrev_b32 v104, 4, v0
    v_lshrrev_b32 v106, 3, v0
    v_lshlrev_b32 v109, 2, v106
    v_mul_u32_u24 v106, 4608, v106
    v_and_b32 v105, 7, v0
    v_lshl_add_u32 v106, v105, 4, v106
    s_add_u32 s29, s80, 0
    buffer_load_dwordx4 v[112:115], v106, s[20:23], s29 offen
    s_add_u32 s29, s80, 36864
    buffer_load_dwordx4 v[116:119], v106, s[20:23], s29 offen
    s_add_u32 s29, s80, 1152
    buffer_load_dwordx4 v[120:123], v106, s[20:23], s29 offen
    s_add_u32 s29, s80, 38016
    buffer_load_dwordx4 v[124:127], v106, s[20:23], s29 offen
    s_add_u32 s29, s80, 2304
    buffer_load_dwordx4 v[128:131], v106, s[20:23], s29 offen
    s_add_u32 s29, s80, 39168
    buffer_load_dwordx4 v[132:135], v106, s[20:23], s29 offen
    s_add_u32 s29, s80, 3456
    buffer_load_dwordx4 v[136:139], v106, s[20:23], s29 offen
    s_add_u32 s29, s80, 40320
    buffer_load_dwordx4 v[140:143], v106, s[20:23], s29 offen
    v_lshl_add_u32 v110, v104, 5, v105
    s_lshl_b32 s29, s24, 7
    v_add_lshl_u32 v110, v110, s29, 2
    v_lshl_add_u32 v111, v104, 9, v2
    v_bfe_u32 v105, v0, 2, 2
    v_add_u32 v105, v105, v104
    v_and_b32 v105, 3, v105
    v_and_b32 v107, 3, v0
    v_lshl_add_u32 v105, v107, 2, v105
    v_lshlrev_b32 v108, 3, v105
    s_mov_b32 s81, 2
    s_mov_b32 s82, 0
    s_mov_b32 s83, 9216
    s_mov_b32 s84, 0x20000
    s_mov_b32 s85, 14848
    s_mov_b32 s101, 13824
    v_mov_b32 v12, v38
    s_nop 1
    v_permlane16_swap_b32 v38, v12
    v_add_f32 v38, v38, v12
    v_mov_b32 v12, v38
    s_nop 1
    v_permlane32_swap_b32 v38, v12
    v_add_f32 v38, v38, v12
    s_lshl_b32 s29, s24, 10
    v_add_u32 v12, s29, v8
    s_lshl_b32 s29, s24, 3
    v_bfe_u32 v13, v0, 3, 1
    v_lshl_add_u32 v13, v13, 5, s29
    v_mov_b32 v14, v37
    v_mov_b32 v15, v38
    ds_write_b128 v12, v[32:35] offset:2304
    ds_write_b64 v13, v[14:15] offset:6400
    s_and_b32 s29, s24, 1
    s_lshl_b32 s29, s29, 9
    s_lshr_b32 s59, s24, 1
    s_lshl_b32 s73, s59, 7
    s_add_u32 s29, s29, s73
    v_lshrrev_b32 v95, 5, v0
    v_lshl_add_u32 v95, v95, 8, s29
    v_and_b32 v94, 7, v0
    v_lshl_add_u32 v95, v94, 4, v95
    v_bfe_u32 v94, v0, 3, 2
    v_lshl_add_u32 v95, v94, 2, v95
    s_lshl_b32 s59, s59, 5
    v_mov_b32 v94, s59
    s_waitcnt lgkmcnt(0)
    s_barrier
    ds_read_b128 v[84:87], v94 offset:6400
    ds_read_b128 v[88:91], v94 offset:6416
    ds_read_b32 v80, v95 offset:2304
    ds_read_b32 v81, v95 offset:3328
    ds_read_b32 v82, v95 offset:4352
    ds_read_b32 v83, v95 offset:5376
    s_lshl_b32 s69, s81, 18
    s_add_u32 s69, s69, s78
    s_lshl_b32 s70, s81, 12
    s_add_u32 s70, s70, s79
    s_lshl_b32 s29, s26, 10
    s_add_u32 s29, s29, s69
    s_lshl_b32 s59, s26, 3
    s_add_u32 s59, s59, s70
    s_waitcnt lgkmcnt(4)
    v_max3_f32 v92, v84, v86, v88
    v_max_f32 v92, v92, v90
    v_sub_f32 v84, v84, v92
    v_sub_f32 v86, v86, v92
    v_sub_f32 v88, v88, v92
    v_sub_f32 v90, v90, v92
    v_exp_f32 v84, v84
    v_exp_f32 v86, v86
    v_exp_f32 v88, v88
    v_exp_f32 v90, v90
    s_waitcnt lgkmcnt(0)
    v_mul_f32 v96, v80, v84
    v_mul_f32 v93, v85, v84
    v_fmac_f32 v96, v81, v86
    v_fmac_f32 v93, v87, v86
    v_fmac_f32 v96, v82, v88
    v_fmac_f32 v93, v89, v88
    v_fmac_f32 v96, v83, v90
    v_fmac_f32 v93, v91, v90
    s_mov_b64 exec, 1
    s_cmp_eq_u32 s89, 0
    s_cbranch_scc1 FS_92
    buffer_store_dwordx2 v[92:93], v3, s[12:15], s59 offen
FS_93:
    s_mov_b64 exec, -1
    s_cmp_eq_u32 s89, 0
    s_cbranch_scc1 FS_94
    buffer_store_dword v96, v3, s[12:15], s29 offen
FS_95:
    s_nop 0
    ds_read_b128 v[16:19], v9 offset:14336
    ds_read_b128 v[20:23], v9 offset:14464
    v_mov_b32 v32, 0
    v_mov_b32 v33, 0
    v_mov_b32 v34, 0
    v_mov_b32 v35, 0
    v_mov_b32 v36, 0xff800000
    v_mov_b32 v37, 0xff800000
    v_mov_b32 v38, 0
    s_waitcnt lgkmcnt(0)
    s_call_b64 s[30:31], U_v144_v160
    s_add_u32 s91, s58, 0x4018000
    s_add_u32 m0, s71, 24576
    s_nop 0
    buffer_load_dwordx4 v1, s[4:7], s91 offen offset:0 nt lds
    s_add_u32 m0, s71, 25472
    s_nop 0
    buffer_load_dwordx4 v1, s[4:7], s91 offen offset:128 nt lds
    s_add_u32 m0, s71, 24576
    s_nop 0
    buffer_load_dwordx4 v1, s[4:7], s91 offen offset:2048 nt lds
    s_add_u32 m0, s71, 25472
    s_nop 0
    buffer_load_dwordx4 v1, s[4:7], s91 offen offset:2176 nt lds
    s_add_u32 m0, s71, 28672
    s_nop 0
    buffer_load_dwordx4 v2, s[8:11], s91 offen offset:0 nt lds
    s_add_u32 m0, s71, 29440
    s_nop 0
    buffer_load_dwordx4 v2, s[8:11], s91 offen offset:256 nt lds
    s_add_u32 m0, s71, 28672
    s_nop 0
    buffer_load_dwordx4 v2, s[8:11], s91 offen offset:2048 nt lds
    s_add_u32 m0, s71, 29440
    s_nop 0
    buffer_load_dwordx4 v2, s[8:11], s91 offen offset:2304 nt lds
    v_lshrrev_b32 v45, 4, v0
    v_min_u32 v45, 2, v45
    v_lshlrev_b32 v45, 18, v45
    v_and_b32 v44, 0xf0, v8
    v_add_u32 v45, v45, v44
    s_lshl_b32 s59, s26, 10
    s_add_u32 s59, s59, s78
    s_add_u32 s59, s59, 0x40000
    buffer_load_dword v44, v45, s[12:15], s59 offen sc1
    s_waitcnt vmcnt(51)
    s_call_b64 s[30:31], U_a160_a176
    s_waitcnt vmcnt(43)
    s_call_b64 s[30:31], U_a128_a144
    s_add_u32 s92, s58, 0x401c000
    s_add_u32 m0, s71, 32768
    s_nop 0
    buffer_load_dwordx4 v1, s[4:7], s92 offen offset:0 nt lds
    s_add_u32 m0, s71, 33664
    s_nop 0
    buffer_load_dwordx4 v1, s[4:7], s92 offen offset:128 nt lds
    s_add_u32 m0, s71, 32768
    s_nop 0
    buffer_load_dwordx4 v1, s[4:7], s92 offen offset:2048 nt lds
    s_add_u32 m0, s71, 33664
    s_nop 0
    buffer_load_dwordx4 v1, s[4:7], s92 offen offset:2176 nt lds
    buffer_load_dwordx4 v[240:243], v2, s[8:11], s92 offen offset:0 nt
    buffer_load_dwordx4 v[244:247], v2, s[8:11], s92 offen offset:256 nt
    buffer_load_dwordx4 v[248:251], v2, s[8:11], s92 offen offset:2048 nt
    buffer_load_dwordx4 v[252:255], v2, s[8:11], s92 offen offset:2304 nt
    s_waitcnt vmcnt(43)
    ds_read_b128 a[224:227], v10 offset:0
    ds_read_b128 a[228:231], v10 offset:1024
    ds_read_b128 a[232:235], v10 offset:2048
    ds_read_b128 a[236:239], v10 offset:3072
    ds_read_b128 a[240:243], v10 offset:4096
    ds_read_b128 a[244:247], v10 offset:5120
    ds_read_b128 a[248:251], v10 offset:6144
    ds_read_b128 a[252:255], v10 offset:7168
    s_waitcnt lgkmcnt(0)
    s_call_b64 s[30:31], U_a224_a240
    s_add_u32 s93, s58, 0x4020000
    buffer_load_dwordx4 a[96:99], v1, s[4:7], s93 offen offset:0 nt
    buffer_load_dwordx4 a[100:103], v1, s[4:7], s93 offen offset:128 nt
    buffer_load_dwordx4 a[104:107], v1, s[4:7], s93 offen offset:2048 nt
    buffer_load_dwordx4 a[108:111], v1, s[4:7], s93 offen offset:2176 nt
    buffer_load_dwordx4 a[112:115], v2, s[8:11], s93 offen offset:0 nt
    buffer_load_dwordx4 a[116:119], v2, s[8:11], s93 offen offset:256 nt
    buffer_load_dwordx4 a[120:123], v2, s[8:11], s93 offen offset:2048 nt
    buffer_load_dwordx4 a[124:127], v2, s[8:11], s93 offen offset:2304 nt
    s_waitcnt vmcnt(43)
    ds_read_b128 a[192:195], v10 offset:8192
    ds_read_b128 a[196:199], v10 offset:9216
    ds_read_b128 a[200:203], v10 offset:10240
    ds_read_b128 a[204:207], v10 offset:11264
    ds_read_b128 a[208:211], v10 offset:12288
    ds_read_b128 a[212:215], v10 offset:13312
    ds_read_b128 a[216:219], v10 offset:14336
    ds_read_b128 a[220:223], v10 offset:15360
    s_waitcnt lgkmcnt(0)
    s_call_b64 s[30:31], U_a192_a208
    s_waitcnt vmcnt(35)
    ds_read_b128 a[224:227], v10 offset:16384
    ds_read_b128 a[228:231], v10 offset:17408
    ds_read_b128 a[232:235], v10 offset:18432
    ds_read_b128 a[236:239], v10 offset:19456
    ds_read_b128 a[240:243], v10 offset:20480
    ds_read_b128 a[244:247], v10 offset:21504
    ds_read_b128 a[248:251], v10 offset:22528
    ds_read_b128 a[252:255], v10 offset:23552
    s_waitcnt lgkmcnt(0)
    s_call_b64 s[30:31], U_a224_a240
    s_waitcnt vmcnt(17)
    ds_read_b128 a[192:195], v10 offset:24576
    ds_read_b128 a[196:199], v10 offset:25600
    ds_read_b128 a[200:203], v10 offset:26624
    ds_read_b128 a[204:207], v10 offset:27648
    ds_read_b128 a[208:211], v10 offset:28672
    ds_read_b128 a[212:215], v10 offset:29696
    ds_read_b128 a[216:219], v10 offset:30720
    ds_read_b128 a[220:223], v10 offset:31744
    s_waitcnt lgkmcnt(0)
    s_call_b64 s[30:31], U_a192_a208
    s_add_u32 s29, s58, 0x4024000
    buffer_load_dwordx4 a[64:67], v1, s[4:7], s29 offen offset:0 nt
    buffer_load_dwordx4 a[68:71], v1, s[4:7], s29 offen offset:128 nt
    buffer_load_dwordx4 a[72:75], v1, s[4:7], s29 offen offset:2048 nt
    buffer_load_dwordx4 a[76:79], v1, s[4:7], s29 offen offset:2176 nt
    buffer_load_dwordx4 a[80:83], v2, s[8:11], s29 offen offset:0 nt
    buffer_load_dwordx4 a[84:87], v2, s[8:11], s29 offen offset:256 nt
    buffer_load_dwordx4 a[88:91], v2, s[8:11], s29 offen offset:2048 nt
    buffer_load_dwordx4 a[92:95], v2, s[8:11], s29 offen offset:2304 nt
    s_waitcnt vmcnt(16)
    ds_read_b128 a[224:227], v10 offset:32768
    ds_read_b128 a[228:231], v10 offset:33792
    ds_read_b128 a[232:235], v10 offset:34816
    ds_read_b128 a[236:239], v10 offset:35840
    s_waitcnt lgkmcnt(0)
    s_call_b64 s[30:31], U_a224_v240
    s_add_u32 s29, s58, 0x4028000
    buffer_load_dwordx4 a[32:35], v1, s[4:7], s29 offen offset:0 nt
    buffer_load_dwordx4 a[36:39], v1, s[4:7], s29 offen offset:128 nt
    buffer_load_dwordx4 a[40:43], v1, s[4:7], s29 offen offset:2048 nt
    buffer_load_dwordx4 a[44:47], v1, s[4:7], s29 offen offset:2176 nt
    buffer_load_dwordx4 a[48:51], v2, s[8:11], s29 offen offset:0 nt
    buffer_load_dwordx4 a[52:55], v2, s[8:11], s29 offen offset:256 nt
    buffer_load_dwordx4 a[56:59], v2, s[8:11], s29 offen offset:2048 nt
    buffer_load_dwordx4 a[60:63], v2, s[8:11], s29 offen offset:2304 nt
    s_waitcnt vmcnt(16)
    s_call_b64 s[30:31], U_a96_a112
    s_add_u32 s29, s58, 0x402c000
    buffer_load_dwordx4 a[0:3], v1, s[4:7], s29 offen offset:0 nt
    buffer_load_dwordx4 a[4:7], v1, s[4:7], s29 offen offset:128 nt
    buffer_load_dwordx4 a[8:11], v1, s[4:7], s29 offen offset:2048 nt
    buffer_load_dwordx4 a[12:15], v1, s[4:7], s29 offen offset:2176 nt
    buffer_load_dwordx4 a[16:19], v2, s[8:11], s29 offen offset:0 nt
    buffer_load_dwordx4 a[20:23], v2, s[8:11], s29 offen offset:256 nt
    buffer_load_dwordx4 a[24:27], v2, s[8:11], s29 offen offset:2048 nt
    buffer_load_dwordx4 a[28:31], v2, s[8:11], s29 offen offset:2304 nt
    s_waitcnt vmcnt(16)
    s_call_b64 s[30:31], U_a64_a80
    s_add_u32 s29, s58, 0x4030000
    buffer_load_dwordx4 v[176:179], v1, s[4:7], s29 offen offset:0 nt
    buffer_load_dwordx4 v[180:183], v1, s[4:7], s29 offen offset:128 nt
    buffer_load_dwordx4 v[184:187], v1, s[4:7], s29 offen offset:2048 nt
    buffer_load_dwordx4 v[188:191], v1, s[4:7], s29 offen offset:2176 nt
    buffer_load_dwordx4 v[192:195], v2, s[8:11], s29 offen offset:0 nt
    buffer_load_dwordx4 v[196:199], v2, s[8:11], s29 offen offset:256 nt
    buffer_load_dwordx4 v[200:203], v2, s[8:11], s29 offen offset:2048 nt
    buffer_load_dwordx4 v[204:207], v2, s[8:11], s29 offen offset:2304 nt
    s_waitcnt vmcnt(16)
    s_call_b64 s[30:31], U_a32_a48
    s_add_u32 s29, s58, 0x4034000
    buffer_load_dwordx4 v[208:211], v1, s[4:7], s29 offen offset:0 nt
    buffer_load_dwordx4 v[212:215], v1, s[4:7], s29 offen offset:128 nt
    buffer_load_dwordx4 v[216:219], v1, s[4:7], s29 offen offset:2048 nt
    buffer_load_dwordx4 v[220:223], v1, s[4:7], s29 offen offset:2176 nt
    buffer_load_dwordx4 v[224:227], v2, s[8:11], s29 offen offset:0 nt
    buffer_load_dwordx4 v[228:231], v2, s[8:11], s29 offen offset:256 nt
    buffer_load_dwordx4 v[232:235], v2, s[8:11], s29 offen offset:2048 nt
    buffer_load_dwordx4 v[236:239], v2, s[8:11], s29 offen offset:2304 nt
    s_waitcnt vmcnt(16)
    s_call_b64 s[30:31], U_a0_a16
    s_add_u32 s29, s58, 0x4038000
    buffer_load_dwordx4 a[192:195], v1, s[4:7], s29 offen offset:0 nt
    buffer_load_dwordx4 a[196:199], v1, s[4:7], s29 offen offset:128 nt
    buffer_load_dwordx4 a[200:203], v1, s[4:7], s29 offen offset:2048 nt
    buffer_load_dwordx4 a[204:207], v1, s[4:7], s29 offen offset:2176 nt
    buffer_load_dwordx4 a[208:211], v2, s[8:11], s29 offen offset:0 nt
    buffer_load_dwordx4 a[212:215], v2, s[8:11], s29 offen offset:256 nt
    buffer_load_dwordx4 a[216:219], v2, s[8:11], s29 offen offset:2048 nt
    buffer_load_dwordx4 a[220:223], v2, s[8:11], s29 offen offset:2304 nt
    s_waitcnt vmcnt(16)
    s_call_b64 s[30:31], U_v176_v192
    s_add_u32 s29, s58, 0x403c000
    buffer_load_dwordx4 a[224:227], v1, s[4:7], s29 offen offset:0 nt
    buffer_load_dwordx4 a[228:231], v1, s[4:7], s29 offen offset:128 nt
    buffer_load_dwordx4 a[232:235], v1, s[4:7], s29 offen offset:2048 nt
    buffer_load_dwordx4 a[236:239], v1, s[4:7], s29 offen offset:2176 nt
    buffer_load_dwordx4 a[240:243], v2, s[8:11], s29 offen offset:0 nt
    buffer_load_dwordx4 a[244:247], v2, s[8:11], s29 offen offset:256 nt
    buffer_load_dwordx4 a[248:251], v2, s[8:11], s29 offen offset:2048 nt
    buffer_load_dwordx4 a[252:255], v2, s[8:11], s29 offen offset:2304 nt
    s_waitcnt vmcnt(16)
    s_call_b64 s[30:31], U_v208_v224
    s_waitcnt vmcnt(8)
    s_call_b64 s[30:31], U_a192_a208
    s_waitcnt vmcnt(0)
    s_call_b64 s[30:31], U_a224_a240
    s_mov_b32 s81, 1
    s_mov_b32 s82, 1
    s_mov_b32 s83, 11520
    s_mov_b32 s84, 0x30000
    s_mov_b32 s85, 14848
    s_mov_b32 s101, 13824
    s_call_b64 s[30:31], F_comb
    s_sleep 4
    s_call_b64 s[30:31], F_woi
    s_waitcnt vmcnt(0)
    s_call_b64 s[30:31], F_wof
    s_sleep 16
    s_call_b64 s[30:31], F_g4i
    s_waitcnt vmcnt(12)
    s_call_b64 s[30:31], F_up
    s_waitcnt vmcnt(0)
    s_call_b64 s[30:31], F_xc
    s_call_b64 s[30:31], F_xf
    s_sleep 18
    s_call_b64 s[30:31], F_yi
    s_waitcnt vmcnt(0)
    s_call_b64 s[30:31], F_qstage
    v_add_u32 v12, s83, v8
    v_add_u32 v13, s83, v3
    ds_write_b128 v12, v[80:83]
    ds_write_b128 v12, v[84:87] offset:1024
    ds_write_b32 v13, v88 offset:2048
    s_call_b64 s[30:31], F_qgi
    s_waitcnt vmcnt(0)
    s_call_b64 s[30:31], F_qgf
L_join:
    s_call_b64 s[30:31], F_wow
    v_mfma_f32_16x16x32_bf16 v[48:51], v[144:147], v[16:19], 0
    v_mfma_f32_16x16x32_bf16 v[52:55], v[152:155], v[16:19], 0
    v_mfma_f32_16x16x32_bf16 v[48:51], v[148:151], v[20:23], v[48:51]
    v_mfma_f32_16x16x32_bf16 v[52:55], v[156:159], v[20:23], v[52:55]
    v_mov_b32 v83, 0
    v_mov_b32 v85, 0
    v_mov_b32 v81, s27
    s_nop 4
    v_mov_b32_dpp v48, v48 quad_perm:[0,0,2,2] row_mask:0xf bank_mask:0xf
    v_mov_b32_dpp v50, v50 quad_perm:[0,0,2,2] row_mask:0xf bank_mask:0xf
    v_mov_b32_dpp v52, v52 quad_perm:[0,0,2,2] row_mask:0xf bank_mask:0xf
    v_mov_b32_dpp v54, v54 quad_perm:[0,0,2,2] row_mask:0xf bank_mask:0xf
    v_add_f32_dpp v48, v49, v48 quad_perm:[1,1,3,3] row_mask:0xf bank_mask:0xf
    v_add_f32_dpp v50, v51, v50 quad_perm:[1,1,3,3] row_mask:0xf bank_mask:0xf
    v_add_f32_dpp v52, v53, v52 quad_perm:[1,1,3,3] row_mask:0xf bank_mask:0xf
    v_add_f32_dpp v54, v55, v54 quad_perm:[1,1,3,3] row_mask:0xf bank_mask:0xf
    v_max3_f32 v12, v48, v50, v52
    v_max_f32 v12, v12, v54
    v_mov_b32 v13, v12
    s_nop 1
    v_permlane16_swap_b32 v12, v13
    v_max_f32 v12, v12, v13
    v_mov_b32 v13, v12
    s_nop 1
    v_permlane32_swap_b32 v12, v13
    v_max_f32 v12, v12, v13
    v_mul_f32 v37, s27, v12
    v_add_f32 v36, 0x427af233, v12
    v_sub_f32 v82, 0, v12
    v_sub_f32 v84, 0, v12
    v_fma_f32 v48, v48, s27, -v37
    v_fma_f32 v50, v50, s27, -v37
    v_fma_f32 v52, v52, s27, -v37
    v_fma_f32 v54, v54, s27, -v37
    v_mfma_f32_16x16x32_bf16 v[24:27], a[160:163], v[16:19], v[82:85]
    v_mfma_f32_16x16x32_bf16 v[28:31], a[168:171], v[16:19], v[82:85]
    v_exp_f32 v48, v48
    v_exp_f32 v50, v50
    v_mfma_f32_16x16x32_bf16 v[24:27], a[164:167], v[20:23], v[24:27]
    v_exp_f32 v52, v52
    v_exp_f32 v54, v54
    v_mfma_f32_16x16x32_bf16 v[28:31], a[172:175], v[20:23], v[28:31]
    v_cvt_pk_bf16_f32 v13, v48, v48
    v_and_b32 v56, v13, v4
    v_and_b32 v57, v13, v5
    v_and_b32 v58, v13, v6
    v_and_b32 v59, v13, v7
    v_add_f32 v38, v38, v48
    v_cvt_pk_bf16_f32 v13, v50, v50
    v_mfma_f32_16x16x32_bf16 v[32:35], v[160:163], v[56:59], v[32:35]
    v_and_b32 v56, v13, v4
    v_and_b32 v57, v13, v5
    v_and_b32 v58, v13, v6
    v_and_b32 v59, v13, v7
    v_add_f32 v38, v38, v50
    v_cvt_pk_bf16_f32 v13, v52, v52
    v_mfma_f32_16x16x32_bf16 v[32:35], v[164:167], v[56:59], v[32:35]
    v_and_b32 v56, v13, v4
    v_and_b32 v57, v13, v5
    v_and_b32 v58, v13, v6
    v_and_b32 v59, v13, v7
    v_add_f32 v38, v38, v52
    v_cvt_pk_bf16_f32 v13, v54, v54
    v_mfma_f32_16x16x32_bf16 v[32:35], v[168:171], v[56:59], v[32:35]
    v_and_b32 v56, v13, v4
    v_and_b32 v57, v13, v5
    v_and_b32 v58, v13, v6
    v_and_b32 v59, v13, v7
    v_add_f32 v38, v38, v54
    s_nop 0
    v_mfma_f32_16x16x32_bf16 v[32:35], v[172:175], v[56:59], v[32:35]
    v_mul_f32_dpp v24, v24, v81 quad_perm:[0,0,2,2] row_mask:0xf bank_mask:0xf
    v_mul_f32_dpp v26, v26, v81 quad_perm:[0,0,2,2] row_mask:0xf bank_mask:0xf
    v_mul_f32_dpp v28, v28, v81 quad_perm:[0,0,2,2] row_mask:0xf bank_mask:0xf
    v_mul_f32_dpp v30, v30, v81 quad_perm:[0,0,2,2] row_mask:0xf bank_mask:0xf
    v_mfma_f32_16x16x32_bf16 v[48:51], a[128:131], v[16:19], v[82:85]
    v_fmac_f32_dpp v24, v25, v81 quad_perm:[1,1,3,3] row_mask:0xf bank_mask:0xf
    v_fmac_f32_dpp v26, v27, v81 quad_perm:[1,1,3,3] row_mask:0xf bank_mask:0xf
    v_fmac_f32_dpp v28, v29, v81 quad_perm:[1,1,3,3] row_mask:0xf bank_mask:0xf
    v_fmac_f32_dpp v30, v31, v81 quad_perm:[1,1,3,3] row_mask:0xf bank_mask:0xf
    v_mfma_f32_16x16x32_bf16 v[52:55], a[136:139], v[16:19], v[82:85]
    v_exp_f32 v24, v24
    v_exp_f32 v26, v26
    v_mfma_f32_16x16x32_bf16 v[48:51], a[132:135], v[20:23], v[48:51]
    v_exp_f32 v28, v28
    v_exp_f32 v30, v30
    v_mfma_f32_16x16x32_bf16 v[52:55], a[140:143], v[20:23], v[52:55]
    v_cvt_pk_bf16_f32 v13, v24, v24
    v_and_b32 v56, v13, v4
    v_and_b32 v57, v13, v5
    v_and_b32 v58, v13, v6
    v_and_b32 v59, v13, v7
    v_add_f32 v38, v38, v24
    v_cvt_pk_bf16_f32 v13, v26, v26
    v_mfma_f32_16x16x32_bf16 v[32:35], a[176:179], v[56:59], v[32:35]
    v_and_b32 v56, v13, v4
    v_and_b32 v57, v13, v5
    v_and_b32 v58, v13, v6
    v_and_b32 v59, v13, v7
    v_add_f32 v38, v38, v26
    v_cvt_pk_bf16_f32 v13, v28, v28
    v_mfma_f32_16x16x32_bf16 v[32:35], a[180:183], v[56:59], v[32:35]
    v_and_b32 v56, v13, v4
    v_and_b32 v57, v13, v5
    v_and_b32 v58, v13, v6
    v_and_b32 v59, v13, v7
    v_add_f32 v38, v38, v28
    v_cvt_pk_bf16_f32 v13, v30, v30
    v_mfma_f32_16x16x32_bf16 v[32:35], a[184:187], v[56:59], v[32:35]
    v_and_b32 v56, v13, v4
    v_and_b32 v57, v13, v5
    v_and_b32 v58, v13, v6
    v_and_b32 v59, v13, v7
    v_add_f32 v38, v38, v30
    s_nop 0
    v_mfma_f32_16x16x32_bf16 v[32:35], a[188:191], v[56:59], v[32:35]
    v_mul_f32_dpp v48, v48, v81 quad_perm:[0,0,2,2] row_mask:0xf bank_mask:0xf
    v_mul_f32_dpp v50, v50, v81 quad_perm:[0,0,2,2] row_mask:0xf bank_mask:0xf
    v_mul_f32_dpp v52, v52, v81 quad_perm:[0,0,2,2] row_mask:0xf bank_mask:0xf
    v_mul_f32_dpp v54, v54, v81 quad_perm:[0,0,2,2] row_mask:0xf bank_mask:0xf
    v_mfma_f32_16x16x32_bf16 v[24:27], a[96:99], v[16:19], v[82:85]
    v_fmac_f32_dpp v48, v49, v81 quad_perm:[1,1,3,3] row_mask:0xf bank_mask:0xf
    v_fmac_f32_dpp v50, v51, v81 quad_perm:[1,1,3,3] row_mask:0xf bank_mask:0xf
    v_fmac_f32_dpp v52, v53, v81 quad_perm:[1,1,3,3] row_mask:0xf bank_mask:0xf
    v_fmac_f32_dpp v54, v55, v81 quad_perm:[1,1,3,3] row_mask:0xf bank_mask:0xf
    v_mfma_f32_16x16x32_bf16 v[28:31], a[104:107], v[16:19], v[82:85]
    v_exp_f32 v48, v48
    v_exp_f32 v50, v50
    v_mfma_f32_16x16x32_bf16 v[24:27], a[100:103], v[20:23], v[24:27]
    v_exp_f32 v52, v52
    v_exp_f32 v54, v54
    v_mfma_f32_16x16x32_bf16 v[28:31], a[108:111], v[20:23], v[28:31]
    v_cvt_pk_bf16_f32 v13, v48, v48
    v_and_b32 v56, v13, v4
    v_and_b32 v57, v13, v5
    v_and_b32 v58, v13, v6
    v_and_b32 v59, v13, v7
    v_add_f32 v38, v38, v48
    v_cvt_pk_bf16_f32 v13, v50, v50
    v_mfma_f32_16x16x32_bf16 v[32:35], a[144:147], v[56:59], v[32:35]
    v_and_b32 v56, v13, v4
    v_and_b32 v57, v13, v5
    v_and_b32 v58, v13, v6
    v_and_b32 v59, v13, v7
    v_add_f32 v38, v38, v50
    v_cvt_pk_bf16_f32 v13, v52, v52
    v_mfma_f32_16x16x32_bf16 v[32:35], a[148:151], v[56:59], v[32:35]
    v_and_b32 v56, v13, v4
    v_and_b32 v57, v13, v5
    v_and_b32 v58, v13, v6
    v_and_b32 v59, v13, v7
    v_add_f32 v38, v38, v52
    v_cvt_pk_bf16_f32 v13, v54, v54
    v_mfma_f32_16x16x32_bf16 v[32:35], a[152:155], v[56:59], v[32:35]
    v_and_b32 v56, v13, v4
    v_and_b32 v57, v13, v5
    v_and_b32 v58, v13, v6
    v_and_b32 v59, v13, v7
    v_add_f32 v38, v38, v54
    s_nop 0
    v_mfma_f32_16x16x32_bf16 v[32:35], a[156:159], v[56:59], v[32:35]
    v_mul_f32_dpp v24, v24, v81 quad_perm:[0,0,2,2] row_mask:0xf bank_mask:0xf
    v_mul_f32_dpp v26, v26, v81 quad_perm:[0,0,2,2] row_mask:0xf bank_mask:0xf
    v_mul_f32_dpp v28, v28, v81 quad_perm:[0,0,2,2] row_mask:0xf bank_mask:0xf
    v_mul_f32_dpp v30, v30, v81 quad_perm:[0,0,2,2] row_mask:0xf bank_mask:0xf
    v_mfma_f32_16x16x32_bf16 v[48:51], a[224:227], v[16:19], v[82:85]
    v_fmac_f32_dpp v24, v25, v81 quad_perm:[1,1,3,3] row_mask:0xf bank_mask:0xf
    v_fmac_f32_dpp v26, v27, v81 quad_perm:[1,1,3,3] row_mask:0xf bank_mask:0xf
    v_fmac_f32_dpp v28, v29, v81 quad_perm:[1,1,3,3] row_mask:0xf bank_mask:0xf
    v_fmac_f32_dpp v30, v31, v81 quad_perm:[1,1,3,3] row_mask:0xf bank_mask:0xf
    v_mfma_f32_16x16x32_bf16 v[52:55], a[232:235], v[16:19], v[82:85]
    v_exp_f32 v24, v24
    v_exp_f32 v26, v26
    v_mfma_f32_16x16x32_bf16 v[48:51], a[228:231], v[20:23], v[48:51]
    v_exp_f32 v28, v28
    v_exp_f32 v30, v30
    v_mfma_f32_16x16x32_bf16 v[52:55], a[236:239], v[20:23], v[52:55]
    v_cvt_pk_bf16_f32 v13, v24, v24
    v_and_b32 v56, v13, v4
    v_and_b32 v57, v13, v5
    v_and_b32 v58, v13, v6
    v_and_b32 v59, v13, v7
    v_add_f32 v38, v38, v24
    v_cvt_pk_bf16_f32 v13, v26, v26
    v_mfma_f32_16x16x32_bf16 v[32:35], a[112:115], v[56:59], v[32:35]
    v_and_b32 v56, v13, v4
    v_and_b32 v57, v13, v5
    v_and_b32 v58, v13, v6
    v_and_b32 v59, v13, v7
    v_add_f32 v38, v38, v26
    v_cvt_pk_bf16_f32 v13, v28, v28
    v_mfma_f32_16x16x32_bf16 v[32:35], a[116:119], v[56:59], v[32:35]
    v_and_b32 v56, v13, v4
    v_and_b32 v57, v13, v5
    v_and_b32 v58, v13, v6
    v_and_b32 v59, v13, v7
    v_add_f32 v38, v38, v28
    v_cvt_pk_bf16_f32 v13, v30, v30
    v_mfma_f32_16x16x32_bf16 v[32:35], a[120:123], v[56:59], v[32:35]
    v_and_b32 v56, v13, v4
    v_and_b32 v57, v13, v5
    v_and_b32 v58, v13, v6
    v_and_b32 v59, v13, v7
    v_add_f32 v38, v38, v30
    s_nop 0
    v_mfma_f32_16x16x32_bf16 v[32:35], a[124:127], v[56:59], v[32:35]
    ds_read_b128 a[224:227], v10 offset:0
    ds_read_b128 a[228:231], v10 offset:1024
    ds_read_b128 a[232:235], v10 offset:2048
    ds_read_b128 a[236:239], v10 offset:3072
    v_mul_f32_dpp v48, v48, v81 quad_perm:[0,0,2,2] row_mask:0xf bank_mask:0xf
    v_mul_f32_dpp v50, v50, v81 quad_perm:[0,0,2,2] row_mask:0xf bank_mask:0xf
    v_mul_f32_dpp v52, v52, v81 quad_perm:[0,0,2,2] row_mask:0xf bank_mask:0xf
    v_mul_f32_dpp v54, v54, v81 quad_perm:[0,0,2,2] row_mask:0xf bank_mask:0xf
    v_mfma_f32_16x16x32_bf16 v[24:27], a[192:195], v[16:19], v[82:85]
    v_fmac_f32_dpp v48, v49, v81 quad_perm:[1,1,3,3] row_mask:0xf bank_mask:0xf
    v_fmac_f32_dpp v50, v51, v81 quad_perm:[1,1,3,3] row_mask:0xf bank_mask:0xf
    v_fmac_f32_dpp v52, v53, v81 quad_perm:[1,1,3,3] row_mask:0xf bank_mask:0xf
    v_fmac_f32_dpp v54, v55, v81 quad_perm:[1,1,3,3] row_mask:0xf bank_mask:0xf
    v_mfma_f32_16x16x32_bf16 v[28:31], a[200:203], v[16:19], v[82:85]
    v_exp_f32 v48, v48
    v_exp_f32 v50, v50
    v_mfma_f32_16x16x32_bf16 v[24:27], a[196:199], v[20:23], v[24:27]
    v_exp_f32 v52, v52
    v_exp_f32 v54, v54
    v_mfma_f32_16x16x32_bf16 v[28:31], a[204:207], v[20:23], v[28:31]
    v_cvt_pk_bf16_f32 v13, v48, v48
    v_and_b32 v56, v13, v4
    v_and_b32 v57, v13, v5
    v_and_b32 v58, v13, v6
    v_and_b32 v59, v13, v7
    v_add_f32 v38, v38, v48
    v_cvt_pk_bf16_f32 v13, v50, v50
    v_mfma_f32_16x16x32_bf16 v[32:35], a[240:243], v[56:59], v[32:35]
    v_and_b32 v56, v13, v4
    v_and_b32 v57, v13, v5
    v_and_b32 v58, v13, v6
    v_and_b32 v59, v13, v7
    v_add_f32 v38, v38, v50
    v_cvt_pk_bf16_f32 v13, v52, v52
    v_mfma_f32_16x16x32_bf16 v[32:35], a[244:247], v[56:59], v[32:35]
    v_and_b32 v56, v13, v4
    v_and_b32 v57, v13, v5
    v_and_b32 v58, v13, v6
    v_and_b32 v59, v13, v7
    v_add_f32 v38, v38, v52
    v_cvt_pk_bf16_f32 v13, v54, v54
    v_mfma_f32_16x16x32_bf16 v[32:35], a[248:251], v[56:59], v[32:35]
    v_and_b32 v56, v13, v4
    v_and_b32 v57, v13, v5
    v_and_b32 v58, v13, v6
    v_and_b32 v59, v13, v7
    v_add_f32 v38, v38, v54
    s_nop 0
    v_mfma_f32_16x16x32_bf16 v[32:35], a[252:255], v[56:59], v[32:35]
    s_waitcnt lgkmcnt(0)
    ds_read_b128 a[192:195], v10 offset:8192
    ds_read_b128 a[196:199], v10 offset:9216
    ds_read_b128 a[200:203], v10 offset:10240
    ds_read_b128 a[204:207], v10 offset:11264
    ds_read_b128 a[240:243], v10 offset:4096
    ds_read_b128 a[244:247], v10 offset:5120
    ds_read_b128 a[248:251], v10 offset:6144
    ds_read_b128 a[252:255], v10 offset:7168
    v_mul_f32_dpp v24, v24, v81 quad_perm:[0,0,2,2] row_mask:0xf bank_mask:0xf
    v_mul_f32_dpp v26, v26, v81 quad_perm:[0,0,2,2] row_mask:0xf bank_mask:0xf
    v_mul_f32_dpp v28, v28, v81 quad_perm:[0,0,2,2] row_mask:0xf bank_mask:0xf
    v_mul_f32_dpp v30, v30, v81 quad_perm:[0,0,2,2] row_mask:0xf bank_mask:0xf
    v_mfma_f32_16x16x32_bf16 v[48:51], a[224:227], v[16:19], v[82:85]
    v_fmac_f32_dpp v24, v25, v81 quad_perm:[1,1,3,3] row_mask:0xf bank_mask:0xf
    v_fmac_f32_dpp v26, v27, v81 quad_perm:[1,1,3,3] row_mask:0xf bank_mask:0xf
    v_fmac_f32_dpp v28, v29, v81 quad_perm:[1,1,3,3] row_mask:0xf bank_mask:0xf
    v_fmac_f32_dpp v30, v31, v81 quad_perm:[1,1,3,3] row_mask:0xf bank_mask:0xf
    v_mfma_f32_16x16x32_bf16 v[52:55], a[232:235], v[16:19], v[82:85]
    v_exp_f32 v24, v24
    v_exp_f32 v26, v26
    v_mfma_f32_16x16x32_bf16 v[48:51], a[228:231], v[20:23], v[48:51]
    v_exp_f32 v28, v28
    v_exp_f32 v30, v30
    v_mfma_f32_16x16x32_bf16 v[52:55], a[236:239], v[20:23], v[52:55]
    v_cvt_pk_bf16_f32 v13, v24, v24
    v_and_b32 v56, v13, v4
    v_and_b32 v57, v13, v5
    v_and_b32 v58, v13, v6
    v_and_b32 v59, v13, v7
    v_add_f32 v38, v38, v24
    v_cvt_pk_bf16_f32 v13, v26, v26
    v_mfma_f32_16x16x32_bf16 v[32:35], a[208:211], v[56:59], v[32:35]
    v_and_b32 v56, v13, v4
    v_and_b32 v57, v13, v5
    v_and_b32 v58, v13, v6
    v_and_b32 v59, v13, v7
    v_add_f32 v38, v38, v26
    v_cvt_pk_bf16_f32 v13, v28, v28
    v_mfma_f32_16x16x32_bf16 v[32:35], a[212:215], v[56:59], v[32:35]
    v_and_b32 v56, v13, v4
    v_and_b32 v57, v13, v5
    v_and_b32 v58, v13, v6
    v_and_b32 v59, v13, v7
    v_add_f32 v38, v38, v28
    v_cvt_pk_bf16_f32 v13, v30, v30
    v_mfma_f32_16x16x32_bf16 v[32:35], a[216:219], v[56:59], v[32:35]
    v_and_b32 v56, v13, v4
    v_and_b32 v57, v13, v5
    v_and_b32 v58, v13, v6
    v_and_b32 v59, v13, v7
    v_add_f32 v38, v38, v30
    s_nop 0
    v_mfma_f32_16x16x32_bf16 v[32:35], a[220:223], v[56:59], v[32:35]
    s_waitcnt lgkmcnt(0)
    ds_read_b128 a[224:227], v10 offset:16384
    ds_read_b128 a[228:231], v10 offset:17408
    ds_read_b128 a[232:235], v10 offset:18432
    ds_read_b128 a[236:239], v10 offset:19456
    ds_read_b128 a[208:211], v10 offset:12288
    ds_read_b128 a[212:215], v10 offset:13312
    ds_read_b128 a[216:219], v10 offset:14336
    ds_read_b128 a[220:223], v10 offset:15360
    v_mul_f32_dpp v48, v48, v81 quad_perm:[0,0,2,2] row_mask:0xf bank_mask:0xf
    v_mul_f32_dpp v50, v50, v81 quad_perm:[0,0,2,2] row_mask:0xf bank_mask:0xf
    v_mul_f32_dpp v52, v52, v81 quad_perm:[0,0,2,2] row_mask:0xf bank_mask:0xf
    v_mul_f32_dpp v54, v54, v81 quad_perm:[0,0,2,2] row_mask:0xf bank_mask:0xf
    v_mfma_f32_16x16x32_bf16 v[24:27], a[192:195], v[16:19], v[82:85]
    v_fmac_f32_dpp v48, v49, v81 quad_perm:[1,1,3,3] row_mask:0xf bank_mask:0xf
    v_fmac_f32_dpp v50, v51, v81 quad_perm:[1,1,3,3] row_mask:0xf bank_mask:0xf
    v_fmac_f32_dpp v52, v53, v81 quad_perm:[1,1,3,3] row_mask:0xf bank_mask:0xf
    v_fmac_f32_dpp v54, v55, v81 quad_perm:[1,1,3,3] row_mask:0xf bank_mask:0xf
    v_mfma_f32_16x16x32_bf16 v[28:31], a[200:203], v[16:19], v[82:85]
    v_exp_f32 v48, v48
    v_exp_f32 v50, v50
    v_mfma_f32_16x16x32_bf16 v[24:27], a[196:199], v[20:23], v[24:27]
    v_exp_f32 v52, v52
    v_exp_f32 v54, v54
    v_mfma_f32_16x16x32_bf16 v[28:31], a[204:207], v[20:23], v[28:31]
    v_cvt_pk_bf16_f32 v13, v48, v48
    v_and_b32 v56, v13, v4
    v_and_b32 v57, v13, v5
    v_and_b32 v58, v13, v6
    v_and_b32 v59, v13, v7
    v_add_f32 v38, v38, v48
    v_cvt_pk_bf16_f32 v13, v50, v50
    v_mfma_f32_16x16x32_bf16 v[32:35], a[240:243], v[56:59], v[32:35]
    v_and_b32 v56, v13, v4
    v_and_b32 v57, v13, v5
    v_and_b32 v58, v13, v6
    v_and_b32 v59, v13, v7
    v_add_f32 v38, v38, v50
    v_cvt_pk_bf16_f32 v13, v52, v52
    v_mfma_f32_16x16x32_bf16 v[32:35], a[244:247], v[56:59], v[32:35]
    v_and_b32 v56, v13, v4
    v_and_b32 v57, v13, v5
    v_and_b32 v58, v13, v6
    v_and_b32 v59, v13, v7
    v_add_f32 v38, v38, v52
    v_cvt_pk_bf16_f32 v13, v54, v54
    v_mfma_f32_16x16x32_bf16 v[32:35], a[248:251], v[56:59], v[32:35]
    v_and_b32 v56, v13, v4
    v_and_b32 v57, v13, v5
    v_and_b32 v58, v13, v6
    v_and_b32 v59, v13, v7
    v_add_f32 v38, v38, v54
    s_nop 0
    v_mfma_f32_16x16x32_bf16 v[32:35], a[252:255], v[56:59], v[32:35]
    s_waitcnt lgkmcnt(0)
    ds_read_b128 a[192:195], v10 offset:24576
    ds_read_b128 a[196:199], v10 offset:25600
    ds_read_b128 a[200:203], v10 offset:26624
    ds_read_b128 a[204:207], v10 offset:27648
    ds_read_b128 a[240:243], v10 offset:20480
    ds_read_b128 a[244:247], v10 offset:21504
    ds_read_b128 a[248:251], v10 offset:22528
    ds_read_b128 a[252:255], v10 offset:23552
    v_mul_f32_dpp v24, v24, v81 quad_perm:[0,0,2,2] row_mask:0xf bank_mask:0xf
    v_mul_f32_dpp v26, v26, v81 quad_perm:[0,0,2,2] row_mask:0xf bank_mask:0xf
    v_mul_f32_dpp v28, v28, v81 quad_perm:[0,0,2,2] row_mask:0xf bank_mask:0xf
    v_mul_f32_dpp v30, v30, v81 quad_perm:[0,0,2,2] row_mask:0xf bank_mask:0xf
    v_mfma_f32_16x16x32_bf16 v[48:51], a[224:227], v[16:19], v[82:85]
    v_fmac_f32_dpp v24, v25, v81 quad_perm:[1,1,3,3] row_mask:0xf bank_mask:0xf
    v_fmac_f32_dpp v26, v27, v81 quad_perm:[1,1,3,3] row_mask:0xf bank_mask:0xf
    v_fmac_f32_dpp v28, v29, v81 quad_perm:[1,1,3,3] row_mask:0xf bank_mask:0xf
    v_fmac_f32_dpp v30, v31, v81 quad_perm:[1,1,3,3] row_mask:0xf bank_mask:0xf
    v_mfma_f32_16x16x32_bf16 v[52:55], a[232:235], v[16:19], v[82:85]
    v_exp_f32 v24, v24
    v_exp_f32 v26, v26
    v_mfma_f32_16x16x32_bf16 v[48:51], a[228:231], v[20:23], v[48:51]
    v_exp_f32 v28, v28
    v_exp_f32 v30, v30
    v_mfma_f32_16x16x32_bf16 v[52:55], a[236:239], v[20:23], v[52:55]
    v_cvt_pk_bf16_f32 v13, v24, v24
    v_and_b32 v56, v13, v4
    v_and_b32 v57, v13, v5
    v_and_b32 v58, v13, v6
    v_and_b32 v59, v13, v7
    v_add_f32 v38, v38, v24
    v_cvt_pk_bf16_f32 v13, v26, v26
    v_mfma_f32_16x16x32_bf16 v[32:35], a[208:211], v[56:59], v[32:35]
    v_and_b32 v56, v13, v4
    v_and_b32 v57, v13, v5
    v_and_b32 v58, v13, v6
    v_and_b32 v59, v13, v7
    v_add_f32 v38, v38, v26
    v_cvt_pk_bf16_f32 v13, v28, v28
    v_mfma_f32_16x16x32_bf16 v[32:35], a[212:215], v[56:59], v[32:35]
    v_and_b32 v56, v13, v4
    v_and_b32 v57, v13, v5
    v_and_b32 v58, v13, v6
    v_and_b32 v59, v13, v7
    v_add_f32 v38, v38, v28
    v_cvt_pk_bf16_f32 v13, v30, v30
    v_mfma_f32_16x16x32_bf16 v[32:35], a[216:219], v[56:59], v[32:35]
    v_and_b32 v56, v13, v4
    v_and_b32 v57, v13, v5
    v_and_b32 v58, v13, v6
    v_and_b32 v59, v13, v7
    v_add_f32 v38, v38, v30
    s_nop 0
    v_mfma_f32_16x16x32_bf16 v[32:35], a[220:223], v[56:59], v[32:35]
    s_waitcnt lgkmcnt(0)
    ds_read_b128 a[224:227], v10 offset:32768
    ds_read_b128 a[228:231], v10 offset:33792
    ds_read_b128 a[232:235], v10 offset:34816
    ds_read_b128 a[236:239], v10 offset:35840
    ds_read_b128 a[208:211], v10 offset:28672
    ds_read_b128 a[212:215], v10 offset:29696
    ds_read_b128 a[216:219], v10 offset:30720
    ds_read_b128 a[220:223], v10 offset:31744
    v_mul_f32_dpp v48, v48, v81 quad_perm:[0,0,2,2] row_mask:0xf bank_mask:0xf
    v_mul_f32_dpp v50, v50, v81 quad_perm:[0,0,2,2] row_mask:0xf bank_mask:0xf
    v_mul_f32_dpp v52, v52, v81 quad_perm:[0,0,2,2] row_mask:0xf bank_mask:0xf
    v_mul_f32_dpp v54, v54, v81 quad_perm:[0,0,2,2] row_mask:0xf bank_mask:0xf
    v_mfma_f32_16x16x32_bf16 v[24:27], a[192:195], v[16:19], v[82:85]
    v_fmac_f32_dpp v48, v49, v81 quad_perm:[1,1,3,3] row_mask:0xf bank_mask:0xf
    v_fmac_f32_dpp v50, v51, v81 quad_perm:[1,1,3,3] row_mask:0xf bank_mask:0xf
    v_fmac_f32_dpp v52, v53, v81 quad_perm:[1,1,3,3] row_mask:0xf bank_mask:0xf
    v_fmac_f32_dpp v54, v55, v81 quad_perm:[1,1,3,3] row_mask:0xf bank_mask:0xf
    v_mfma_f32_16x16x32_bf16 v[28:31], a[200:203], v[16:19], v[82:85]
    v_exp_f32 v48, v48
    v_exp_f32 v50, v50
    v_mfma_f32_16x16x32_bf16 v[24:27], a[196:199], v[20:23], v[24:27]
    v_exp_f32 v52, v52
    v_exp_f32 v54, v54
    v_mfma_f32_16x16x32_bf16 v[28:31], a[204:207], v[20:23], v[28:31]
    v_cvt_pk_bf16_f32 v13, v48, v48
    v_and_b32 v56, v13, v4
    v_and_b32 v57, v13, v5
    v_and_b32 v58, v13, v6
    v_and_b32 v59, v13, v7
    v_add_f32 v38, v38, v48
    v_cvt_pk_bf16_f32 v13, v50, v50
    v_mfma_f32_16x16x32_bf16 v[32:35], a[240:243], v[56:59], v[32:35]
    v_and_b32 v56, v13, v4
    v_and_b32 v57, v13, v5
    v_and_b32 v58, v13, v6
    v_and_b32 v59, v13, v7
    v_add_f32 v38, v38, v50
    v_cvt_pk_bf16_f32 v13, v52, v52
    v_mfma_f32_16x16x32_bf16 v[32:35], a[244:247], v[56:59], v[32:35]
    v_and_b32 v56, v13, v4
    v_and_b32 v57, v13, v5
    v_and_b32 v58, v13, v6
    v_and_b32 v59, v13, v7
    v_add_f32 v38, v38, v52
    v_cvt_pk_bf16_f32 v13, v54, v54
    v_mfma_f32_16x16x32_bf16 v[32:35], a[248:251], v[56:59], v[32:35]
    v_and_b32 v56, v13, v4
    v_and_b32 v57, v13, v5
    v_and_b32 v58, v13, v6
    v_and_b32 v59, v13, v7
    v_add_f32 v38, v38, v54
    s_nop 0
    v_mfma_f32_16x16x32_bf16 v[32:35], a[252:255], v[56:59], v[32:35]
    s_waitcnt lgkmcnt(0)
    v_mul_f32_dpp v24, v24, v81 quad_perm:[0,0,2,2] row_mask:0xf bank_mask:0xf
    v_mul_f32_dpp v26, v26, v81 quad_perm:[0,0,2,2] row_mask:0xf bank_mask:0xf
    v_mul_f32_dpp v28, v28, v81 quad_perm:[0,0,2,2] row_mask:0xf bank_mask:0xf
    v_mul_f32_dpp v30, v30, v81 quad_perm:[0,0,2,2] row_mask:0xf bank_mask:0xf
    v_mfma_f32_16x16x32_bf16 v[48:51], a[224:227], v[16:19], v[82:85]
    v_fmac_f32_dpp v24, v25, v81 quad_perm:[1,1,3,3] row_mask:0xf bank_mask:0xf
    v_fmac_f32_dpp v26, v27, v81 quad_perm:[1,1,3,3] row_mask:0xf bank_mask:0xf
    v_fmac_f32_dpp v28, v29, v81 quad_perm:[1,1,3,3] row_mask:0xf bank_mask:0xf
    v_fmac_f32_dpp v30, v31, v81 quad_perm:[1,1,3,3] row_mask:0xf bank_mask:0xf
    v_mfma_f32_16x16x32_bf16 v[52:55], a[232:235], v[16:19], v[82:85]
    v_exp_f32 v24, v24
    v_exp_f32 v26, v26
    v_mfma_f32_16x16x32_bf16 v[48:51], a[228:231], v[20:23], v[48:51]
    v_exp_f32 v28, v28
    v_exp_f32 v30, v30
    v_mfma_f32_16x16x32_bf16 v[52:55], a[236:239], v[20:23], v[52:55]
    v_cvt_pk_bf16_f32 v13, v24, v24
    v_and_b32 v56, v13, v4
    v_and_b32 v57, v13, v5
    v_and_b32 v58, v13, v6
    v_and_b32 v59, v13, v7
    v_add_f32 v38, v38, v24
    v_cvt_pk_bf16_f32 v13, v26, v26
    v_mfma_f32_16x16x32_bf16 v[32:35], a[208:211], v[56:59], v[32:35]
    v_and_b32 v56, v13, v4
    v_and_b32 v57, v13, v5
    v_and_b32 v58, v13, v6
    v_and_b32 v59, v13, v7
    v_add_f32 v38, v38, v26
    v_cvt_pk_bf16_f32 v13, v28, v28
    v_mfma_f32_16x16x32_bf16 v[32:35], a[212:215], v[56:59], v[32:35]
    v_and_b32 v56, v13, v4
    v_and_b32 v57, v13, v5
    v_and_b32 v58, v13, v6
    v_and_b32 v59, v13, v7
    v_add_f32 v38, v38, v28
    v_cvt_pk_bf16_f32 v13, v30, v30
    v_mfma_f32_16x16x32_bf16 v[32:35], a[216:219], v[56:59], v[32:35]
    v_and_b32 v56, v13, v4
    v_and_b32 v57, v13, v5
    v_and_b32 v58, v13, v6
    v_and_b32 v59, v13, v7
    v_add_f32 v38, v38, v30
    s_nop 0
    v_mfma_f32_16x16x32_bf16 v[32:35], a[220:223], v[56:59], v[32:35]
    v_mul_f32_dpp v48, v48, v81 quad_perm:[0,0,2,2] row_mask:0xf bank_mask:0xf
    v_mul_f32_dpp v50, v50, v81 quad_perm:[0,0,2,2] row_mask:0xf bank_mask:0xf
    v_mul_f32_dpp v52, v52, v81 quad_perm:[0,0,2,2] row_mask:0xf bank_mask:0xf
    v_mul_f32_dpp v54, v54, v81 quad_perm:[0,0,2,2] row_mask:0xf bank_mask:0xf
    v_mfma_f32_16x16x32_bf16 v[24:27], a[64:67], v[16:19], v[82:85]
    v_fmac_f32_dpp v48, v49, v81 quad_perm:[1,1,3,3] row_mask:0xf bank_mask:0xf
    v_fmac_f32_dpp v50, v51, v81 quad_perm:[1,1,3,3] row_mask:0xf bank_mask:0xf
    v_fmac_f32_dpp v52, v53, v81 quad_perm:[1,1,3,3] row_mask:0xf bank_mask:0xf
    v_fmac_f32_dpp v54, v55, v81 quad_perm:[1,1,3,3] row_mask:0xf bank_mask:0xf
    v_mfma_f32_16x16x32_bf16 v[28:31], a[72:75], v[16:19], v[82:85]
    v_exp_f32 v48, v48
    v_exp_f32 v50, v50
    v_mfma_f32_16x16x32_bf16 v[24:27], a[68:71], v[20:23], v[24:27]
    v_exp_f32 v52, v52
    v_exp_f32 v54, v54
    v_mfma_f32_16x16x32_bf16 v[28:31], a[76:79], v[20:23], v[28:31]
    v_cvt_pk_bf16_f32 v13, v48, v48
    v_and_b32 v56, v13, v4
    v_and_b32 v57, v13, v5
    v_and_b32 v58, v13, v6
    v_and_b32 v59, v13, v7
    v_add_f32 v38, v38, v48
    v_cvt_pk_bf16_f32 v13, v50, v50
    v_mfma_f32_16x16x32_bf16 v[32:35], v[240:243], v[56:59], v[32:35]
    v_and_b32 v56, v13, v4
    v_and_b32 v57, v13, v5
    v_and_b32 v58, v13, v6
    v_and_b32 v59, v13, v7
    v_add_f32 v38, v38, v50
    v_cvt_pk_bf16_f32 v13, v52, v52
    v_mfma_f32_16x16x32_bf16 v[32:35], v[244:247], v[56:59], v[32:35]
    v_and_b32 v56, v13, v4
    v_and_b32 v57, v13, v5
    v_and_b32 v58, v13, v6
    v_and_b32 v59, v13, v7
    v_add_f32 v38, v38, v52
    v_cvt_pk_bf16_f32 v13, v54, v54
    v_mfma_f32_16x16x32_bf16 v[32:35], v[248:251], v[56:59], v[32:35]
    v_and_b32 v56, v13, v4
    v_and_b32 v57, v13, v5
    v_and_b32 v58, v13, v6
    v_and_b32 v59, v13, v7
    v_add_f32 v38, v38, v54
    s_nop 0
    v_mfma_f32_16x16x32_bf16 v[32:35], v[252:255], v[56:59], v[32:35]
    v_mul_f32_dpp v24, v24, v81 quad_perm:[0,0,2,2] row_mask:0xf bank_mask:0xf
    v_mul_f32_dpp v26, v26, v81 quad_perm:[0,0,2,2] row_mask:0xf bank_mask:0xf
    v_mul_f32_dpp v28, v28, v81 quad_perm:[0,0,2,2] row_mask:0xf bank_mask:0xf
    v_mul_f32_dpp v30, v30, v81 quad_perm:[0,0,2,2] row_mask:0xf bank_mask:0xf
    v_mfma_f32_16x16x32_bf16 v[48:51], a[32:35], v[16:19], v[82:85]
    v_fmac_f32_dpp v24, v25, v81 quad_perm:[1,1,3,3] row_mask:0xf bank_mask:0xf
    v_fmac_f32_dpp v26, v27, v81 quad_perm:[1,1,3,3] row_mask:0xf bank_mask:0xf
    v_fmac_f32_dpp v28, v29, v81 quad_perm:[1,1,3,3] row_mask:0xf bank_mask:0xf
    v_fmac_f32_dpp v30, v31, v81 quad_perm:[1,1,3,3] row_mask:0xf bank_mask:0xf
    v_mfma_f32_16x16x32_bf16 v[52:55], a[40:43], v[16:19], v[82:85]
    v_exp_f32 v24, v24
    v_exp_f32 v26, v26
    v_mfma_f32_16x16x32_bf16 v[48:51], a[36:39], v[20:23], v[48:51]
    v_exp_f32 v28, v28
    v_exp_f32 v30, v30
    v_mfma_f32_16x16x32_bf16 v[52:55], a[44:47], v[20:23], v[52:55]
    v_cvt_pk_bf16_f32 v13, v24, v24
    v_and_b32 v56, v13, v4
    v_and_b32 v57, v13, v5
    v_and_b32 v58, v13, v6
    v_and_b32 v59, v13, v7
    v_add_f32 v38, v38, v24
    v_cvt_pk_bf16_f32 v13, v26, v26
    v_mfma_f32_16x16x32_bf16 v[32:35], a[80:83], v[56:59], v[32:35]
    v_and_b32 v56, v13, v4
    v_and_b32 v57, v13, v5
    v_and_b32 v58, v13, v6
    v_and_b32 v59, v13, v7
    v_add_f32 v38, v38, v26
    v_cvt_pk_bf16_f32 v13, v28, v28
    v_mfma_f32_16x16x32_bf16 v[32:35], a[84:87], v[56:59], v[32:35]
    v_and_b32 v56, v13, v4
    v_and_b32 v57, v13, v5
    v_and_b32 v58, v13, v6
    v_and_b32 v59, v13, v7
    v_add_f32 v38, v38, v28
    v_cvt_pk_bf16_f32 v13, v30, v30
    v_mfma_f32_16x16x32_bf16 v[32:35], a[88:91], v[56:59], v[32:35]
    v_and_b32 v56, v13, v4
    v_and_b32 v57, v13, v5
    v_and_b32 v58, v13, v6
    v_and_b32 v59, v13, v7
    v_add_f32 v38, v38, v30
    s_nop 0
    v_mfma_f32_16x16x32_bf16 v[32:35], a[92:95], v[56:59], v[32:35]
    v_mul_f32_dpp v48, v48, v81 quad_perm:[0,0,2,2] row_mask:0xf bank_mask:0xf
    v_mul_f32_dpp v50, v50, v81 quad_perm:[0,0,2,2] row_mask:0xf bank_mask:0xf
    v_mul_f32_dpp v52, v52, v81 quad_perm:[0,0,2,2] row_mask:0xf bank_mask:0xf
    v_mul_f32_dpp v54, v54, v81 quad_perm:[0,0,2,2] row_mask:0xf bank_mask:0xf
    v_mfma_f32_16x16x32_bf16 v[24:27], a[0:3], v[16:19], v[82:85]
    v_fmac_f32_dpp v48, v49, v81 quad_perm:[1,1,3,3] row_mask:0xf bank_mask:0xf
    v_fmac_f32_dpp v50, v51, v81 quad_perm:[1,1,3,3] row_mask:0xf bank_mask:0xf
    v_fmac_f32_dpp v52, v53, v81 quad_perm:[1,1,3,3] row_mask:0xf bank_mask:0xf
    v_fmac_f32_dpp v54, v55, v81 quad_perm:[1,1,3,3] row_mask:0xf bank_mask:0xf
    v_mfma_f32_16x16x32_bf16 v[28:31], a[8:11], v[16:19], v[82:85]
    v_exp_f32 v48, v48
    v_exp_f32 v50, v50
    v_mfma_f32_16x16x32_bf16 v[24:27], a[4:7], v[20:23], v[24:27]
    v_exp_f32 v52, v52
    v_exp_f32 v54, v54
    v_mfma_f32_16x16x32_bf16 v[28:31], a[12:15], v[20:23], v[28:31]
    v_cvt_pk_bf16_f32 v13, v48, v48
    v_and_b32 v56, v13, v4
    v_and_b32 v57, v13, v5
    v_and_b32 v58, v13, v6
    v_and_b32 v59, v13, v7
    v_add_f32 v38, v38, v48
    v_cvt_pk_bf16_f32 v13, v50, v50
    v_mfma_f32_16x16x32_bf16 v[32:35], a[48:51], v[56:59], v[32:35]
    v_and_b32 v56, v13, v4
    v_and_b32 v57, v13, v5
    v_and_b32 v58, v13, v6
    v_and_b32 v59, v13, v7
    v_add_f32 v38, v38, v50
    v_cvt_pk_bf16_f32 v13, v52, v52
    v_mfma_f32_16x16x32_bf16 v[32:35], a[52:55], v[56:59], v[32:35]
    v_and_b32 v56, v13, v4
    v_and_b32 v57, v13, v5
    v_and_b32 v58, v13, v6
    v_and_b32 v59, v13, v7
    v_add_f32 v38, v38, v52
    v_cvt_pk_bf16_f32 v13, v54, v54
    v_mfma_f32_16x16x32_bf16 v[32:35], a[56:59], v[56:59], v[32:35]
    v_and_b32 v56, v13, v4
    v_and_b32 v57, v13, v5
    v_and_b32 v58, v13, v6
    v_and_b32 v59, v13, v7
    v_add_f32 v38, v38, v54
    s_nop 0
    v_mfma_f32_16x16x32_bf16 v[32:35], a[60:63], v[56:59], v[32:35]
    v_mul_f32_dpp v24, v24, v81 quad_perm:[0,0,2,2] row_mask:0xf bank_mask:0xf
    v_mul_f32_dpp v26, v26, v81 quad_perm:[0,0,2,2] row_mask:0xf bank_mask:0xf
    v_mul_f32_dpp v28, v28, v81 quad_perm:[0,0,2,2] row_mask:0xf bank_mask:0xf
    v_mul_f32_dpp v30, v30, v81 quad_perm:[0,0,2,2] row_mask:0xf bank_mask:0xf
    v_mfma_f32_16x16x32_bf16 v[48:51], v[176:179], v[16:19], v[82:85]
    v_fmac_f32_dpp v24, v25, v81 quad_perm:[1,1,3,3] row_mask:0xf bank_mask:0xf
    v_fmac_f32_dpp v26, v27, v81 quad_perm:[1,1,3,3] row_mask:0xf bank_mask:0xf
    v_fmac_f32_dpp v28, v29, v81 quad_perm:[1,1,3,3] row_mask:0xf bank_mask:0xf
    v_fmac_f32_dpp v30, v31, v81 quad_perm:[1,1,3,3] row_mask:0xf bank_mask:0xf
    v_mfma_f32_16x16x32_bf16 v[52:55], v[184:187], v[16:19], v[82:85]
    v_exp_f32 v24, v24
    v_exp_f32 v26, v26
    v_mfma_f32_16x16x32_bf16 v[48:51], v[180:183], v[20:23], v[48:51]
    v_exp_f32 v28, v28
    v_exp_f32 v30, v30
    v_mfma_f32_16x16x32_bf16 v[52:55], v[188:191], v[20:23], v[52:55]
    v_cvt_pk_bf16_f32 v13, v24, v24
    v_and_b32 v56, v13, v4
    v_and_b32 v57, v13, v5
    v_and_b32 v58, v13, v6
    v_and_b32 v59, v13, v7
    v_add_f32 v38, v38, v24
    v_cvt_pk_bf16_f32 v13, v26, v26
    v_mfma_f32_16x16x32_bf16 v[32:35], a[16:19], v[56:59], v[32:35]
    v_and_b32 v56, v13, v4
    v_and_b32 v57, v13, v5
    v_and_b32 v58, v13, v6
    v_and_b32 v59, v13, v7
    v_add_f32 v38, v38, v26
    v_cvt_pk_bf16_f32 v13, v28, v28
    v_mfma_f32_16x16x32_bf16 v[32:35], a[20:23], v[56:59], v[32:35]
    v_and_b32 v56, v13, v4
    v_and_b32 v57, v13, v5
    v_and_b32 v58, v13, v6
    v_and_b32 v59, v13, v7
    v_add_f32 v38, v38, v28
    v_cvt_pk_bf16_f32 v13, v30, v30
    v_mfma_f32_16x16x32_bf16 v[32:35], a[24:27], v[56:59], v[32:35]
    v_and_b32 v56, v13, v4
    v_and_b32 v57, v13, v5
    v_and_b32 v58, v13, v6
    v_and_b32 v59, v13, v7
    v_add_f32 v38, v38, v30
    s_nop 0
    v_mfma_f32_16x16x32_bf16 v[32:35], a[28:31], v[56:59], v[32:35]
    v_mul_f32_dpp v48, v48, v81 quad_perm:[0,0,2,2] row_mask:0xf bank_mask:0xf
    v_mul_f32_dpp v50, v50, v81 quad_perm:[0,0,2,2] row_mask:0xf bank_mask:0xf
    v_mul_f32_dpp v52, v52, v81 quad_perm:[0,0,2,2] row_mask:0xf bank_mask:0xf
    v_mul_f32_dpp v54, v54, v81 quad_perm:[0,0,2,2] row_mask:0xf bank_mask:0xf
    v_mfma_f32_16x16x32_bf16 v[24:27], v[208:211], v[16:19], v[82:85]
    v_fmac_f32_dpp v48, v49, v81 quad_perm:[1,1,3,3] row_mask:0xf bank_mask:0xf
    v_fmac_f32_dpp v50, v51, v81 quad_perm:[1,1,3,3] row_mask:0xf bank_mask:0xf
    v_fmac_f32_dpp v52, v53, v81 quad_perm:[1,1,3,3] row_mask:0xf bank_mask:0xf
    v_fmac_f32_dpp v54, v55, v81 quad_perm:[1,1,3,3] row_mask:0xf bank_mask:0xf
    v_mfma_f32_16x16x32_bf16 v[28:31], v[216:219], v[16:19], v[82:85]
    v_exp_f32 v48, v48
    v_exp_f32 v50, v50
    v_mfma_f32_16x16x32_bf16 v[24:27], v[212:215], v[20:23], v[24:27]
    v_exp_f32 v52, v52
    v_exp_f32 v54, v54
    v_mfma_f32_16x16x32_bf16 v[28:31], v[220:223], v[20:23], v[28:31]
    v_cvt_pk_bf16_f32 v13, v48, v48
    v_and_b32 v56, v13, v4
    v_and_b32 v57, v13, v5
    v_and_b32 v58, v13, v6
    v_and_b32 v59, v13, v7
    v_add_f32 v38, v38, v48
    v_cvt_pk_bf16_f32 v13, v50, v50
    v_mfma_f32_16x16x32_bf16 v[32:35], v[192:195], v[56:59], v[32:35]
    v_and_b32 v56, v13, v4
    v_and_b32 v57, v13, v5
    v_and_b32 v58, v13, v6
    v_and_b32 v59, v13, v7
    v_add_f32 v38, v38, v50
    v_cvt_pk_bf16_f32 v13, v52, v52
    v_mfma_f32_16x16x32_bf16 v[32:35], v[196:199], v[56:59], v[32:35]
    v_and_b32 v56, v13, v4
    v_and_b32 v57, v13, v5
    v_and_b32 v58, v13, v6
    v_and_b32 v59, v13, v7
    v_add_f32 v38, v38, v52
    v_cvt_pk_bf16_f32 v13, v54, v54
    v_mfma_f32_16x16x32_bf16 v[32:35], v[200:203], v[56:59], v[32:35]
    v_and_b32 v56, v13, v4
    v_and_b32 v57, v13, v5
    v_and_b32 v58, v13, v6
    v_and_b32 v59, v13, v7
    v_add_f32 v38, v38, v54
    s_nop 0
    v_mfma_f32_16x16x32_bf16 v[32:35], v[204:207], v[56:59], v[32:35]
    v_mul_f32_dpp v24, v24, v81 quad_perm:[0,0,2,2] row_mask:0xf bank_mask:0xf
    v_mul_f32_dpp v26, v26, v81 quad_perm:[0,0,2,2] row_mask:0xf bank_mask:0xf
    v_mul_f32_dpp v28, v28, v81 quad_perm:[0,0,2,2] row_mask:0xf bank_mask:0xf
    v_mul_f32_dpp v30, v30, v81 quad_perm:[0,0,2,2] row_mask:0xf bank_mask:0xf
    v_fmac_f32_dpp v24, v25, v81 quad_perm:[1,1,3,3] row_mask:0xf bank_mask:0xf
    v_fmac_f32_dpp v26, v27, v81 quad_perm:[1,1,3,3] row_mask:0xf bank_mask:0xf
    v_fmac_f32_dpp v28, v29, v81 quad_perm:[1,1,3,3] row_mask:0xf bank_mask:0xf
    v_fmac_f32_dpp v30, v31, v81 quad_perm:[1,1,3,3] row_mask:0xf bank_mask:0xf
    v_exp_f32 v24, v24
    v_exp_f32 v26, v26
    v_exp_f32 v28, v28
    v_exp_f32 v30, v30
    v_cvt_pk_bf16_f32 v13, v24, v24
    v_and_b32 v56, v13, v4
    v_and_b32 v57, v13, v5
    v_and_b32 v58, v13, v6
    v_and_b32 v59, v13, v7
    v_add_f32 v38, v38, v24
    v_cvt_pk_bf16_f32 v13, v26, v26
    v_mfma_f32_16x16x32_bf16 v[32:35], v[224:227], v[56:59], v[32:35]
    v_and_b32 v56, v13, v4
    v_and_b32 v57, v13, v5
    v_and_b32 v58, v13, v6
    v_and_b32 v59, v13, v7
    v_add_f32 v38, v38, v26
    v_cvt_pk_bf16_f32 v13, v28, v28
    v_mfma_f32_16x16x32_bf16 v[32:35], v[228:231], v[56:59], v[32:35]
    v_and_b32 v56, v13, v4
    v_and_b32 v57, v13, v5
    v_and_b32 v58, v13, v6
    v_and_b32 v59, v13, v7
    v_add_f32 v38, v38, v28
    v_cvt_pk_bf16_f32 v13, v30, v30
    v_mfma_f32_16x16x32_bf16 v[32:35], v[232:235], v[56:59], v[32:35]
    v_and_b32 v56, v13, v4
    v_and_b32 v57, v13, v5
    v_and_b32 v58, v13, v6
    v_and_b32 v59, v13, v7
    v_add_f32 v38, v38, v30
    s_nop 0
    v_mfma_f32_16x16x32_bf16 v[32:35], v[236:239], v[56:59], v[32:35]
    v_cmp_ngt_f32 vcc, 0x47800000, v38
    s_cbranch_vccnz FB_112
FR_113:
    s_mov_b32 s81, 3
    s_mov_b32 s82, 1
    s_mov_b32 s83, 11520
    s_mov_b32 s84, 0x30000
    s_mov_b32 s85, 14848
    s_mov_b32 s101, 13824
    s_call_b64 s[30:31], F_comb
    s_cmp_ge_u32 s2, 192
    s_cbranch_scc1 L_end
    s_sleep 4
    s_call_b64 s[30:31], F_woi
    s_waitcnt vmcnt(0)
    s_call_b64 s[30:31], F_wof
    s_sleep 22
    s_call_b64 s[30:31], F_g4i
    s_waitcnt vmcnt(12)
    s_call_b64 s[30:31], F_up
    s_waitcnt vmcnt(0)
    s_call_b64 s[30:31], F_xc
    s_call_b64 s[30:31], F_xf
L_end:
    s_endpgm
F_qstage:
    v_lshl_add_u32 v12, v0, 3, s85
    v_lshl_add_u32 v13, v0, 1, s85
    s_add_u32 s29, s85, s100
    v_lshrrev_b32 v102, 4, v0
    v_lshl_add_u32 v14, v102, 4, s29
CK_4:
    v_pk_add_f32 v[100:101], v[80:81], v[82:83]
    v_pk_add_f32 v[90:91], v[84:85], v[86:87]
    v_pk_add_f32 v[100:101], v[100:101], v[90:91]
    v_add_f32 v100, v100, v88
    v_add_f32 v100, v100, v101
    v_cmp_u_f32 vcc, v100, v100
    s_cbranch_vccnz RT_5
CT_6:
    s_nop 1
    v_add_f32_dpp v100, v100, v100 row_ror:8 row_mask:0xf bank_mask:0xf
    s_nop 1
    v_add_f32_dpp v100, v100, v100 row_ror:4 row_mask:0xf bank_mask:0xf
    s_nop 1
    v_add_f32_dpp v100, v100, v100 row_ror:2 row_mask:0xf bank_mask:0xf
    s_nop 1
    v_add_f32_dpp v100, v100, v100 row_ror:1 row_mask:0xf bank_mask:0xf
    v_mov_b32 v102, v100
    s_nop 1
    v_permlane16_swap_b32 v100, v102
    v_add_f32 v100, v100, v102
    v_mov_b32 v102, v100
    s_nop 1
    v_permlane32_swap_b32 v100, v102
    v_add_f32 v100, v100, v102
    v_mul_f32 v100, 0x3ae38e39, v100
    v_pk_add_f32 v[90:91], v[80:81], v[100:101] op_sel_hi:[1,0] neg_lo:[0,1] neg_hi:[0,1]
    v_pk_add_f32 v[92:93], v[82:83], v[100:101] op_sel_hi:[1,0] neg_lo:[0,1] neg_hi:[0,1]
    v_pk_add_f32 v[94:95], v[84:85], v[100:101] op_sel_hi:[1,0] neg_lo:[0,1] neg_hi:[0,1]
    v_pk_add_f32 v[96:97], v[86:87], v[100:101] op_sel_hi:[1,0] neg_lo:[0,1] neg_hi:[0,1]
    v_sub_f32 v98, v88, v100
    v_pk_mul_f32 v[90:91], v[90:91], v[90:91]
    v_mul_f32 v101, v98, v98
    v_pk_fma_f32 v[90:91], v[92:93], v[92:93], v[90:91]
    v_pk_fma_f32 v[90:91], v[94:95], v[94:95], v[90:91]
    v_pk_fma_f32 v[90:91], v[96:97], v[96:97], v[90:91]
    v_add_f32 v101, v101, v90
    v_add_f32 v101, v101, v91
    s_nop 1
    v_add_f32_dpp v101, v101, v101 row_ror:8 row_mask:0xf bank_mask:0xf
    s_nop 1
    v_add_f32_dpp v101, v101, v101 row_ror:4 row_mask:0xf bank_mask:0xf
    s_nop 1
    v_add_f32_dpp v101, v101, v101 row_ror:2 row_mask:0xf bank_mask:0xf
    s_nop 1
    v_add_f32_dpp v101, v101, v101 row_ror:1 row_mask:0xf bank_mask:0xf
    v_mov_b32 v102, v101
    s_nop 1
    v_permlane16_swap_b32 v101, v102
    v_add_f32 v101, v101, v102
    v_mov_b32 v102, v101
    s_nop 1
    v_permlane32_swap_b32 v101, v102
    v_add_f32 v101, v101, v102
    v_mul_f32 v101, 0x3ae38e39, v101
    v_cvt_pk_bf16_f32 v102, v100, v101
    v_lshlrev_b32 v100, 16, v102
    v_and_b32 v101, 0xffff0000, v102
    v_add_f32 v101, s90, v101
    v_pk_add_f32 v[90:91], v[80:81], v[100:101] op_sel_hi:[1,0] neg_lo:[0,1] neg_hi:[0,1]
    v_pk_add_f32 v[92:93], v[82:83], v[100:101] op_sel_hi:[1,0] neg_lo:[0,1] neg_hi:[0,1]
    v_pk_add_f32 v[94:95], v[84:85], v[100:101] op_sel_hi:[1,0] neg_lo:[0,1] neg_hi:[0,1]
    v_pk_add_f32 v[96:97], v[86:87], v[100:101] op_sel_hi:[1,0] neg_lo:[0,1] neg_hi:[0,1]
    v_sub_f32 v98, v88, v100
    v_cvt_pk_bf16_f32 v102, v101, v101
    v_lshlrev_b32 v101, 16, v102
    v_sqrt_f32 v101, v101
    v_cvt_pk_bf16_f32 v102, v90, v91
    v_lshlrev_b32 v90, 16, v102
    v_and_b32 v91, 0xffff0000, v102
    v_cvt_pk_bf16_f32 v102, v92, v93
    v_lshlrev_b32 v92, 16, v102
    v_and_b32 v93, 0xffff0000, v102
    v_cvt_pk_bf16_f32 v102, v101, v101
    v_lshlrev_b32 v101, 16, v102
    v_rcp_f32 v101, v101
    v_cvt_pk_bf16_f32 v102, v94, v95
    v_lshlrev_b32 v94, 16, v102
    v_and_b32 v95, 0xffff0000, v102
    v_cvt_pk_bf16_f32 v102, v96, v97
    v_lshlrev_b32 v96, 16, v102
    v_and_b32 v97, 0xffff0000, v102
    v_cvt_pk_bf16_f32 v102, v98, v98
    v_lshlrev_b32 v98, 16, v102
    v_pk_mul_f32 v[90:91], v[90:91], v[100:101] op_sel:[0,1] op_sel_hi:[1,1]
    v_pk_mul_f32 v[92:93], v[92:93], v[100:101] op_sel:[0,1] op_sel_hi:[1,1]
    v_pk_mul_f32 v[94:95], v[94:95], v[100:101] op_sel:[0,1] op_sel_hi:[1,1]
    v_pk_mul_f32 v[96:97], v[96:97], v[100:101] op_sel:[0,1] op_sel_hi:[1,1]
    v_mul_f32 v98, v98, v101
    v_cvt_pk_bf16_f32 v104, v90, v91
    v_cvt_pk_bf16_f32 v105, v92, v93
    v_cvt_pk_bf16_f32 v106, v94, v95
    v_cvt_pk_bf16_f32 v107, v96, v97
    v_cvt_pk_bf16_f32 v108, v98, v98
    ds_write_b64 v12, v[104:105]
    ds_write_b64 v12, v[106:107] offset:512
    ds_write_b16 v13, v108 offset:1024
    s_waitcnt lgkmcnt(0)
    ds_read_b128 v[104:107], v14 offset:0
    ds_read_b128 v[108:111], v14 offset:64
    ds_read_b128 v[112:115], v14 offset:128
    ds_read_b128 v[116:119], v14 offset:192
    ds_read_b128 v[120:123], v14 offset:256
    ds_read_b128 v[124:127], v14 offset:320
    s_add_u32 s29, s72, s84
    s_waitcnt lgkmcnt(5)
    v_mfma_f32_16x16x32_bf16 v[90:93], v[104:107], v[60:63], 0
    s_waitcnt lgkmcnt(4)
    v_mfma_f32_16x16x32_bf16 v[100:103], v[108:111], v[64:67], 0
    s_waitcnt lgkmcnt(3)
    v_mfma_f32_16x16x32_bf16 v[90:93], v[112:115], v[68:71], v[90:93]
    s_waitcnt lgkmcnt(2)
    v_mfma_f32_16x16x32_bf16 v[100:103], v[116:119], v[72:75], v[100:103]
    s_waitcnt lgkmcnt(1)
    v_mfma_f32_16x16x32_bf16 v[90:93], v[120:123], v[76:79], v[90:93]
    s_waitcnt lgkmcnt(0)
    v_mfma_f32_16x16x32_bf16 v[100:103], v[124:127], v[40:43], v[100:103]
    s_mov_b64 exec, 0xffff
    s_nop 6
    v_add_f32 v100, v100, v90
    s_cmp_eq_u32 s89, 0
    s_cbranch_scc1 FS_7
    buffer_store_dword v100, v3, s[12:15], s29 offen
FS_8:
    s_mov_b64 exec, -1
    s_setpc_b64 s[30:31]
F_qgi:
    s_lshl_b32 s69, s25, 12
    s_add_u32 s69, s69, s84
    buffer_load_dwordx4 v[128:131], v8, s[12:15], s69 offen offset:0 sc1
    buffer_load_dwordx4 v[132:135], v8, s[12:15], s69 offen offset:1024 sc1
    buffer_load_dwordx4 v[136:139], v8, s[12:15], s69 offen offset:2048 sc1
    s_setpc_b64 s[30:31]
F_qgf:
    v_lshl_add_u32 v14, v0, 3, s101
CK_13:
    v_pk_add_f32 v[128:129], v[128:129], v[132:133]
    v_pk_add_f32 v[130:131], v[130:131], v[134:135]
    v_pk_add_f32 v[128:129], v[128:129], v[136:137]
    v_pk_add_f32 v[130:131], v[130:131], v[138:139]
    v_cvt_pk_bf16_f32 v12, v128, v129
    v_cvt_pk_bf16_f32 v13, v130, v131
    v_pk_add_f32 v[132:133], v[128:129], v[130:131]
    v_cmp_u_f32 vcc, v132, v133
    s_cbranch_vccnz RT_14
CT_15:
    ds_write_b64 v14, v[12:13]
    v_add_u32 v15, s101, v9
    ds_read_b128 v[16:19], v15 offset:0
    ds_read_b128 v[20:23], v15 offset:128
    v_mov_b32 v32, 0
    v_mov_b32 v33, 0
    v_mov_b32 v34, 0
    v_mov_b32 v35, 0
    v_mov_b32 v36, 0xff800000
    v_mov_b32 v37, 0xff800000
    v_mov_b32 v38, 0
    s_waitcnt lgkmcnt(0)
    s_setpc_b64 s[30:31]
U_v208_v224:
    v_mfma_f32_16x16x32_bf16 v[48:51], v[208:211], v[16:19], 0
    v_mfma_f32_16x16x32_bf16 v[52:55], v[216:219], v[16:19], 0
    v_mfma_f32_16x16x32_bf16 v[48:51], v[212:215], v[20:23], v[48:51]
    v_mfma_f32_16x16x32_bf16 v[52:55], v[220:223], v[20:23], v[52:55]
    s_nop 7
    v_mov_b32_dpp v48, v48 quad_perm:[0,0,2,2] row_mask:0xf bank_mask:0xf
    v_mov_b32_dpp v50, v50 quad_perm:[0,0,2,2] row_mask:0xf bank_mask:0xf
    v_mov_b32_dpp v52, v52 quad_perm:[0,0,2,2] row_mask:0xf bank_mask:0xf
    v_mov_b32_dpp v54, v54 quad_perm:[0,0,2,2] row_mask:0xf bank_mask:0xf
    v_add_f32_dpp v48, v49, v48 quad_perm:[1,1,3,3] row_mask:0xf bank_mask:0xf
    v_add_f32_dpp v50, v51, v50 quad_perm:[1,1,3,3] row_mask:0xf bank_mask:0xf
    v_add_f32_dpp v52, v53, v52 quad_perm:[1,1,3,3] row_mask:0xf bank_mask:0xf
    v_add_f32_dpp v54, v55, v54 quad_perm:[1,1,3,3] row_mask:0xf bank_mask:0xf
    v_max3_f32 v12, v48, v50, v52
    v_max_f32 v12, v12, v54
    v_cmp_gt_f32 vcc, v12, v36
    s_cbranch_vccnz RS_16
RC_17:
    v_fma_f32 v48, v48, s27, -v37
    v_fma_f32 v50, v50, s27, -v37
    v_fma_f32 v52, v52, s27, -v37
    v_fma_f32 v54, v54, s27, -v37
    v_exp_f32 v48, v48
    v_exp_f32 v50, v50
    v_exp_f32 v52, v52
    v_exp_f32 v54, v54
    v_cvt_pk_bf16_f32 v13, v48, v48
    v_and_b32 v56, v13, v4
    v_and_b32 v57, v13, v5
    v_and_b32 v58, v13, v6
    v_and_b32 v59, v13, v7
    v_add_f32 v38, v38, v48
    v_cvt_pk_bf16_f32 v13, v50, v50
    v_mfma_f32_16x16x32_bf16 v[32:35], v[224:227], v[56:59], v[32:35]
    v_and_b32 v56, v13, v4
    v_and_b32 v57, v13, v5
    v_and_b32 v58, v13, v6
    v_and_b32 v59, v13, v7
    v_add_f32 v38, v38, v50
    v_cvt_pk_bf16_f32 v13, v52, v52
    v_mfma_f32_16x16x32_bf16 v[32:35], v[228:231], v[56:59], v[32:35]
    v_and_b32 v56, v13, v4
    v_and_b32 v57, v13, v5
    v_and_b32 v58, v13, v6
    v_and_b32 v59, v13, v7
    v_add_f32 v38, v38, v52
    v_cvt_pk_bf16_f32 v13, v54, v54
    v_mfma_f32_16x16x32_bf16 v[32:35], v[232:235], v[56:59], v[32:35]
    v_and_b32 v56, v13, v4
    v_and_b32 v57, v13, v5
    v_and_b32 v58, v13, v6
    v_and_b32 v59, v13, v7
    v_add_f32 v38, v38, v54
    s_nop 0
    v_mfma_f32_16x16x32_bf16 v[32:35], v[236:239], v[56:59], v[32:35]
    s_setpc_b64 s[30:31]
U_a0_a16:
    v_mfma_f32_16x16x32_bf16 v[48:51], a[0:3], v[16:19], 0
    v_mfma_f32_16x16x32_bf16 v[52:55], a[8:11], v[16:19], 0
    v_mfma_f32_16x16x32_bf16 v[48:51], a[4:7], v[20:23], v[48:51]
    v_mfma_f32_16x16x32_bf16 v[52:55], a[12:15], v[20:23], v[52:55]
    s_nop 7
    v_mov_b32_dpp v48, v48 quad_perm:[0,0,2,2] row_mask:0xf bank_mask:0xf
    v_mov_b32_dpp v50, v50 quad_perm:[0,0,2,2] row_mask:0xf bank_mask:0xf
    v_mov_b32_dpp v52, v52 quad_perm:[0,0,2,2] row_mask:0xf bank_mask:0xf
    v_mov_b32_dpp v54, v54 quad_perm:[0,0,2,2] row_mask:0xf bank_mask:0xf
    v_add_f32_dpp v48, v49, v48 quad_perm:[1,1,3,3] row_mask:0xf bank_mask:0xf
    v_add_f32_dpp v50, v51, v50 quad_perm:[1,1,3,3] row_mask:0xf bank_mask:0xf
    v_add_f32_dpp v52, v53, v52 quad_perm:[1,1,3,3] row_mask:0xf bank_mask:0xf
    v_add_f32_dpp v54, v55, v54 quad_perm:[1,1,3,3] row_mask:0xf bank_mask:0xf
    v_max3_f32 v12, v48, v50, v52
    v_max_f32 v12, v12, v54
    v_cmp_gt_f32 vcc, v12, v36
    s_cbranch_vccnz RS_18
RC_19:
    v_fma_f32 v48, v48, s27, -v37
    v_fma_f32 v50, v50, s27, -v37
    v_fma_f32 v52, v52, s27, -v37
    v_fma_f32 v54, v54, s27, -v37
    v_exp_f32 v48, v48
    v_exp_f32 v50, v50
    v_exp_f32 v52, v52
    v_exp_f32 v54, v54
    v_cvt_pk_bf16_f32 v13, v48, v48
    v_and_b32 v56, v13, v4
    v_and_b32 v57, v13, v5
    v_and_b32 v58, v13, v6
    v_and_b32 v59, v13, v7
    v_add_f32 v38, v38, v48
    v_cvt_pk_bf16_f32 v13, v50, v50
    v_mfma_f32_16x16x32_bf16 v[32:35], a[16:19], v[56:59], v[32:35]
    v_and_b32 v56, v13, v4
    v_and_b32 v57, v13, v5
    v_and_b32 v58, v13, v6
    v_and_b32 v59, v13, v7
    v_add_f32 v38, v38, v50
    v_cvt_pk_bf16_f32 v13, v52, v52
    v_mfma_f32_16x16x32_bf16 v[32:35], a[20:23], v[56:59], v[32:35]
    v_and_b32 v56, v13, v4
    v_and_b32 v57, v13, v5
    v_and_b32 v58, v13, v6
    v_and_b32 v59, v13, v7
    v_add_f32 v38, v38, v52
    v_cvt_pk_bf16_f32 v13, v54, v54
    v_mfma_f32_16x16x32_bf16 v[32:35], a[24:27], v[56:59], v[32:35]
    v_and_b32 v56, v13, v4
    v_and_b32 v57, v13, v5
    v_and_b32 v58, v13, v6
    v_and_b32 v59, v13, v7
    v_add_f32 v38, v38, v54
    s_nop 0
    v_mfma_f32_16x16x32_bf16 v[32:35], a[28:31], v[56:59], v[32:35]
    s_setpc_b64 s[30:31]
U_a32_a48:
    v_mfma_f32_16x16x32_bf16 v[48:51], a[32:35], v[16:19], 0
    v_mfma_f32_16x16x32_bf16 v[52:55], a[40:43], v[16:19], 0
    v_mfma_f32_16x16x32_bf16 v[48:51], a[36:39], v[20:23], v[48:51]
    v_mfma_f32_16x16x32_bf16 v[52:55], a[44:47], v[20:23], v[52:55]
    s_nop 7
    v_mov_b32_dpp v48, v48 quad_perm:[0,0,2,2] row_mask:0xf bank_mask:0xf
    v_mov_b32_dpp v50, v50 quad_perm:[0,0,2,2] row_mask:0xf bank_mask:0xf
    v_mov_b32_dpp v52, v52 quad_perm:[0,0,2,2] row_mask:0xf bank_mask:0xf
    v_mov_b32_dpp v54, v54 quad_perm:[0,0,2,2] row_mask:0xf bank_mask:0xf
    v_add_f32_dpp v48, v49, v48 quad_perm:[1,1,3,3] row_mask:0xf bank_mask:0xf
    v_add_f32_dpp v50, v51, v50 quad_perm:[1,1,3,3] row_mask:0xf bank_mask:0xf
    v_add_f32_dpp v52, v53, v52 quad_perm:[1,1,3,3] row_mask:0xf bank_mask:0xf
    v_add_f32_dpp v54, v55, v54 quad_perm:[1,1,3,3] row_mask:0xf bank_mask:0xf
    v_max3_f32 v12, v48, v50, v52
    v_max_f32 v12, v12, v54
    v_cmp_gt_f32 vcc, v12, v36
    s_cbranch_vccnz RS_20
RC_21:
    v_fma_f32 v48, v48, s27, -v37
    v_fma_f32 v50, v50, s27, -v37
    v_fma_f32 v52, v52, s27, -v37
    v_fma_f32 v54, v54, s27, -v37
    v_exp_f32 v48, v48
    v_exp_f32 v50, v50
    v_exp_f32 v52, v52
    v_exp_f32 v54, v54
    v_cvt_pk_bf16_f32 v13, v48, v48
    v_and_b32 v56, v13, v4
    v_and_b32 v57, v13, v5
    v_and_b32 v58, v13, v6
    v_and_b32 v59, v13, v7
    v_add_f32 v38, v38, v48
    v_cvt_pk_bf16_f32 v13, v50, v50
    v_mfma_f32_16x16x32_bf16 v[32:35], a[48:51], v[56:59], v[32:35]
    v_and_b32 v56, v13, v4
    v_and_b32 v57, v13, v5
    v_and_b32 v58, v13, v6
    v_and_b32 v59, v13, v7
    v_add_f32 v38, v38, v50
    v_cvt_pk_bf16_f32 v13, v52, v52
    v_mfma_f32_16x16x32_bf16 v[32:35], a[52:55], v[56:59], v[32:35]
    v_and_b32 v56, v13, v4
    v_and_b32 v57, v13, v5
    v_and_b32 v58, v13, v6
    v_and_b32 v59, v13, v7
    v_add_f32 v38, v38, v52
    v_cvt_pk_bf16_f32 v13, v54, v54
    v_mfma_f32_16x16x32_bf16 v[32:35], a[56:59], v[56:59], v[32:35]
    v_and_b32 v56, v13, v4
    v_and_b32 v57, v13, v5
    v_and_b32 v58, v13, v6
    v_and_b32 v59, v13, v7
    v_add_f32 v38, v38, v54
    s_nop 0
    v_mfma_f32_16x16x32_bf16 v[32:35], a[60:63], v[56:59], v[32:35]
    s_setpc_b64 s[30:31]
U_a64_a80:
    v_mfma_f32_16x16x32_bf16 v[48:51], a[64:67], v[16:19], 0
    v_mfma_f32_16x16x32_bf16 v[52:55], a[72:75], v[16:19], 0
    v_mfma_f32_16x16x32_bf16 v[48:51], a[68:71], v[20:23], v[48:51]
    v_mfma_f32_16x16x32_bf16 v[52:55], a[76:79], v[20:23], v[52:55]
    s_nop 7
    v_mov_b32_dpp v48, v48 quad_perm:[0,0,2,2] row_mask:0xf bank_mask:0xf
    v_mov_b32_dpp v50, v50 quad_perm:[0,0,2,2] row_mask:0xf bank_mask:0xf
    v_mov_b32_dpp v52, v52 quad_perm:[0,0,2,2] row_mask:0xf bank_mask:0xf
    v_mov_b32_dpp v54, v54 quad_perm:[0,0,2,2] row_mask:0xf bank_mask:0xf
    v_add_f32_dpp v48, v49, v48 quad_perm:[1,1,3,3] row_mask:0xf bank_mask:0xf
    v_add_f32_dpp v50, v51, v50 quad_perm:[1,1,3,3] row_mask:0xf bank_mask:0xf
    v_add_f32_dpp v52, v53, v52 quad_perm:[1,1,3,3] row_mask:0xf bank_mask:0xf
    v_add_f32_dpp v54, v55, v54 quad_perm:[1,1,3,3] row_mask:0xf bank_mask:0xf
    v_max3_f32 v12, v48, v50, v52
    v_max_f32 v12, v12, v54
    v_cmp_gt_f32 vcc, v12, v36
    s_cbranch_vccnz RS_22
RC_23:
    v_fma_f32 v48, v48, s27, -v37
    v_fma_f32 v50, v50, s27, -v37
    v_fma_f32 v52, v52, s27, -v37
    v_fma_f32 v54, v54, s27, -v37
    v_exp_f32 v48, v48
    v_exp_f32 v50, v50
    v_exp_f32 v52, v52
    v_exp_f32 v54, v54
    v_cvt_pk_bf16_f32 v13, v48, v48
    v_and_b32 v56, v13, v4
    v_and_b32 v57, v13, v5
    v_and_b32 v58, v13, v6
    v_and_b32 v59, v13, v7
    v_add_f32 v38, v38, v48
    v_cvt_pk_bf16_f32 v13, v50, v50
    v_mfma_f32_16x16x32_bf16 v[32:35], a[80:83], v[56:59], v[32:35]
    v_and_b32 v56, v13, v4
    v_and_b32 v57, v13, v5
    v_and_b32 v58, v13, v6
    v_and_b32 v59, v13, v7
    v_add_f32 v38, v38, v50
    v_cvt_pk_bf16_f32 v13, v52, v52
    v_mfma_f32_16x16x32_bf16 v[32:35], a[84:87], v[56:59], v[32:35]
    v_and_b32 v56, v13, v4
    v_and_b32 v57, v13, v5
    v_and_b32 v58, v13, v6
    v_and_b32 v59, v13, v7
    v_add_f32 v38, v38, v52
    v_cvt_pk_bf16_f32 v13, v54, v54
    v_mfma_f32_16x16x32_bf16 v[32:35], a[88:91], v[56:59], v[32:35]
    v_and_b32 v56, v13, v4
    v_and_b32 v57, v13, v5
    v_and_b32 v58, v13, v6
    v_and_b32 v59, v13, v7
    v_add_f32 v38, v38, v54
    s_nop 0
    v_mfma_f32_16x16x32_bf16 v[32:35], a[92:95], v[56:59], v[32:35]
    s_setpc_b64 s[30:31]
U_a96_a112:
    v_mfma_f32_16x16x32_bf16 v[48:51], a[96:99], v[16:19], 0
    v_mfma_f32_16x16x32_bf16 v[52:55], a[104:107], v[16:19], 0
    v_mfma_f32_16x16x32_bf16 v[48:51], a[100:103], v[20:23], v[48:51]
    v_mfma_f32_16x16x32_bf16 v[52:55], a[108:111], v[20:23], v[52:55]
    s_nop 7
    v_mov_b32_dpp v48, v48 quad_perm:[0,0,2,2] row_mask:0xf bank_mask:0xf
    v_mov_b32_dpp v50, v50 quad_perm:[0,0,2,2] row_mask:0xf bank_mask:0xf
    v_mov_b32_dpp v52, v52 quad_perm:[0,0,2,2] row_mask:0xf bank_mask:0xf
    v_mov_b32_dpp v54, v54 quad_perm:[0,0,2,2] row_mask:0xf bank_mask:0xf
    v_add_f32_dpp v48, v49, v48 quad_perm:[1,1,3,3] row_mask:0xf bank_mask:0xf
    v_add_f32_dpp v50, v51, v50 quad_perm:[1,1,3,3] row_mask:0xf bank_mask:0xf
    v_add_f32_dpp v52, v53, v52 quad_perm:[1,1,3,3] row_mask:0xf bank_mask:0xf
    v_add_f32_dpp v54, v55, v54 quad_perm:[1,1,3,3] row_mask:0xf bank_mask:0xf
    v_max3_f32 v12, v48, v50, v52
    v_max_f32 v12, v12, v54
    v_cmp_gt_f32 vcc, v12, v36
    s_cbranch_vccnz RS_24
RC_25:
    v_fma_f32 v48, v48, s27, -v37
    v_fma_f32 v50, v50, s27, -v37
    v_fma_f32 v52, v52, s27, -v37
    v_fma_f32 v54, v54, s27, -v37
    v_exp_f32 v48, v48
    v_exp_f32 v50, v50
    v_exp_f32 v52, v52
    v_exp_f32 v54, v54
    v_cvt_pk_bf16_f32 v13, v48, v48
    v_and_b32 v56, v13, v4
    v_and_b32 v57, v13, v5
    v_and_b32 v58, v13, v6
    v_and_b32 v59, v13, v7
    v_add_f32 v38, v38, v48
    v_cvt_pk_bf16_f32 v13, v50, v50
    v_mfma_f32_16x16x32_bf16 v[32:35], a[112:115], v[56:59], v[32:35]
    v_and_b32 v56, v13, v4
    v_and_b32 v57, v13, v5
    v_and_b32 v58, v13, v6
    v_and_b32 v59, v13, v7
    v_add_f32 v38, v38, v50
    v_cvt_pk_bf16_f32 v13, v52, v52
    v_mfma_f32_16x16x32_bf16 v[32:35], a[116:119], v[56:59], v[32:35]
    v_and_b32 v56, v13, v4
    v_and_b32 v57, v13, v5
    v_and_b32 v58, v13, v6
    v_and_b32 v59, v13, v7
    v_add_f32 v38, v38, v52
    v_cvt_pk_bf16_f32 v13, v54, v54
    v_mfma_f32_16x16x32_bf16 v[32:35], a[120:123], v[56:59], v[32:35]
    v_and_b32 v56, v13, v4
    v_and_b32 v57, v13, v5
    v_and_b32 v58, v13, v6
    v_and_b32 v59, v13, v7
    v_add_f32 v38, v38, v54
    s_nop 0
    v_mfma_f32_16x16x32_bf16 v[32:35], a[124:127], v[56:59], v[32:35]
    s_setpc_b64 s[30:31]
U_a128_a144:
    v_mfma_f32_16x16x32_bf16 v[48:51], a[128:131], v[16:19], 0
    v_mfma_f32_16x16x32_bf16 v[52:55], a[136:139], v[16:19], 0
    v_mfma_f32_16x16x32_bf16 v[48:51], a[132:135], v[20:23], v[48:51]
    v_mfma_f32_16x16x32_bf16 v[52:55], a[140:143], v[20:23], v[52:55]
    s_nop 7
    v_mov_b32_dpp v48, v48 quad_perm:[0,0,2,2] row_mask:0xf bank_mask:0xf
    v_mov_b32_dpp v50, v50 quad_perm:[0,0,2,2] row_mask:0xf bank_mask:0xf
    v_mov_b32_dpp v52, v52 quad_perm:[0,0,2,2] row_mask:0xf bank_mask:0xf
    v_mov_b32_dpp v54, v54 quad_perm:[0,0,2,2] row_mask:0xf bank_mask:0xf
    v_add_f32_dpp v48, v49, v48 quad_perm:[1,1,3,3] row_mask:0xf bank_mask:0xf
    v_add_f32_dpp v50, v51, v50 quad_perm:[1,1,3,3] row_mask:0xf bank_mask:0xf
    v_add_f32_dpp v52, v53, v52 quad_perm:[1,1,3,3] row_mask:0xf bank_mask:0xf
    v_add_f32_dpp v54, v55, v54 quad_perm:[1,1,3,3] row_mask:0xf bank_mask:0xf
    v_max3_f32 v12, v48, v50, v52
    v_max_f32 v12, v12, v54
    v_cmp_gt_f32 vcc, v12, v36
    s_cbranch_vccnz RS_26
RC_27:
    v_fma_f32 v48, v48, s27, -v37
    v_fma_f32 v50, v50, s27, -v37
    v_fma_f32 v52, v52, s27, -v37
    v_fma_f32 v54, v54, s27, -v37
    v_exp_f32 v48, v48
    v_exp_f32 v50, v50
    v_exp_f32 v52, v52
    v_exp_f32 v54, v54
    v_cvt_pk_bf16_f32 v13, v48, v48
    v_and_b32 v56, v13, v4
    v_and_b32 v57, v13, v5
    v_and_b32 v58, v13, v6
    v_and_b32 v59, v13, v7
    v_add_f32 v38, v38, v48
    v_cvt_pk_bf16_f32 v13, v50, v50
    v_mfma_f32_16x16x32_bf16 v[32:35], a[144:147], v[56:59], v[32:35]
    v_and_b32 v56, v13, v4
    v_and_b32 v57, v13, v5
    v_and_b32 v58, v13, v6
    v_and_b32 v59, v13, v7
    v_add_f32 v38, v38, v50
    v_cvt_pk_bf16_f32 v13, v52, v52
    v_mfma_f32_16x16x32_bf16 v[32:35], a[148:151], v[56:59], v[32:35]
    v_and_b32 v56, v13, v4
    v_and_b32 v57, v13, v5
    v_and_b32 v58, v13, v6
    v_and_b32 v59, v13, v7
    v_add_f32 v38, v38, v52
    v_cvt_pk_bf16_f32 v13, v54, v54
    v_mfma_f32_16x16x32_bf16 v[32:35], a[152:155], v[56:59], v[32:35]
    v_and_b32 v56, v13, v4
    v_and_b32 v57, v13, v5
    v_and_b32 v58, v13, v6
    v_and_b32 v59, v13, v7
    v_add_f32 v38, v38, v54
    s_nop 0
    v_mfma_f32_16x16x32_bf16 v[32:35], a[156:159], v[56:59], v[32:35]
    s_setpc_b64 s[30:31]
U_a160_a176:
    v_mfma_f32_16x16x32_bf16 v[48:51], a[160:163], v[16:19], 0
    v_mfma_f32_16x16x32_bf16 v[52:55], a[168:171], v[16:19], 0
    v_mfma_f32_16x16x32_bf16 v[48:51], a[164:167], v[20:23], v[48:51]
    v_mfma_f32_16x16x32_bf16 v[52:55], a[172:175], v[20:23], v[52:55]
    s_nop 7
    v_mov_b32_dpp v48, v48 quad_perm:[0,0,2,2] row_mask:0xf bank_mask:0xf
    v_mov_b32_dpp v50, v50 quad_perm:[0,0,2,2] row_mask:0xf bank_mask:0xf
    v_mov_b32_dpp v52, v52 quad_perm:[0,0,2,2] row_mask:0xf bank_mask:0xf
    v_mov_b32_dpp v54, v54 quad_perm:[0,0,2,2] row_mask:0xf bank_mask:0xf
    v_add_f32_dpp v48, v49, v48 quad_perm:[1,1,3,3] row_mask:0xf bank_mask:0xf
    v_add_f32_dpp v50, v51, v50 quad_perm:[1,1,3,3] row_mask:0xf bank_mask:0xf
    v_add_f32_dpp v52, v53, v52 quad_perm:[1,1,3,3] row_mask:0xf bank_mask:0xf
    v_add_f32_dpp v54, v55, v54 quad_perm:[1,1,3,3] row_mask:0xf bank_mask:0xf
    v_max3_f32 v12, v48, v50, v52
    v_max_f32 v12, v12, v54
    v_cmp_gt_f32 vcc, v12, v36
    s_cbranch_vccnz RS_28
RC_29:
    v_fma_f32 v48, v48, s27, -v37
    v_fma_f32 v50, v50, s27, -v37
    v_fma_f32 v52, v52, s27, -v37
    v_fma_f32 v54, v54, s27, -v37
    v_exp_f32 v48, v48
    v_exp_f32 v50, v50
    v_exp_f32 v52, v52
    v_exp_f32 v54, v54
    v_cvt_pk_bf16_f32 v13, v48, v48
    v_and_b32 v56, v13, v4
    v_and_b32 v57, v13, v5
    v_and_b32 v58, v13, v6
    v_and_b32 v59, v13, v7
    v_add_f32 v38, v38, v48
    v_cvt_pk_bf16_f32 v13, v50, v50
    v_mfma_f32_16x16x32_bf16 v[32:35], a[176:179], v[56:59], v[32:35]
    v_and_b32 v56, v13, v4
    v_and_b32 v57, v13, v5
    v_and_b32 v58, v13, v6
    v_and_b32 v59, v13, v7
    v_add_f32 v38, v38, v50
    v_cvt_pk_bf16_f32 v13, v52, v52
    v_mfma_f32_16x16x32_bf16 v[32:35], a[180:183], v[56:59], v[32:35]
    v_and_b32 v56, v13, v4
    v_and_b32 v57, v13, v5
    v_and_b32 v58, v13, v6
    v_and_b32 v59, v13, v7
    v_add_f32 v38, v38, v52
    v_cvt_pk_bf16_f32 v13, v54, v54
    v_mfma_f32_16x16x32_bf16 v[32:35], a[184:187], v[56:59], v[32:35]
    v_and_b32 v56, v13, v4
    v_and_b32 v57, v13, v5
    v_and_b32 v58, v13, v6
    v_and_b32 v59, v13, v7
    v_add_f32 v38, v38, v54
    s_nop 0
    v_mfma_f32_16x16x32_bf16 v[32:35], a[188:191], v[56:59], v[32:35]
    s_setpc_b64 s[30:31]
U_a192_a208:
    v_mfma_f32_16x16x32_bf16 v[48:51], a[192:195], v[16:19], 0
    v_mfma_f32_16x16x32_bf16 v[52:55], a[200:203], v[16:19], 0
    v_mfma_f32_16x16x32_bf16 v[48:51], a[196:199], v[20:23], v[48:51]
    v_mfma_f32_16x16x32_bf16 v[52:55], a[204:207], v[20:23], v[52:55]
    s_nop 7
    v_mov_b32_dpp v48, v48 quad_perm:[0,0,2,2] row_mask:0xf bank_mask:0xf
    v_mov_b32_dpp v50, v50 quad_perm:[0,0,2,2] row_mask:0xf bank_mask:0xf
    v_mov_b32_dpp v52, v52 quad_perm:[0,0,2,2] row_mask:0xf bank_mask:0xf
    v_mov_b32_dpp v54, v54 quad_perm:[0,0,2,2] row_mask:0xf bank_mask:0xf
    v_add_f32_dpp v48, v49, v48 quad_perm:[1,1,3,3] row_mask:0xf bank_mask:0xf
    v_add_f32_dpp v50, v51, v50 quad_perm:[1,1,3,3] row_mask:0xf bank_mask:0xf
    v_add_f32_dpp v52, v53, v52 quad_perm:[1,1,3,3] row_mask:0xf bank_mask:0xf
    v_add_f32_dpp v54, v55, v54 quad_perm:[1,1,3,3] row_mask:0xf bank_mask:0xf
    v_max3_f32 v12, v48, v50, v52
    v_max_f32 v12, v12, v54
    v_cmp_gt_f32 vcc, v12, v36
    s_cbranch_vccnz RS_30
RC_31:
    v_fma_f32 v48, v48, s27, -v37
    v_fma_f32 v50, v50, s27, -v37
    v_fma_f32 v52, v52, s27, -v37
    v_fma_f32 v54, v54, s27, -v37
    v_exp_f32 v48, v48
    v_exp_f32 v50, v50
    v_exp_f32 v52, v52
    v_exp_f32 v54, v54
    v_cvt_pk_bf16_f32 v13, v48, v48
    v_and_b32 v56, v13, v4
    v_and_b32 v57, v13, v5
    v_and_b32 v58, v13, v6
    v_and_b32 v59, v13, v7
    v_add_f32 v38, v38, v48
    v_cvt_pk_bf16_f32 v13, v50, v50
    v_mfma_f32_16x16x32_bf16 v[32:35], a[208:211], v[56:59], v[32:35]
    v_and_b32 v56, v13, v4
    v_and_b32 v57, v13, v5
    v_and_b32 v58, v13, v6
    v_and_b32 v59, v13, v7
    v_add_f32 v38, v38, v50
    v_cvt_pk_bf16_f32 v13, v52, v52
    v_mfma_f32_16x16x32_bf16 v[32:35], a[212:215], v[56:59], v[32:35]
    v_and_b32 v56, v13, v4
    v_and_b32 v57, v13, v5
    v_and_b32 v58, v13, v6
    v_and_b32 v59, v13, v7
    v_add_f32 v38, v38, v52
    v_cvt_pk_bf16_f32 v13, v54, v54
    v_mfma_f32_16x16x32_bf16 v[32:35], a[216:219], v[56:59], v[32:35]
    v_and_b32 v56, v13, v4
    v_and_b32 v57, v13, v5
    v_and_b32 v58, v13, v6
    v_and_b32 v59, v13, v7
    v_add_f32 v38, v38, v54
    s_nop 0
    v_mfma_f32_16x16x32_bf16 v[32:35], a[220:223], v[56:59], v[32:35]
    s_setpc_b64 s[30:31]
U_a224_a240:
    v_mfma_f32_16x16x32_bf16 v[48:51], a[224:227], v[16:19], 0
    v_mfma_f32_16x16x32_bf16 v[52:55], a[232:235], v[16:19], 0
    v_mfma_f32_16x16x32_bf16 v[48:51], a[228:231], v[20:23], v[48:51]
    v_mfma_f32_16x16x32_bf16 v[52:55], a[236:239], v[20:23], v[52:55]
    s_nop 7
    v_mov_b32_dpp v48, v48 quad_perm:[0,0,2,2] row_mask:0xf bank_mask:0xf
    v_mov_b32_dpp v50, v50 quad_perm:[0,0,2,2] row_mask:0xf bank_mask:0xf
    v_mov_b32_dpp v52, v52 quad_perm:[0,0,2,2] row_mask:0xf bank_mask:0xf
    v_mov_b32_dpp v54, v54 quad_perm:[0,0,2,2] row_mask:0xf bank_mask:0xf
    v_add_f32_dpp v48, v49, v48 quad_perm:[1,1,3,3] row_mask:0xf bank_mask:0xf
    v_add_f32_dpp v50, v51, v50 quad_perm:[1,1,3,3] row_mask:0xf bank_mask:0xf
    v_add_f32_dpp v52, v53, v52 quad_perm:[1,1,3,3] row_mask:0xf bank_mask:0xf
    v_add_f32_dpp v54, v55, v54 quad_perm:[1,1,3,3] row_mask:0xf bank_mask:0xf
    v_max3_f32 v12, v48, v50, v52
    v_max_f32 v12, v12, v54
    v_cmp_gt_f32 vcc, v12, v36
    s_cbranch_vccnz RS_32
RC_33:
    v_fma_f32 v48, v48, s27, -v37
    v_fma_f32 v50, v50, s27, -v37
    v_fma_f32 v52, v52, s27, -v37
    v_fma_f32 v54, v54, s27, -v37
    v_exp_f32 v48, v48
    v_exp_f32 v50, v50
    v_exp_f32 v52, v52
    v_exp_f32 v54, v54
    v_cvt_pk_bf16_f32 v13, v48, v48
    v_and_b32 v56, v13, v4
    v_and_b32 v57, v13, v5
    v_and_b32 v58, v13, v6
    v_and_b32 v59, v13, v7
    v_add_f32 v38, v38, v48
    v_cvt_pk_bf16_f32 v13, v50, v50
    v_mfma_f32_16x16x32_bf16 v[32:35], a[240:243], v[56:59], v[32:35]
    v_and_b32 v56, v13, v4
    v_and_b32 v57, v13, v5
    v_and_b32 v58, v13, v6
    v_and_b32 v59, v13, v7
    v_add_f32 v38, v38, v50
    v_cvt_pk_bf16_f32 v13, v52, v52
    v_mfma_f32_16x16x32_bf16 v[32:35], a[244:247], v[56:59], v[32:35]
    v_and_b32 v56, v13, v4
    v_and_b32 v57, v13, v5
    v_and_b32 v58, v13, v6
    v_and_b32 v59, v13, v7
    v_add_f32 v38, v38, v52
    v_cvt_pk_bf16_f32 v13, v54, v54
    v_mfma_f32_16x16x32_bf16 v[32:35], a[248:251], v[56:59], v[32:35]
    v_and_b32 v56, v13, v4
    v_and_b32 v57, v13, v5
    v_and_b32 v58, v13, v6
    v_and_b32 v59, v13, v7
    v_add_f32 v38, v38, v54
    s_nop 0
    v_mfma_f32_16x16x32_bf16 v[32:35], a[252:255], v[56:59], v[32:35]
    s_setpc_b64 s[30:31]
U_a192_v240:
    v_mfma_f32_16x16x32_bf16 v[48:51], a[192:195], v[16:19], 0
    v_mfma_f32_16x16x32_bf16 v[52:55], a[200:203], v[16:19], 0
    v_mfma_f32_16x16x32_bf16 v[48:51], a[196:199], v[20:23], v[48:51]
    v_mfma_f32_16x16x32_bf16 v[52:55], a[204:207], v[20:23], v[52:55]
    s_nop 7
    v_mov_b32_dpp v48, v48 quad_perm:[0,0,2,2] row_mask:0xf bank_mask:0xf
    v_mov_b32_dpp v50, v50 quad_perm:[0,0,2,2] row_mask:0xf bank_mask:0xf
    v_mov_b32_dpp v52, v52 quad_perm:[0,0,2,2] row_mask:0xf bank_mask:0xf
    v_mov_b32_dpp v54, v54 quad_perm:[0,0,2,2] row_mask:0xf bank_mask:0xf
    v_add_f32_dpp v48, v49, v48 quad_perm:[1,1,3,3] row_mask:0xf bank_mask:0xf
    v_add_f32_dpp v50, v51, v50 quad_perm:[1,1,3,3] row_mask:0xf bank_mask:0xf
    v_add_f32_dpp v52, v53, v52 quad_perm:[1,1,3,3] row_mask:0xf bank_mask:0xf
    v_add_f32_dpp v54, v55, v54 quad_perm:[1,1,3,3] row_mask:0xf bank_mask:0xf
    v_max3_f32 v12, v48, v50, v52
    v_max_f32 v12, v12, v54
    v_cmp_gt_f32 vcc, v12, v36
    s_cbranch_vccnz RS_37
RC_38:
    v_fma_f32 v48, v48, s27, -v37
    v_fma_f32 v50, v50, s27, -v37
    v_fma_f32 v52, v52, s27, -v37
    v_fma_f32 v54, v54, s27, -v37
    v_exp_f32 v48, v48
    v_exp_f32 v50, v50
    v_exp_f32 v52, v52
    v_exp_f32 v54, v54
    v_cvt_pk_bf16_f32 v13, v48, v48
    v_and_b32 v56, v13, v4
    v_and_b32 v57, v13, v5
    v_and_b32 v58, v13, v6
    v_and_b32 v59, v13, v7
    v_add_f32 v38, v38, v48
    v_cvt_pk_bf16_f32 v13, v50, v50
    v_mfma_f32_16x16x32_bf16 v[32:35], v[240:243], v[56:59], v[32:35]
    v_and_b32 v56, v13, v4
    v_and_b32 v57, v13, v5
    v_and_b32 v58, v13, v6
    v_and_b32 v59, v13, v7
    v_add_f32 v38, v38, v50
    v_cvt_pk_bf16_f32 v13, v52, v52
    v_mfma_f32_16x16x32_bf16 v[32:35], v[244:247], v[56:59], v[32:35]
    v_and_b32 v56, v13, v4
    v_and_b32 v57, v13, v5
    v_and_b32 v58, v13, v6
    v_and_b32 v59, v13, v7
    v_add_f32 v38, v38, v52
    v_cvt_pk_bf16_f32 v13, v54, v54
    v_mfma_f32_16x16x32_bf16 v[32:35], v[248:251], v[56:59], v[32:35]
    v_and_b32 v56, v13, v4
    v_and_b32 v57, v13, v5
    v_and_b32 v58, v13, v6
    v_and_b32 v59, v13, v7
    v_add_f32 v38, v38, v54
    s_nop 0
    v_mfma_f32_16x16x32_bf16 v[32:35], v[252:255], v[56:59], v[32:35]
    s_setpc_b64 s[30:31]
U_v176_v192:
    v_mfma_f32_16x16x32_bf16 v[48:51], v[176:179], v[16:19], 0
    v_mfma_f32_16x16x32_bf16 v[52:55], v[184:187], v[16:19], 0
    v_mfma_f32_16x16x32_bf16 v[48:51], v[180:183], v[20:23], v[48:51]
    v_mfma_f32_16x16x32_bf16 v[52:55], v[188:191], v[20:23], v[52:55]
    s_nop 7
    v_mov_b32_dpp v48, v48 quad_perm:[0,0,2,2] row_mask:0xf bank_mask:0xf
    v_mov_b32_dpp v50, v50 quad_perm:[0,0,2,2] row_mask:0xf bank_mask:0xf
    v_mov_b32_dpp v52, v52 quad_perm:[0,0,2,2] row_mask:0xf bank_mask:0xf
    v_mov_b32_dpp v54, v54 quad_perm:[0,0,2,2] row_mask:0xf bank_mask:0xf
    v_add_f32_dpp v48, v49, v48 quad_perm:[1,1,3,3] row_mask:0xf bank_mask:0xf
    v_add_f32_dpp v50, v51, v50 quad_perm:[1,1,3,3] row_mask:0xf bank_mask:0xf
    v_add_f32_dpp v52, v53, v52 quad_perm:[1,1,3,3] row_mask:0xf bank_mask:0xf
    v_add_f32_dpp v54, v55, v54 quad_perm:[1,1,3,3] row_mask:0xf bank_mask:0xf
    v_max3_f32 v12, v48, v50, v52
    v_max_f32 v12, v12, v54
    v_cmp_gt_f32 vcc, v12, v36
    s_cbranch_vccnz RS_39
RC_40:
    v_fma_f32 v48, v48, s27, -v37
    v_fma_f32 v50, v50, s27, -v37
    v_fma_f32 v52, v52, s27, -v37
    v_fma_f32 v54, v54, s27, -v37
    v_exp_f32 v48, v48
    v_exp_f32 v50, v50
    v_exp_f32 v52, v52
    v_exp_f32 v54, v54
    v_cvt_pk_bf16_f32 v13, v48, v48
    v_and_b32 v56, v13, v4
    v_and_b32 v57, v13, v5
    v_and_b32 v58, v13, v6
    v_and_b32 v59, v13, v7
    v_add_f32 v38, v38, v48
    v_cvt_pk_bf16_f32 v13, v50, v50
    v_mfma_f32_16x16x32_bf16 v[32:35], v[192:195], v[56:59], v[32:35]
    v_and_b32 v56, v13, v4
    v_and_b32 v57, v13, v5
    v_and_b32 v58, v13, v6
    v_and_b32 v59, v13, v7
    v_add_f32 v38, v38, v50
    v_cvt_pk_bf16_f32 v13, v52, v52
    v_mfma_f32_16x16x32_bf16 v[32:35], v[196:199], v[56:59], v[32:35]
    v_and_b32 v56, v13, v4
    v_and_b32 v57, v13, v5
    v_and_b32 v58, v13, v6
    v_and_b32 v59, v13, v7
    v_add_f32 v38, v38, v52
    v_cvt_pk_bf16_f32 v13, v54, v54
    v_mfma_f32_16x16x32_bf16 v[32:35], v[200:203], v[56:59], v[32:35]
    v_and_b32 v56, v13, v4
    v_and_b32 v57, v13, v5
    v_and_b32 v58, v13, v6
    v_and_b32 v59, v13, v7
    v_add_f32 v38, v38, v54
    s_nop 0
    v_mfma_f32_16x16x32_bf16 v[32:35], v[204:207], v[56:59], v[32:35]
    s_setpc_b64 s[30:31]
U_v144_v160:
    v_mfma_f32_16x16x32_bf16 v[48:51], v[144:147], v[16:19], 0
    v_mfma_f32_16x16x32_bf16 v[52:55], v[152:155], v[16:19], 0
    v_mfma_f32_16x16x32_bf16 v[48:51], v[148:151], v[20:23], v[48:51]
    v_mfma_f32_16x16x32_bf16 v[52:55], v[156:159], v[20:23], v[52:55]
    s_nop 7
    v_mov_b32_dpp v48, v48 quad_perm:[0,0,2,2] row_mask:0xf bank_mask:0xf
    v_mov_b32_dpp v50, v50 quad_perm:[0,0,2,2] row_mask:0xf bank_mask:0xf
    v_mov_b32_dpp v52, v52 quad_perm:[0,0,2,2] row_mask:0xf bank_mask:0xf
    v_mov_b32_dpp v54, v54 quad_perm:[0,0,2,2] row_mask:0xf bank_mask:0xf
    v_add_f32_dpp v48, v49, v48 quad_perm:[1,1,3,3] row_mask:0xf bank_mask:0xf
    v_add_f32_dpp v50, v51, v50 quad_perm:[1,1,3,3] row_mask:0xf bank_mask:0xf
    v_add_f32_dpp v52, v53, v52 quad_perm:[1,1,3,3] row_mask:0xf bank_mask:0xf
    v_add_f32_dpp v54, v55, v54 quad_perm:[1,1,3,3] row_mask:0xf bank_mask:0xf
    v_max3_f32 v12, v48, v50, v52
    v_max_f32 v12, v12, v54
    v_cmp_gt_f32 vcc, v12, v36
    s_cbranch_vccnz RS_41
RC_42:
    v_fma_f32 v48, v48, s27, -v37
    v_fma_f32 v50, v50, s27, -v37
    v_fma_f32 v52, v52, s27, -v37
    v_fma_f32 v54, v54, s27, -v37
    v_exp_f32 v48, v48
    v_exp_f32 v50, v50
    v_exp_f32 v52, v52
    v_exp_f32 v54, v54
    v_cvt_pk_bf16_f32 v13, v48, v48
    v_and_b32 v56, v13, v4
    v_and_b32 v57, v13, v5
    v_and_b32 v58, v13, v6
    v_and_b32 v59, v13, v7
    v_add_f32 v38, v38, v48
    v_cvt_pk_bf16_f32 v13, v50, v50
    v_mfma_f32_16x16x32_bf16 v[32:35], v[160:163], v[56:59], v[32:35]
    v_and_b32 v56, v13, v4
    v_and_b32 v57, v13, v5
    v_and_b32 v58, v13, v6
    v_and_b32 v59, v13, v7
    v_add_f32 v38, v38, v50
    v_cvt_pk_bf16_f32 v13, v52, v52
    v_mfma_f32_16x16x32_bf16 v[32:35], v[164:167], v[56:59], v[32:35]
    v_and_b32 v56, v13, v4
    v_and_b32 v57, v13, v5
    v_and_b32 v58, v13, v6
    v_and_b32 v59, v13, v7
    v_add_f32 v38, v38, v52
    v_cvt_pk_bf16_f32 v13, v54, v54
    v_mfma_f32_16x16x32_bf16 v[32:35], v[168:171], v[56:59], v[32:35]
    v_and_b32 v56, v13, v4
    v_and_b32 v57, v13, v5
    v_and_b32 v58, v13, v6
    v_and_b32 v59, v13, v7
    v_add_f32 v38, v38, v54
    s_nop 0
    v_mfma_f32_16x16x32_bf16 v[32:35], v[172:175], v[56:59], v[32:35]
    s_setpc_b64 s[30:31]
F_wow:
    v_lshrrev_b32 v104, 4, v0
    v_lshrrev_b32 v106, 3, v0
    v_lshlrev_b32 v109, 2, v106
    v_mul_u32_u24 v106, 4608, v106
    v_and_b32 v105, 7, v0
    v_lshl_add_u32 v106, v105, 4, v106
    s_add_u32 s29, s80, 0
    buffer_load_dwordx4 v[112:115], v106, s[20:23], s29 offen
    s_add_u32 s29, s80, 36864
    buffer_load_dwordx4 v[116:119], v106, s[20:23], s29 offen
    s_add_u32 s29, s80, 1152
    buffer_load_dwordx4 v[120:123], v106, s[20:23], s29 offen
    s_add_u32 s29, s80, 38016
    buffer_load_dwordx4 v[124:127], v106, s[20:23], s29 offen
    s_add_u32 s29, s80, 2304
    buffer_load_dwordx4 v[128:131], v106, s[20:23], s29 offen
    s_add_u32 s29, s80, 39168
    buffer_load_dwordx4 v[132:135], v106, s[20:23], s29 offen
    s_add_u32 s29, s80, 3456
    buffer_load_dwordx4 v[136:139], v106, s[20:23], s29 offen
    s_add_u32 s29, s80, 40320
    buffer_load_dwordx4 v[140:143], v106, s[20:23], s29 offen
    v_lshl_add_u32 v110, v104, 5, v105
    s_lshl_b32 s29, s24, 7
    v_add_lshl_u32 v110, v110, s29, 2
    v_lshl_add_u32 v111, v104, 9, v2
    v_bfe_u32 v105, v0, 2, 2
    v_add_u32 v105, v105, v104
    v_and_b32 v105, 3, v105
    v_and_b32 v107, 3, v0
    v_lshl_add_u32 v105, v107, 2, v105
    v_lshlrev_b32 v108, 3, v105
    s_setpc_b64 s[30:31]
F_comb:
    v_mov_b32 v12, v38
    s_nop 1
    v_permlane16_swap_b32 v38, v12
    v_add_f32 v38, v38, v12
    v_mov_b32 v12, v38
    s_nop 1
    v_permlane32_swap_b32 v38, v12
    v_add_f32 v38, v38, v12
    s_lshl_b32 s29, s24, 10
    v_add_u32 v12, s29, v8
    s_lshl_b32 s29, s24, 3
    v_bfe_u32 v13, v0, 3, 1
    v_lshl_add_u32 v13, v13, 5, s29
    v_mov_b32 v14, v37
    v_mov_b32 v15, v38
    ds_write_b128 v12, v[32:35] offset:2304
    ds_write_b64 v13, v[14:15] offset:6400
    s_and_b32 s29, s24, 1
    s_lshl_b32 s29, s29, 9
    s_lshr_b32 s59, s24, 1
    s_lshl_b32 s73, s59, 7
    s_add_u32 s29, s29, s73
    v_lshrrev_b32 v95, 5, v0
    v_lshl_add_u32 v95, v95, 8, s29
    v_and_b32 v94, 7, v0
    v_lshl_add_u32 v95, v94, 4, v95
    v_bfe_u32 v94, v0, 3, 2
    v_lshl_add_u32 v95, v94, 2, v95
    s_lshl_b32 s59, s59, 5
    v_mov_b32 v94, s59
    s_waitcnt lgkmcnt(0)
    s_barrier
    ds_read_b128 v[84:87], v94 offset:6400
    ds_read_b128 v[88:91], v94 offset:6416
    ds_read_b32 v80, v95 offset:2304
    ds_read_b32 v81, v95 offset:3328
    ds_read_b32 v82, v95 offset:4352
    ds_read_b32 v83, v95 offset:5376
    s_lshl_b32 s69, s81, 18
    s_add_u32 s69, s69, s78
    s_lshl_b32 s70, s81, 12
    s_add_u32 s70, s70, s79
    s_lshl_b32 s29, s26, 10
    s_add_u32 s29, s29, s69
    s_lshl_b32 s59, s26, 3
    s_add_u32 s59, s59, s70
    s_waitcnt lgkmcnt(4)
    v_max3_f32 v92, v84, v86, v88
    v_max_f32 v92, v92, v90
    v_sub_f32 v84, v84, v92
    v_sub_f32 v86, v86, v92
    v_sub_f32 v88, v88, v92
    v_sub_f32 v90, v90, v92
    v_exp_f32 v84, v84
    v_exp_f32 v86, v86
    v_exp_f32 v88, v88
    v_exp_f32 v90, v90
    s_waitcnt lgkmcnt(0)
    v_mul_f32 v96, v80, v84
    v_mul_f32 v93, v85, v84
    v_fmac_f32 v96, v81, v86
    v_fmac_f32 v93, v87, v86
    v_fmac_f32 v96, v82, v88
    v_fmac_f32 v93, v89, v88
    v_fmac_f32 v96, v83, v90
    v_fmac_f32 v93, v91, v90
    s_mov_b64 exec, 1
    s_cmp_eq_u32 s89, 0
    s_cbranch_scc1 FS_43
    buffer_store_dwordx2 v[92:93], v3, s[12:15], s59 offen
FS_44:
    s_mov_b64 exec, -1
    s_cmp_eq_u32 s89, 0
    s_cbranch_scc1 FS_45
    buffer_store_dword v96, v3, s[12:15], s29 offen
FS_46:
    s_nop 0
    s_setpc_b64 s[30:31]
F_woi:
    buffer_load_dwordx2 v[96:97], v108, s[12:15], s70 offen sc1
    s_mov_b32 s29, s69
    buffer_load_dwordx4 v[80:83], v111, s[12:15], s29 offen sc1
    s_add_u32 s29, s29, 4096
    buffer_load_dwordx4 v[84:87], v111, s[12:15], s29 offen sc1
    s_add_u32 s29, s29, 4096
    buffer_load_dwordx4 v[88:91], v111, s[12:15], s29 offen sc1
    s_add_u32 s29, s29, 4096
    buffer_load_dwordx4 v[92:95], v111, s[12:15], s29 offen sc1
    s_setpc_b64 s[30:31]
F_wof:
CK_48:
    v_mov_b32 v99, v96
    s_nop 1
    v_max_f32_dpp v99, v99, v99 row_ror:8 row_mask:0xf bank_mask:0xf
    s_nop 1
    v_max_f32_dpp v99, v99, v99 row_ror:4 row_mask:0xf bank_mask:0xf
    s_nop 1
    v_max_f32_dpp v99, v99, v99 row_ror:2 row_mask:0xf bank_mask:0xf
    s_nop 1
    v_max_f32_dpp v99, v99, v99 row_ror:1 row_mask:0xf bank_mask:0xf
    v_sub_f32 v99, v96, v99
    v_exp_f32 v99, v99
    s_nop 0
    v_mul_f32 v100, v99, v97
    v_mul_f32_dpp v104, v99, v80 row_newbcast:0 row_mask:0xf bank_mask:0xf
    v_mul_f32_dpp v105, v99, v81 row_newbcast:0 row_mask:0xf bank_mask:0xf
    v_mul_f32_dpp v106, v99, v82 row_newbcast:0 row_mask:0xf bank_mask:0xf
    v_mul_f32_dpp v107, v99, v83 row_newbcast:0 row_mask:0xf bank_mask:0xf
    v_add_f32_dpp v100, v100, v100 row_ror:8 row_mask:0xf bank_mask:0xf
    v_fmac_f32_dpp v104, v99, v84 row_newbcast:1 row_mask:0xf bank_mask:0xf
    v_fmac_f32_dpp v105, v99, v85 row_newbcast:1 row_mask:0xf bank_mask:0xf
    v_fmac_f32_dpp v106, v99, v86 row_newbcast:1 row_mask:0xf bank_mask:0xf
    v_fmac_f32_dpp v107, v99, v87 row_newbcast:1 row_mask:0xf bank_mask:0xf
    v_add_f32_dpp v100, v100, v100 row_ror:4 row_mask:0xf bank_mask:0xf
    v_fmac_f32_dpp v104, v99, v88 row_newbcast:2 row_mask:0xf bank_mask:0xf
    v_fmac_f32_dpp v105, v99, v89 row_newbcast:2 row_mask:0xf bank_mask:0xf
    v_fmac_f32_dpp v106, v99, v90 row_newbcast:2 row_mask:0xf bank_mask:0xf
    v_fmac_f32_dpp v107, v99, v91 row_newbcast:2 row_mask:0xf bank_mask:0xf
    v_add_f32_dpp v100, v100, v100 row_ror:2 row_mask:0xf bank_mask:0xf
    v_fmac_f32_dpp v104, v99, v92 row_newbcast:3 row_mask:0xf bank_mask:0xf
    v_fmac_f32_dpp v105, v99, v93 row_newbcast:3 row_mask:0xf bank_mask:0xf
    v_fmac_f32_dpp v106, v99, v94 row_newbcast:3 row_mask:0xf bank_mask:0xf
    v_fmac_f32_dpp v107, v99, v95 row_newbcast:3 row_mask:0xf bank_mask:0xf
    v_add_f32_dpp v100, v100, v100 row_ror:1 row_mask:0xf bank_mask:0xf
    v_rcp_f32 v100, v100
    v_permlane32_swap_b32 v104, v106
    v_permlane32_swap_b32 v105, v107
    v_add_f32 v104, v104, v106
    v_add_f32 v105, v105, v107
    s_nop 1
    v_permlane16_swap_b32 v104, v105
    v_add_f32 v104, v104, v105
    v_mul_f32 v104, v104, v100
    v_cmp_u_f32 vcc, v104, v104
    s_cbranch_vccnz RT_49
CT_50:
    v_cvt_pk_bf16_f32 v98, v104, v104
    ds_bpermute_b32 v80, v109, v98 offset:0
    ds_bpermute_b32 v81, v109, v98 offset:32
    ds_bpermute_b32 v82, v109, v98 offset:64
    ds_bpermute_b32 v83, v109, v98 offset:96
    ds_bpermute_b32 v84, v109, v98 offset:128
    ds_bpermute_b32 v85, v109, v98 offset:160
    ds_bpermute_b32 v86, v109, v98 offset:192
    ds_bpermute_b32 v87, v109, v98 offset:224
    s_waitcnt lgkmcnt(7)
    v_and_b32 v88, v80, v4
    v_and_b32 v89, v80, v5
    v_and_b32 v90, v80, v6
    v_and_b32 v91, v80, v7
    s_waitcnt lgkmcnt(6)
    v_and_b32 v92, v81, v4
    v_and_b32 v93, v81, v5
    v_and_b32 v94, v81, v6
    v_and_b32 v95, v81, v7
    v_mfma_f32_16x16x32_bf16 v[104:107], v[112:115], v[88:91], 0
    s_waitcnt lgkmcnt(5)
    v_and_b32 v88, v82, v4
    v_and_b32 v89, v82, v5
    v_and_b32 v90, v82, v6
    v_and_b32 v91, v82, v7
    v_mfma_f32_16x16x32_bf16 v[104:107], v[116:119], v[92:95], v[104:107]
    s_waitcnt lgkmcnt(4)
    v_and_b32 v92, v83, v4
    v_and_b32 v93, v83, v5
    v_and_b32 v94, v83, v6
    v_and_b32 v95, v83, v7
    v_mfma_f32_16x16x32_bf16 v[104:107], v[120:123], v[88:91], v[104:107]
    s_waitcnt lgkmcnt(3)
    v_and_b32 v88, v84, v4
    v_and_b32 v89, v84, v5
    v_and_b32 v90, v84, v6
    v_and_b32 v91, v84, v7
    v_mfma_f32_16x16x32_bf16 v[104:107], v[124:127], v[92:95], v[104:107]
    s_waitcnt lgkmcnt(2)
    v_and_b32 v92, v85, v4
    v_and_b32 v93, v85, v5
    v_and_b32 v94, v85, v6
    v_and_b32 v95, v85, v7
    v_mfma_f32_16x16x32_bf16 v[104:107], v[128:131], v[88:91], v[104:107]
    s_waitcnt lgkmcnt(1)
    v_and_b32 v88, v86, v4
    v_and_b32 v89, v86, v5
    v_and_b32 v90, v86, v6
    v_and_b32 v91, v86, v7
    v_mfma_f32_16x16x32_bf16 v[104:107], v[132:135], v[92:95], v[104:107]
    s_waitcnt lgkmcnt(0)
    v_and_b32 v92, v87, v4
    v_and_b32 v93, v87, v5
    v_and_b32 v94, v87, v6
    v_and_b32 v95, v87, v7
    v_mfma_f32_16x16x32_bf16 v[104:107], v[136:139], v[88:91], v[104:107]
    s_nop 0
    v_mfma_f32_16x16x32_bf16 v[104:107], v[140:143], v[92:95], v[104:107]
    s_mov_b64 exec, s[74:75]
    s_nop 6
    ds_write_b32 v110, v104 offset:0
    ds_write_b32 v110, v105 offset:32
    ds_write_b32 v110, v106 offset:64
    ds_write_b32 v110, v107 offset:96
    s_mov_b64 exec, -1
WS_47:
    s_mul_i32 s29, s24, 2304
    v_add_u32 v12, s29, v8
    v_add_u32 v13, s29, v3
    global_load_dwordx4 v[116:119], v12, s[44:45]
    global_load_dwordx4 v[120:123], v12, s[44:45] offset:1024
    global_load_dword v140, v13, s[44:45] offset:2048
    global_load_dwordx4 v[124:127], v12, s[46:47]
    global_load_dwordx4 v[128:131], v12, s[46:47] offset:1024
    global_load_dword v141, v13, s[46:47] offset:2048
    global_load_dwordx4 v[132:135], v12, s[48:49]
    global_load_dwordx4 v[136:139], v12, s[48:49] offset:1024
    global_load_dword v142, v13, s[48:49] offset:2048
    s_waitcnt lgkmcnt(0)
    s_barrier
    s_mul_i32 s70, s81, 36864
    s_add_u32 s70, s70, 0x44000
    s_mul_i32 s69, s24, 9216
    s_add_u32 s69, s69, s70
    s_cmp_ge_u32 s60, 9
    s_cbranch_scc1 WS_51
    s_cmp_lg_u32 s24, 0
    s_cbranch_scc1 WS_51
    ds_read2st64_b32 v[80:81], v3 offset0:0 offset1:1
    ds_read2st64_b32 v[82:83], v3 offset0:2 offset1:3
    ds_read2st64_b32 v[84:85], v3 offset0:4 offset1:5
    ds_read2st64_b32 v[86:87], v3 offset0:6 offset1:7
    s_mul_i32 s29, s25, 2304
    s_lshl_b32 s59, s60, 8
    s_add_u32 s29, s29, s59
    s_add_u32 s29, s29, s70
    s_waitcnt lgkmcnt(0)
    v_add_f32 v80, v80, v84
    v_add_f32 v81, v81, v85
    v_add_f32 v82, v82, v86
    v_add_f32 v83, v83, v87
    v_add_f32 v80, v80, v81
    v_add_f32 v82, v82, v83
    v_add_f32 v80, v80, v82
    s_nop 1
    v_mov_b32_dpp v81, v80 quad_perm:[1,1,1,1] row_mask:0xf bank_mask:0xf
    v_mov_b32_dpp v82, v80 quad_perm:[2,2,2,2] row_mask:0xf bank_mask:0xf
    v_mov_b32_dpp v83, v80 quad_perm:[3,3,3,3] row_mask:0xf bank_mask:0xf
    s_mov_b64 exec, s[96:97]
    buffer_store_dwordx4 v[80:83], v3, s[12:15], s29 offen sc1
    s_mov_b64 exec, -1
WS_51:
    s_setpc_b64 s[30:31]
F_g4i:
    s_mov_b32 s29, s69
    buffer_load_dwordx4 v[80:83], v8, s[12:15], s29 offen sc1
    buffer_load_dwordx4 v[84:87], v8, s[12:15], s29 offen offset:1024 sc1
    buffer_load_dword v112, v3, s[12:15], s29 offen offset:2048 sc1
    s_add_u32 s29, s29, 2304
    buffer_load_dwordx4 v[88:91], v8, s[12:15], s29 offen sc1
    buffer_load_dwordx4 v[92:95], v8, s[12:15], s29 offen offset:1024 sc1
    buffer_load_dword v113, v3, s[12:15], s29 offen offset:2048 sc1
    s_add_u32 s29, s29, 2304
    buffer_load_dwordx4 v[96:99], v8, s[12:15], s29 offen sc1
    buffer_load_dwordx4 v[100:103], v8, s[12:15], s29 offen offset:1024 sc1
    buffer_load_dword v114, v3, s[12:15], s29 offen offset:2048 sc1
    s_add_u32 s29, s29, 2304
    buffer_load_dwordx4 v[104:107], v8, s[12:15], s29 offen sc1
    buffer_load_dwordx4 v[108:111], v8, s[12:15], s29 offen offset:1024 sc1
    buffer_load_dword v115, v3, s[12:15], s29 offen offset:2048 sc1
    s_setpc_b64 s[30:31]
F_up:
    v_lshlrev_b32 v16, 16, v116
    v_and_b32 v116, 0xffff0000, v116
    v_lshlrev_b32 v17, 16, v117
    v_and_b32 v117, 0xffff0000, v117
    v_lshlrev_b32 v18, 16, v118
    v_and_b32 v118, 0xffff0000, v118
    v_lshlrev_b32 v19, 16, v119
    v_and_b32 v119, 0xffff0000, v119
    v_lshlrev_b32 v20, 16, v120
    v_and_b32 v120, 0xffff0000, v120
    v_lshlrev_b32 v21, 16, v121
    v_and_b32 v121, 0xffff0000, v121
    v_lshlrev_b32 v22, 16, v122
    v_and_b32 v122, 0xffff0000, v122
    v_lshlrev_b32 v23, 16, v123
    v_and_b32 v123, 0xffff0000, v123
    v_lshlrev_b32 v24, 16, v124
    v_and_b32 v124, 0xffff0000, v124
    v_lshlrev_b32 v25, 16, v125
    v_and_b32 v125, 0xffff0000, v125
    v_lshlrev_b32 v26, 16, v126
    v_and_b32 v126, 0xffff0000, v126
    v_lshlrev_b32 v27, 16, v127
    v_and_b32 v127, 0xffff0000, v127
    v_lshlrev_b32 v28, 16, v128
    v_and_b32 v128, 0xffff0000, v128
    v_lshlrev_b32 v29, 16, v129
    v_and_b32 v129, 0xffff0000, v129
    v_lshlrev_b32 v30, 16, v130
    v_and_b32 v130, 0xffff0000, v130
    v_lshlrev_b32 v31, 16, v131
    v_and_b32 v131, 0xffff0000, v131
    v_lshlrev_b32 v44, 16, v132
    v_and_b32 v132, 0xffff0000, v132
    v_lshlrev_b32 v45, 16, v133
    v_and_b32 v133, 0xffff0000, v133
    v_lshlrev_b32 v46, 16, v134
    v_and_b32 v134, 0xffff0000, v134
    v_lshlrev_b32 v47, 16, v135
    v_and_b32 v135, 0xffff0000, v135
    s_setpc_b64 s[30:31]
F_xc:
    v_add_u32 v58, s83, v8
    v_add_u32 v59, s83, v3
    ds_read_b128 v[48:51], v58
    ds_read_b128 v[52:55], v58 offset:1024
    ds_read_b32 v56, v59 offset:2048
    s_mul_i32 s59, s24, 2304
    v_add_u32 v12, s59, v8
    v_add_u32 v13, s59, v3
CK_54:
    v_pk_add_f32 v[80:81], v[80:81], v[88:89]
    v_pk_add_f32 v[96:97], v[96:97], v[104:105]
    v_pk_add_f32 v[82:83], v[82:83], v[90:91]
    v_pk_add_f32 v[98:99], v[98:99], v[106:107]
    v_pk_add_f32 v[84:85], v[84:85], v[92:93]
    v_pk_add_f32 v[100:101], v[100:101], v[108:109]
    v_pk_add_f32 v[86:87], v[86:87], v[94:95]
    v_pk_add_f32 v[102:103], v[102:103], v[110:111]
    v_pk_add_f32 v[112:113], v[112:113], v[114:115]
    v_pk_add_f32 v[80:81], v[80:81], v[96:97]
    v_pk_add_f32 v[82:83], v[82:83], v[98:99]
    v_pk_add_f32 v[84:85], v[84:85], v[100:101]
    v_pk_add_f32 v[86:87], v[86:87], v[102:103]
    v_add_f32 v88, v112, v113
    v_pk_add_f32 v[90:91], v[80:81], v[82:83]
    v_pk_add_f32 v[92:93], v[84:85], v[86:87]
    v_pk_add_f32 v[90:91], v[90:91], v[92:93]
    v_add_f32 v90, v90, v88
    v_cmp_u_f32 vcc, v90, v91
    s_cbranch_vccnz RT_55
CT_56:
    ds_write_b128 v12, v[80:83] offset:0
    ds_write_b128 v12, v[84:87] offset:1024
    ds_write_b32 v13, v88 offset:2048
    s_setpc_b64 s[30:31]
F_yi:
    s_mul_i32 s69, s82, 2304
    s_add_u32 s69, s69, 0x68000
    buffer_load_dwordx4 v[80:83], v8, s[12:15], s69 offen sc1
    buffer_load_dwordx4 v[84:87], v8, s[12:15], s69 offen offset:1024 sc1
    buffer_load_dword v88, v3, s[12:15], s69 offen offset:2048 sc1
    s_setpc_b64 s[30:31]
U_v80_v96:
    v_mfma_f32_16x16x32_bf16 v[48:51], v[80:83], v[16:19], 0
    v_mfma_f32_16x16x32_bf16 v[52:55], v[88:91], v[16:19], 0
    v_mfma_f32_16x16x32_bf16 v[48:51], v[84:87], v[20:23], v[48:51]
    v_mfma_f32_16x16x32_bf16 v[52:55], v[92:95], v[20:23], v[52:55]
    s_nop 7
    v_mov_b32_dpp v48, v48 quad_perm:[0,0,2,2] row_mask:0xf bank_mask:0xf
    v_mov_b32_dpp v50, v50 quad_perm:[0,0,2,2] row_mask:0xf bank_mask:0xf
    v_mov_b32_dpp v52, v52 quad_perm:[0,0,2,2] row_mask:0xf bank_mask:0xf
    v_mov_b32_dpp v54, v54 quad_perm:[0,0,2,2] row_mask:0xf bank_mask:0xf
    v_add_f32_dpp v48, v49, v48 quad_perm:[1,1,3,3] row_mask:0xf bank_mask:0xf
    v_add_f32_dpp v50, v51, v50 quad_perm:[1,1,3,3] row_mask:0xf bank_mask:0xf
    v_add_f32_dpp v52, v53, v52 quad_perm:[1,1,3,3] row_mask:0xf bank_mask:0xf
    v_add_f32_dpp v54, v55, v54 quad_perm:[1,1,3,3] row_mask:0xf bank_mask:0xf
    v_max3_f32 v12, v48, v50, v52
    v_max_f32 v12, v12, v54
    v_cmp_gt_f32 vcc, v12, v36
    s_cbranch_vccnz RS_90
RC_91:
    v_fma_f32 v48, v48, s27, -v37
    v_fma_f32 v50, v50, s27, -v37
    v_fma_f32 v52, v52, s27, -v37
    v_fma_f32 v54, v54, s27, -v37
    v_exp_f32 v48, v48
    v_exp_f32 v50, v50
    v_exp_f32 v52, v52
    v_exp_f32 v54, v54
    v_cvt_pk_bf16_f32 v13, v48, v48
    v_and_b32 v56, v13, v4
    v_and_b32 v57, v13, v5
    v_and_b32 v58, v13, v6
    v_and_b32 v59, v13, v7
    v_add_f32 v38, v38, v48
    v_cvt_pk_bf16_f32 v13, v50, v50
    v_mfma_f32_16x16x32_bf16 v[32:35], v[96:99], v[56:59], v[32:35]
    v_and_b32 v56, v13, v4
    v_and_b32 v57, v13, v5
    v_and_b32 v58, v13, v6
    v_and_b32 v59, v13, v7
    v_add_f32 v38, v38, v50
    v_cvt_pk_bf16_f32 v13, v52, v52
    v_mfma_f32_16x16x32_bf16 v[32:35], v[100:103], v[56:59], v[32:35]
    v_and_b32 v56, v13, v4
    v_and_b32 v57, v13, v5
    v_and_b32 v58, v13, v6
    v_and_b32 v59, v13, v7
    v_add_f32 v38, v38, v52
    v_cvt_pk_bf16_f32 v13, v54, v54
    v_mfma_f32_16x16x32_bf16 v[32:35], v[104:107], v[56:59], v[32:35]
    v_and_b32 v56, v13, v4
    v_and_b32 v57, v13, v5
    v_and_b32 v58, v13, v6
    v_and_b32 v59, v13, v7
    v_add_f32 v38, v38, v54
    s_nop 0
    v_mfma_f32_16x16x32_bf16 v[32:35], v[108:111], v[56:59], v[32:35]
    s_setpc_b64 s[30:31]
U_a224_v240:
    v_mfma_f32_16x16x32_bf16 v[48:51], a[224:227], v[16:19], 0
    v_mfma_f32_16x16x32_bf16 v[52:55], a[232:235], v[16:19], 0
    v_mfma_f32_16x16x32_bf16 v[48:51], a[228:231], v[20:23], v[48:51]
    v_mfma_f32_16x16x32_bf16 v[52:55], a[236:239], v[20:23], v[52:55]
    s_nop 7
    v_mov_b32_dpp v48, v48 quad_perm:[0,0,2,2] row_mask:0xf bank_mask:0xf
    v_mov_b32_dpp v50, v50 quad_perm:[0,0,2,2] row_mask:0xf bank_mask:0xf
    v_mov_b32_dpp v52, v52 quad_perm:[0,0,2,2] row_mask:0xf bank_mask:0xf
    v_mov_b32_dpp v54, v54 quad_perm:[0,0,2,2] row_mask:0xf bank_mask:0xf
    v_add_f32_dpp v48, v49, v48 quad_perm:[1,1,3,3] row_mask:0xf bank_mask:0xf
    v_add_f32_dpp v50, v51, v50 quad_perm:[1,1,3,3] row_mask:0xf bank_mask:0xf
    v_add_f32_dpp v52, v53, v52 quad_perm:[1,1,3,3] row_mask:0xf bank_mask:0xf
    v_add_f32_dpp v54, v55, v54 quad_perm:[1,1,3,3] row_mask:0xf bank_mask:0xf
    v_max3_f32 v12, v48, v50, v52
    v_max_f32 v12, v12, v54
    v_cmp_gt_f32 vcc, v12, v36
    s_cbranch_vccnz RS_96
RC_97:
    v_fma_f32 v48, v48, s27, -v37
    v_fma_f32 v50, v50, s27, -v37
    v_fma_f32 v52, v52, s27, -v37
    v_fma_f32 v54, v54, s27, -v37
    v_exp_f32 v48, v48
    v_exp_f32 v50, v50
    v_exp_f32 v52, v52
    v_exp_f32 v54, v54
    v_cvt_pk_bf16_f32 v13, v48, v48
    v_and_b32 v56, v13, v4
    v_and_b32 v57, v13, v5
    v_and_b32 v58, v13, v6
    v_and_b32 v59, v13, v7
    v_add_f32 v38, v38, v48
    v_cvt_pk_bf16_f32 v13, v50, v50
    v_mfma_f32_16x16x32_bf16 v[32:35], v[240:243], v[56:59], v[32:35]
    v_and_b32 v56, v13, v4
    v_and_b32 v57, v13, v5
    v_and_b32 v58, v13, v6
    v_and_b32 v59, v13, v7
    v_add_f32 v38, v38, v50
    v_cvt_pk_bf16_f32 v13, v52, v52
    v_mfma_f32_16x16x32_bf16 v[32:35], v[244:247], v[56:59], v[32:35]
    v_and_b32 v56, v13, v4
    v_and_b32 v57, v13, v5
    v_and_b32 v58, v13, v6
    v_and_b32 v59, v13, v7
    v_add_f32 v38, v38, v52
    v_cvt_pk_bf16_f32 v13, v54, v54
    v_mfma_f32_16x16x32_bf16 v[32:35], v[248:251], v[56:59], v[32:35]
    v_and_b32 v56, v13, v4
    v_and_b32 v57, v13, v5
    v_and_b32 v58, v13, v6
    v_and_b32 v59, v13, v7
    v_add_f32 v38, v38, v54
    s_nop 0
    v_mfma_f32_16x16x32_bf16 v[32:35], v[252:255], v[56:59], v[32:35]
    s_setpc_b64 s[30:31]
F_xf:
    s_mul_i32 s73, s61, 12
    v_and_b32 v14, 12, v3
    v_add_u32 v14, s73, v14
    v_add_u32 v15, s83, v14
    ds_read_b32 v58, v15
    s_waitcnt lgkmcnt(0)
    s_barrier
    ds_read_b32 v143, v14 offset:0
    ds_read_b32 v12, v14 offset:2304
    ds_read_b32 v13, v14 offset:4608
    ds_read_b32 v15, v14 offset:6912
    ds_read_b128 v[80:83], v8 offset:0
    ds_read_b128 v[84:87], v8 offset:1024
    ds_read_b32 v112, v3 offset:2048
    ds_read_b128 v[88:91], v8 offset:2304
    ds_read_b128 v[92:95], v8 offset:3328
    ds_read_b32 v113, v3 offset:4352
    ds_read_b128 v[96:99], v8 offset:4608
    ds_read_b128 v[100:103], v8 offset:5632
    ds_read_b32 v114, v3 offset:6656
    ds_read_b128 v[104:107], v8 offset:6912
    ds_read_b128 v[108:111], v8 offset:7936
    ds_read_b32 v115, v3 offset:8960
    s_waitcnt lgkmcnt(12)
    v_add_f32 v143, v143, v12
    v_add_f32 v13, v13, v15
    v_add_f32 v143, v143, v13
    v_cvt_pk_bf16_f32 v12, v143, v143
    v_lshlrev_b32 v143, 16, v12
    v_add_f32 v143, v143, v58
    v_cvt_pk_bf16_f32 v12, v143, v143
    v_lshlrev_b32 v143, 16, v12
    s_waitcnt lgkmcnt(6)
    v_pk_add_f32 v[48:49], v[48:49], v[80:81]
    v_pk_add_f32 v[50:51], v[50:51], v[82:83]
    v_pk_add_f32 v[52:53], v[52:53], v[84:85]
    v_pk_add_f32 v[54:55], v[54:55], v[86:87]
    v_pk_add_f32 v[48:49], v[48:49], v[88:89]
    v_pk_add_f32 v[50:51], v[50:51], v[90:91]
    v_pk_add_f32 v[52:53], v[52:53], v[92:93]
    v_pk_add_f32 v[54:55], v[54:55], v[94:95]
    s_waitcnt lgkmcnt(0)
    v_pk_add_f32 v[96:97], v[96:97], v[104:105]
    v_pk_add_f32 v[98:99], v[98:99], v[106:107]
    v_pk_add_f32 v[100:101], v[100:101], v[108:109]
    v_pk_add_f32 v[102:103], v[102:103], v[110:111]
    v_pk_add_f32 v[112:113], v[112:113], v[114:115]
    v_pk_add_f32 v[48:49], v[48:49], v[96:97]
    v_pk_add_f32 v[50:51], v[50:51], v[98:99]
    v_pk_add_f32 v[52:53], v[52:53], v[100:101]
    v_pk_add_f32 v[54:55], v[54:55], v[102:103]
    v_add_f32 v56, v56, v112
    v_add_f32 v56, v56, v113
    v_pk_add_f32 v[100:101], v[48:49], v[50:51]
    v_pk_add_f32 v[80:81], v[52:53], v[54:55]
    v_pk_add_f32 v[100:101], v[100:101], v[80:81]
    v_add_f32 v100, v100, v56
    v_add_f32 v100, v100, v101
    s_nop 1
    v_add_f32_dpp v100, v100, v100 row_ror:8 row_mask:0xf bank_mask:0xf
    s_nop 1
    v_add_f32_dpp v100, v100, v100 row_ror:4 row_mask:0xf bank_mask:0xf
    s_nop 1
    v_add_f32_dpp v100, v100, v100 row_ror:2 row_mask:0xf bank_mask:0xf
    s_nop 1
    v_add_f32_dpp v100, v100, v100 row_ror:1 row_mask:0xf bank_mask:0xf
    v_mov_b32 v12, v100
    s_nop 1
    v_permlane16_swap_b32 v100, v12
    v_add_f32 v100, v100, v12
    v_mov_b32 v12, v100
    s_nop 1
    v_permlane32_swap_b32 v100, v12
    v_add_f32 v100, v100, v12
    v_mul_f32 v100, 0x3ae38e39, v100
    v_pk_add_f32 v[80:81], v[48:49], v[100:101] op_sel_hi:[1,0] neg_lo:[0,1] neg_hi:[0,1]
    v_pk_add_f32 v[82:83], v[50:51], v[100:101] op_sel_hi:[1,0] neg_lo:[0,1] neg_hi:[0,1]
    v_pk_add_f32 v[84:85], v[52:53], v[100:101] op_sel_hi:[1,0] neg_lo:[0,1] neg_hi:[0,1]
    v_pk_add_f32 v[86:87], v[54:55], v[100:101] op_sel_hi:[1,0] neg_lo:[0,1] neg_hi:[0,1]
    v_sub_f32 v88, v56, v100
    v_pk_mul_f32 v[80:81], v[80:81], v[80:81]
    v_mul_f32 v101, v88, v88
    v_pk_fma_f32 v[80:81], v[82:83], v[82:83], v[80:81]
    v_pk_fma_f32 v[80:81], v[84:85], v[84:85], v[80:81]
    v_pk_fma_f32 v[80:81], v[86:87], v[86:87], v[80:81]
    v_add_f32 v101, v101, v80
    v_add_f32 v101, v101, v81
    s_nop 1
    v_add_f32_dpp v101, v101, v101 row_ror:8 row_mask:0xf bank_mask:0xf
    s_nop 1
    v_add_f32_dpp v101, v101, v101 row_ror:4 row_mask:0xf bank_mask:0xf
    s_nop 1
    v_add_f32_dpp v101, v101, v101 row_ror:2 row_mask:0xf bank_mask:0xf
    s_nop 1
    v_add_f32_dpp v101, v101, v101 row_ror:1 row_mask:0xf bank_mask:0xf
    v_mov_b32 v12, v101
    s_nop 1
    v_permlane16_swap_b32 v101, v12
    v_add_f32 v101, v101, v12
    v_mov_b32 v12, v101
    s_nop 1
    v_permlane32_swap_b32 v101, v12
    v_add_f32 v101, v101, v12
    v_mul_f32 v101, 0x3ae38e39, v101
    v_cvt_pk_bf16_f32 v12, v100, v101
    v_lshlrev_b32 v80, 16, v12
    v_and_b32 v81, 0xffff0000, v12
    v_add_f32 v81, s90, v81
    v_sub_f32 v13, v143, v80
    v_cvt_pk_bf16_f32 v12, v81, v13
    v_lshlrev_b32 v81, 16, v12
    v_and_b32 v13, 0xffff0000, v12
    v_sqrt_f32 v81, v81
    v_sub_f32 v82, v100, v80
    v_cvt_pk_bf16_f32 v12, v81, v81
    v_lshlrev_b32 v81, 16, v12
    v_rcp_f32 v81, v81
    s_nop 0
    v_mul_f32 v101, v101, v81
    v_mul_f32 v82, v82, v81
    v_mul_f32 v101, v101, v81
    v_mul_f32 v13, v13, v81
    v_cvt_pk_bf16_f32 v12, v82, v101
    v_lshlrev_b32 v82, 16, v12
    v_and_b32 v101, 0xffff0000, v12
    v_add_f32 v101, s90, v101
    v_cvt_pk_bf16_f32 v12, v13, v101
    v_lshlrev_b32 v13, 16, v12
    v_and_b32 v101, 0xffff0000, v12
    v_sqrt_f32 v101, v101
    v_sub_f32 v13, v13, v82
    v_cvt_pk_bf16_f32 v12, v13, v101
    v_lshlrev_b32 v13, 16, v12
    v_and_b32 v101, 0xffff0000, v12
    v_rcp_f32 v101, v101
    s_nop 0
    v_mul_f32 v13, v13, v101
    v_cvt_pk_bf16_f32 v12, v13, v13
    v_lshlrev_b32 v13, 16, v12
    v_mov_b32 v108, 0xc0135761
    s_nop 0
    v_mov_b32_dpp v102, v13 quad_perm:[0,0,0,0] row_mask:0xf bank_mask:0xf
    v_mov_b32_dpp v104, v13 quad_perm:[1,1,1,1] row_mask:0xf bank_mask:0xf
    v_mov_b32_dpp v106, v13 quad_perm:[2,2,2,2] row_mask:0xf bank_mask:0xf
    v_pk_fma_f32 v[86:87], v[102:103], v[116:117], v[124:125] op_sel_hi:[0,1,1]
    v_pk_fma_f32 v[88:89], v[104:105], v[116:117], v[124:125] op_sel_hi:[0,1,1]
    v_pk_fma_f32 v[90:91], v[106:107], v[116:117], v[124:125] op_sel_hi:[0,1,1]
    v_pk_mul_f32 v[92:93], v[86:87], v[86:87]
    v_pk_mul_f32 v[94:95], v[88:89], v[88:89]
    v_pk_mul_f32 v[96:97], v[90:91], v[90:91]
    v_pk_fma_f32 v[92:93], v[92:93], s[66:67], v[108:109] op_sel_hi:[1,1,0]
    v_pk_fma_f32 v[94:95], v[94:95], s[66:67], v[108:109] op_sel_hi:[1,1,0]
    v_pk_fma_f32 v[96:97], v[96:97], s[66:67], v[108:109] op_sel_hi:[1,1,0]
    v_pk_mul_f32 v[92:93], v[92:93], v[86:87]
    v_pk_mul_f32 v[94:95], v[94:95], v[88:89]
    v_pk_mul_f32 v[96:97], v[96:97], v[90:91]
    v_exp_f32 v92, v92
    v_exp_f32 v93, v93
    v_exp_f32 v94, v94
    v_exp_f32 v95, v95
    v_exp_f32 v96, v96
    v_exp_f32 v97, v97
    v_pk_mul_f32 v[86:87], v[86:87], v[132:133]
    v_pk_mul_f32 v[88:89], v[88:89], v[132:133]
    v_pk_mul_f32 v[90:91], v[90:91], v[132:133]
    v_pk_add_f32 v[92:93], v[92:93], 1.0 op_sel_hi:[1,0]
    v_pk_add_f32 v[94:95], v[94:95], 1.0 op_sel_hi:[1,0]
    v_pk_add_f32 v[96:97], v[96:97], 1.0 op_sel_hi:[1,0]
    v_rcp_f32 v92, v92
    v_rcp_f32 v93, v93
    v_rcp_f32 v94, v94
    v_rcp_f32 v95, v95
    v_rcp_f32 v96, v96
    v_rcp_f32 v97, v97
    v_pk_mul_f32 v[110:111], v[86:87], v[92:93]
    v_pk_mul_f32 v[112:113], v[88:89], v[94:95]
    v_pk_mul_f32 v[114:115], v[90:91], v[96:97]
    v_pk_fma_f32 v[86:87], v[102:103], v[118:119], v[126:127] op_sel_hi:[0,1,1]
    v_pk_fma_f32 v[88:89], v[104:105], v[118:119], v[126:127] op_sel_hi:[0,1,1]
    v_pk_fma_f32 v[90:91], v[106:107], v[118:119], v[126:127] op_sel_hi:[0,1,1]
    v_pk_mul_f32 v[92:93], v[86:87], v[86:87]
    v_pk_mul_f32 v[94:95], v[88:89], v[88:89]
    v_pk_mul_f32 v[96:97], v[90:91], v[90:91]
    v_pk_fma_f32 v[92:93], v[92:93], s[66:67], v[108:109] op_sel_hi:[1,1,0]
    v_pk_fma_f32 v[94:95], v[94:95], s[66:67], v[108:109] op_sel_hi:[1,1,0]
    v_pk_fma_f32 v[96:97], v[96:97], s[66:67], v[108:109] op_sel_hi:[1,1,0]
    v_pk_mul_f32 v[92:93], v[92:93], v[86:87]
    v_pk_mul_f32 v[94:95], v[94:95], v[88:89]
    v_pk_mul_f32 v[96:97], v[96:97], v[90:91]
    v_exp_f32 v92, v92
    v_exp_f32 v93, v93
    v_exp_f32 v94, v94
    v_exp_f32 v95, v95
    v_exp_f32 v96, v96
    v_exp_f32 v97, v97
    v_pk_mul_f32 v[86:87], v[86:87], v[134:135]
    v_pk_mul_f32 v[88:89], v[88:89], v[134:135]
    v_pk_mul_f32 v[90:91], v[90:91], v[134:135]
    v_pk_add_f32 v[92:93], v[92:93], 1.0 op_sel_hi:[1,0]
    v_pk_add_f32 v[94:95], v[94:95], 1.0 op_sel_hi:[1,0]
    v_pk_add_f32 v[96:97], v[96:97], 1.0 op_sel_hi:[1,0]
    v_rcp_f32 v92, v92
    v_rcp_f32 v93, v93
    v_rcp_f32 v94, v94
    v_rcp_f32 v95, v95
    v_rcp_f32 v96, v96
    v_rcp_f32 v97, v97
    v_pk_fma_f32 v[110:111], v[86:87], v[92:93], v[110:111]
    v_pk_fma_f32 v[112:113], v[88:89], v[94:95], v[112:113]
    v_pk_fma_f32 v[114:115], v[90:91], v[96:97], v[114:115]
    v_and_b32 v84, 0xffff0000, v136
    v_and_b32 v85, 0xffff0000, v137
    v_pk_fma_f32 v[86:87], v[102:103], v[120:121], v[128:129] op_sel_hi:[0,1,1]
    v_pk_fma_f32 v[88:89], v[104:105], v[120:121], v[128:129] op_sel_hi:[0,1,1]
    v_pk_fma_f32 v[90:91], v[106:107], v[120:121], v[128:129] op_sel_hi:[0,1,1]
    v_pk_mul_f32 v[92:93], v[86:87], v[86:87]
    v_pk_mul_f32 v[94:95], v[88:89], v[88:89]
    v_pk_mul_f32 v[96:97], v[90:91], v[90:91]
    v_pk_fma_f32 v[92:93], v[92:93], s[66:67], v[108:109] op_sel_hi:[1,1,0]
    v_pk_fma_f32 v[94:95], v[94:95], s[66:67], v[108:109] op_sel_hi:[1,1,0]
    v_pk_fma_f32 v[96:97], v[96:97], s[66:67], v[108:109] op_sel_hi:[1,1,0]
    v_pk_mul_f32 v[92:93], v[92:93], v[86:87]
    v_pk_mul_f32 v[94:95], v[94:95], v[88:89]
    v_pk_mul_f32 v[96:97], v[96:97], v[90:91]
    v_exp_f32 v92, v92
    v_exp_f32 v93, v93
    v_exp_f32 v94, v94
    v_exp_f32 v95, v95
    v_exp_f32 v96, v96
    v_exp_f32 v97, v97
    v_pk_mul_f32 v[86:87], v[86:87], v[84:85]
    v_pk_mul_f32 v[88:89], v[88:89], v[84:85]
    v_pk_mul_f32 v[90:91], v[90:91], v[84:85]
    v_pk_add_f32 v[92:93], v[92:93], 1.0 op_sel_hi:[1,0]
    v_pk_add_f32 v[94:95], v[94:95], 1.0 op_sel_hi:[1,0]
    v_pk_add_f32 v[96:97], v[96:97], 1.0 op_sel_hi:[1,0]
    v_rcp_f32 v92, v92
    v_rcp_f32 v93, v93
    v_rcp_f32 v94, v94
    v_rcp_f32 v95, v95
    v_rcp_f32 v96, v96
    v_rcp_f32 v97, v97
    v_pk_fma_f32 v[110:111], v[86:87], v[92:93], v[110:111]
    v_pk_fma_f32 v[112:113], v[88:89], v[94:95], v[112:113]
    v_pk_fma_f32 v[114:115], v[90:91], v[96:97], v[114:115]
    v_and_b32 v84, 0xffff0000, v138
    v_and_b32 v85, 0xffff0000, v139
    v_pk_fma_f32 v[86:87], v[102:103], v[122:123], v[130:131] op_sel_hi:[0,1,1]
    v_pk_fma_f32 v[88:89], v[104:105], v[122:123], v[130:131] op_sel_hi:[0,1,1]
    v_pk_fma_f32 v[90:91], v[106:107], v[122:123], v[130:131] op_sel_hi:[0,1,1]
    v_pk_mul_f32 v[92:93], v[86:87], v[86:87]
    v_pk_mul_f32 v[94:95], v[88:89], v[88:89]
    v_pk_mul_f32 v[96:97], v[90:91], v[90:91]
    v_pk_fma_f32 v[92:93], v[92:93], s[66:67], v[108:109] op_sel_hi:[1,1,0]
    v_pk_fma_f32 v[94:95], v[94:95], s[66:67], v[108:109] op_sel_hi:[1,1,0]
    v_pk_fma_f32 v[96:97], v[96:97], s[66:67], v[108:109] op_sel_hi:[1,1,0]
    v_pk_mul_f32 v[92:93], v[92:93], v[86:87]
    v_pk_mul_f32 v[94:95], v[94:95], v[88:89]
    v_pk_mul_f32 v[96:97], v[96:97], v[90:91]
    v_exp_f32 v92, v92
    v_exp_f32 v93, v93
    v_exp_f32 v94, v94
    v_exp_f32 v95, v95
    v_exp_f32 v96, v96
    v_exp_f32 v97, v97
    v_pk_mul_f32 v[86:87], v[86:87], v[84:85]
    v_pk_mul_f32 v[88:89], v[88:89], v[84:85]
    v_pk_mul_f32 v[90:91], v[90:91], v[84:85]
    v_pk_add_f32 v[92:93], v[92:93], 1.0 op_sel_hi:[1,0]
    v_pk_add_f32 v[94:95], v[94:95], 1.0 op_sel_hi:[1,0]
    v_pk_add_f32 v[96:97], v[96:97], 1.0 op_sel_hi:[1,0]
    v_rcp_f32 v92, v92
    v_rcp_f32 v93, v93
    v_rcp_f32 v94, v94
    v_rcp_f32 v95, v95
    v_rcp_f32 v96, v96
    v_rcp_f32 v97, v97
    v_pk_fma_f32 v[110:111], v[86:87], v[92:93], v[110:111]
    v_pk_fma_f32 v[112:113], v[88:89], v[94:95], v[112:113]
    v_pk_fma_f32 v[114:115], v[90:91], v[96:97], v[114:115]
    v_pk_fma_f32 v[86:87], v[102:103], v[16:17], v[24:25] op_sel_hi:[0,1,1]
    v_pk_fma_f32 v[88:89], v[104:105], v[16:17], v[24:25] op_sel_hi:[0,1,1]
    v_pk_fma_f32 v[90:91], v[106:107], v[16:17], v[24:25] op_sel_hi:[0,1,1]
    v_pk_mul_f32 v[92:93], v[86:87], v[86:87]
    v_pk_mul_f32 v[94:95], v[88:89], v[88:89]
    v_pk_mul_f32 v[96:97], v[90:91], v[90:91]
    v_pk_fma_f32 v[92:93], v[92:93], s[66:67], v[108:109] op_sel_hi:[1,1,0]
    v_pk_fma_f32 v[94:95], v[94:95], s[66:67], v[108:109] op_sel_hi:[1,1,0]
    v_pk_fma_f32 v[96:97], v[96:97], s[66:67], v[108:109] op_sel_hi:[1,1,0]
    v_pk_mul_f32 v[92:93], v[92:93], v[86:87]
    v_pk_mul_f32 v[94:95], v[94:95], v[88:89]
    v_pk_mul_f32 v[96:97], v[96:97], v[90:91]
    v_exp_f32 v92, v92
    v_exp_f32 v93, v93
    v_exp_f32 v94, v94
    v_exp_f32 v95, v95
    v_exp_f32 v96, v96
    v_exp_f32 v97, v97
    v_pk_mul_f32 v[86:87], v[86:87], v[44:45]
    v_pk_mul_f32 v[88:89], v[88:89], v[44:45]
    v_pk_mul_f32 v[90:91], v[90:91], v[44:45]
    v_pk_add_f32 v[92:93], v[92:93], 1.0 op_sel_hi:[1,0]
    v_pk_add_f32 v[94:95], v[94:95], 1.0 op_sel_hi:[1,0]
    v_pk_add_f32 v[96:97], v[96:97], 1.0 op_sel_hi:[1,0]
    v_rcp_f32 v92, v92
    v_rcp_f32 v93, v93
    v_rcp_f32 v94, v94
    v_rcp_f32 v95, v95
    v_rcp_f32 v96, v96
    v_rcp_f32 v97, v97
    v_pk_fma_f32 v[110:111], v[86:87], v[92:93], v[110:111]
    v_pk_fma_f32 v[112:113], v[88:89], v[94:95], v[112:113]
    v_pk_fma_f32 v[114:115], v[90:91], v[96:97], v[114:115]
    v_pk_fma_f32 v[86:87], v[102:103], v[18:19], v[26:27] op_sel_hi:[0,1,1]
    v_pk_fma_f32 v[88:89], v[104:105], v[18:19], v[26:27] op_sel_hi:[0,1,1]
    v_pk_fma_f32 v[90:91], v[106:107], v[18:19], v[26:27] op_sel_hi:[0,1,1]
    v_pk_mul_f32 v[92:93], v[86:87], v[86:87]
    v_pk_mul_f32 v[94:95], v[88:89], v[88:89]
    v_pk_mul_f32 v[96:97], v[90:91], v[90:91]
    v_pk_fma_f32 v[92:93], v[92:93], s[66:67], v[108:109] op_sel_hi:[1,1,0]
    v_pk_fma_f32 v[94:95], v[94:95], s[66:67], v[108:109] op_sel_hi:[1,1,0]
    v_pk_fma_f32 v[96:97], v[96:97], s[66:67], v[108:109] op_sel_hi:[1,1,0]
    v_pk_mul_f32 v[92:93], v[92:93], v[86:87]
    v_pk_mul_f32 v[94:95], v[94:95], v[88:89]
    v_pk_mul_f32 v[96:97], v[96:97], v[90:91]
    v_exp_f32 v92, v92
    v_exp_f32 v93, v93
    v_exp_f32 v94, v94
    v_exp_f32 v95, v95
    v_exp_f32 v96, v96
    v_exp_f32 v97, v97
    v_pk_mul_f32 v[86:87], v[86:87], v[46:47]
    v_pk_mul_f32 v[88:89], v[88:89], v[46:47]
    v_pk_mul_f32 v[90:91], v[90:91], v[46:47]
    v_pk_add_f32 v[92:93], v[92:93], 1.0 op_sel_hi:[1,0]
    v_pk_add_f32 v[94:95], v[94:95], 1.0 op_sel_hi:[1,0]
    v_pk_add_f32 v[96:97], v[96:97], 1.0 op_sel_hi:[1,0]
    v_rcp_f32 v92, v92
    v_rcp_f32 v93, v93
    v_rcp_f32 v94, v94
    v_rcp_f32 v95, v95
    v_rcp_f32 v96, v96
    v_rcp_f32 v97, v97
    v_pk_fma_f32 v[110:111], v[86:87], v[92:93], v[110:111]
    v_pk_fma_f32 v[112:113], v[88:89], v[94:95], v[112:113]
    v_pk_fma_f32 v[114:115], v[90:91], v[96:97], v[114:115]
    v_lshlrev_b32 v84, 16, v136
    v_lshlrev_b32 v85, 16, v137
    v_pk_fma_f32 v[86:87], v[102:103], v[20:21], v[28:29] op_sel_hi:[0,1,1]
    v_pk_fma_f32 v[88:89], v[104:105], v[20:21], v[28:29] op_sel_hi:[0,1,1]
    v_pk_fma_f32 v[90:91], v[106:107], v[20:21], v[28:29] op_sel_hi:[0,1,1]
    v_pk_mul_f32 v[92:93], v[86:87], v[86:87]
    v_pk_mul_f32 v[94:95], v[88:89], v[88:89]
    v_pk_mul_f32 v[96:97], v[90:91], v[90:91]
    v_pk_fma_f32 v[92:93], v[92:93], s[66:67], v[108:109] op_sel_hi:[1,1,0]
    v_pk_fma_f32 v[94:95], v[94:95], s[66:67], v[108:109] op_sel_hi:[1,1,0]
    v_pk_fma_f32 v[96:97], v[96:97], s[66:67], v[108:109] op_sel_hi:[1,1,0]
    v_pk_mul_f32 v[92:93], v[92:93], v[86:87]
    v_pk_mul_f32 v[94:95], v[94:95], v[88:89]
    v_pk_mul_f32 v[96:97], v[96:97], v[90:91]
    v_exp_f32 v92, v92
    v_exp_f32 v93, v93
    v_exp_f32 v94, v94
    v_exp_f32 v95, v95
    v_exp_f32 v96, v96
    v_exp_f32 v97, v97
    v_pk_mul_f32 v[86:87], v[86:87], v[84:85]
    v_pk_mul_f32 v[88:89], v[88:89], v[84:85]
    v_pk_mul_f32 v[90:91], v[90:91], v[84:85]
    v_pk_add_f32 v[92:93], v[92:93], 1.0 op_sel_hi:[1,0]
    v_pk_add_f32 v[94:95], v[94:95], 1.0 op_sel_hi:[1,0]
    v_pk_add_f32 v[96:97], v[96:97], 1.0 op_sel_hi:[1,0]
    v_rcp_f32 v92, v92
    v_rcp_f32 v93, v93
    v_rcp_f32 v94, v94
    v_rcp_f32 v95, v95
    v_rcp_f32 v96, v96
    v_rcp_f32 v97, v97
    v_pk_fma_f32 v[110:111], v[86:87], v[92:93], v[110:111]
    v_pk_fma_f32 v[112:113], v[88:89], v[94:95], v[112:113]
    v_pk_fma_f32 v[114:115], v[90:91], v[96:97], v[114:115]
    v_lshlrev_b32 v84, 16, v138
    v_lshlrev_b32 v85, 16, v139
    v_pk_fma_f32 v[86:87], v[102:103], v[22:23], v[30:31] op_sel_hi:[0,1,1]
    v_pk_fma_f32 v[88:89], v[104:105], v[22:23], v[30:31] op_sel_hi:[0,1,1]
    v_pk_fma_f32 v[90:91], v[106:107], v[22:23], v[30:31] op_sel_hi:[0,1,1]
    v_pk_mul_f32 v[92:93], v[86:87], v[86:87]
    v_pk_mul_f32 v[94:95], v[88:89], v[88:89]
    v_pk_mul_f32 v[96:97], v[90:91], v[90:91]
    v_pk_fma_f32 v[92:93], v[92:93], s[66:67], v[108:109] op_sel_hi:[1,1,0]
    v_pk_fma_f32 v[94:95], v[94:95], s[66:67], v[108:109] op_sel_hi:[1,1,0]
    v_pk_fma_f32 v[96:97], v[96:97], s[66:67], v[108:109] op_sel_hi:[1,1,0]
    v_pk_mul_f32 v[92:93], v[92:93], v[86:87]
    v_pk_mul_f32 v[94:95], v[94:95], v[88:89]
    v_pk_mul_f32 v[96:97], v[96:97], v[90:91]
    v_exp_f32 v92, v92
    v_exp_f32 v93, v93
    v_exp_f32 v94, v94
    v_exp_f32 v95, v95
    v_exp_f32 v96, v96
    v_exp_f32 v97, v97
    v_pk_mul_f32 v[86:87], v[86:87], v[84:85]
    v_pk_mul_f32 v[88:89], v[88:89], v[84:85]
    v_pk_mul_f32 v[90:91], v[90:91], v[84:85]
    v_pk_add_f32 v[92:93], v[92:93], 1.0 op_sel_hi:[1,0]
    v_pk_add_f32 v[94:95], v[94:95], 1.0 op_sel_hi:[1,0]
    v_pk_add_f32 v[96:97], v[96:97], 1.0 op_sel_hi:[1,0]
    v_rcp_f32 v92, v92
    v_rcp_f32 v93, v93
    v_rcp_f32 v94, v94
    v_rcp_f32 v95, v95
    v_rcp_f32 v96, v96
    v_rcp_f32 v97, v97
    v_pk_fma_f32 v[110:111], v[86:87], v[92:93], v[110:111]
    v_pk_fma_f32 v[112:113], v[88:89], v[94:95], v[112:113]
    v_pk_fma_f32 v[114:115], v[90:91], v[96:97], v[114:115]
    v_lshlrev_b32 v80, 16, v140
    v_and_b32 v81, 0xffff0000, v140
    v_lshlrev_b32 v82, 16, v141
    v_and_b32 v83, 0xffff0000, v141
    v_lshlrev_b32 v84, 16, v142
    v_and_b32 v85, 0xffff0000, v142
    v_pk_fma_f32 v[86:87], v[102:103], v[80:81], v[82:83] op_sel_hi:[0,1,1]
    v_pk_fma_f32 v[88:89], v[104:105], v[80:81], v[82:83] op_sel_hi:[0,1,1]
    v_pk_fma_f32 v[90:91], v[106:107], v[80:81], v[82:83] op_sel_hi:[0,1,1]
    v_pk_mul_f32 v[92:93], v[86:87], v[86:87]
    v_pk_mul_f32 v[94:95], v[88:89], v[88:89]
    v_pk_mul_f32 v[96:97], v[90:91], v[90:91]
    v_pk_fma_f32 v[92:93], v[92:93], s[66:67], v[108:109] op_sel_hi:[1,1,0]
    v_pk_fma_f32 v[94:95], v[94:95], s[66:67], v[108:109] op_sel_hi:[1,1,0]
    v_pk_fma_f32 v[96:97], v[96:97], s[66:67], v[108:109] op_sel_hi:[1,1,0]
    v_pk_mul_f32 v[92:93], v[92:93], v[86:87]
    v_pk_mul_f32 v[94:95], v[94:95], v[88:89]
    v_pk_mul_f32 v[96:97], v[96:97], v[90:91]
    v_exp_f32 v92, v92
    v_exp_f32 v93, v93
    v_exp_f32 v94, v94
    v_exp_f32 v95, v95
    v_exp_f32 v96, v96
    v_exp_f32 v97, v97
    v_pk_mul_f32 v[86:87], v[86:87], v[84:85]
    v_pk_mul_f32 v[88:89], v[88:89], v[84:85]
    v_pk_mul_f32 v[90:91], v[90:91], v[84:85]
    v_pk_add_f32 v[92:93], v[92:93], 1.0 op_sel_hi:[1,0]
    v_pk_add_f32 v[94:95], v[94:95], 1.0 op_sel_hi:[1,0]
    v_pk_add_f32 v[96:97], v[96:97], 1.0 op_sel_hi:[1,0]
    v_rcp_f32 v92, v92
    v_rcp_f32 v93, v93
    v_rcp_f32 v94, v94
    v_rcp_f32 v95, v95
    v_rcp_f32 v96, v96
    v_rcp_f32 v97, v97
    v_pk_fma_f32 v[110:111], v[86:87], v[92:93], v[110:111]
    v_pk_fma_f32 v[112:113], v[88:89], v[94:95], v[112:113]
    v_pk_fma_f32 v[114:115], v[90:91], v[96:97], v[114:115]
    v_add_f32 v110, v110, v111
    v_add_f32 v112, v112, v113
    v_add_f32 v114, v114, v115
    v_add_f32_dpp v110, v110, v110 row_ror:8 row_mask:0xf bank_mask:0xf
    v_add_f32_dpp v112, v112, v112 row_ror:8 row_mask:0xf bank_mask:0xf
    v_add_f32_dpp v114, v114, v114 row_ror:8 row_mask:0xf bank_mask:0xf
    v_add_f32_dpp v110, v110, v110 row_ror:4 row_mask:0xf bank_mask:0xf
    v_add_f32_dpp v112, v112, v112 row_ror:4 row_mask:0xf bank_mask:0xf
    v_add_f32_dpp v114, v114, v114 row_ror:4 row_mask:0xf bank_mask:0xf
    v_add_f32_dpp v110, v110, v110 row_ror:2 row_mask:0xf bank_mask:0xf
    v_add_f32_dpp v112, v112, v112 row_ror:2 row_mask:0xf bank_mask:0xf
    v_add_f32_dpp v114, v114, v114 row_ror:2 row_mask:0xf bank_mask:0xf
    v_add_f32_dpp v110, v110, v110 row_ror:1 row_mask:0xf bank_mask:0xf
    v_add_f32_dpp v112, v112, v112 row_ror:1 row_mask:0xf bank_mask:0xf
    v_add_f32_dpp v114, v114, v114 row_ror:1 row_mask:0xf bank_mask:0xf
    s_lshl_b32 s29, s24, 4
    v_lshrrev_b32 v12, 4, v0
    v_lshl_add_u32 v12, v12, 2, s29
    ds_write_b32 v12, v110 offset:14848
    ds_write_b32 v12, v112 offset:14912
    ds_write_b32 v12, v114 offset:14976
    v_and_b32 v13, 3, v0
    v_lshlrev_b32 v13, 6, v13
    s_waitcnt lgkmcnt(0)
    s_barrier
    s_cmp_lg_u32 s24, 0
    s_cbranch_scc1 XD_98
    s_cmp_eq_u32 s62, 0
    s_cbranch_scc1 XD_98
    ds_read_b128 v[80:83], v13 offset:14848
    ds_read_b128 v[84:87], v13 offset:14864
    ds_read_b128 v[88:91], v13 offset:14880
    ds_read_b128 v[92:95], v13 offset:14896
    s_mul_i32 s29, s82, 2304
    s_add_u32 s59, s29, 0x68000
    v_add_u32 v15, s29, v14
    v_lshrrev_b32 v15, 1, v15
    s_waitcnt lgkmcnt(0)
    v_pk_add_f32 v[80:81], v[80:81], v[88:89]
    v_pk_add_f32 v[82:83], v[82:83], v[90:91]
    v_pk_add_f32 v[84:85], v[84:85], v[92:93]
    v_pk_add_f32 v[86:87], v[86:87], v[94:95]
    v_pk_add_f32 v[80:81], v[80:81], v[84:85]
    v_pk_add_f32 v[82:83], v[82:83], v[86:87]
    v_pk_add_f32 v[80:81], v[80:81], v[82:83]
    v_add_f32 v80, v80, v81
    v_cvt_pk_bf16_f32 v12, v80, v80
    v_lshlrev_b32 v80, 16, v12
    v_add_f32 v80, s68, v80
    v_cvt_pk_bf16_f32 v12, v80, v80
    v_lshlrev_b32 v80, 16, v12
    v_add_f32 v80, v80, v143
    v_cvt_pk_bf16_f32 v80, v80, v80
    s_mov_b64 exec, 7
    s_cmp_ge_u32 s81, 2
    s_cbranch_scc1 XF_99
    v_and_b32 v80, 0xffff0000, v80
    buffer_store_dword v80, v14, s[12:15], s59 offen sc1
    s_branch XR_100
XF_99:
    global_store_short v15, v80, s[52:53]
XR_100:
    s_mov_b64 exec, -1
XD_98:
    s_setpc_b64 s[30:31]
U_v112_v128:
    v_mfma_f32_16x16x32_bf16 v[48:51], v[112:115], v[16:19], 0
    v_mfma_f32_16x16x32_bf16 v[52:55], v[120:123], v[16:19], 0
    v_mfma_f32_16x16x32_bf16 v[48:51], v[116:119], v[20:23], v[48:51]
    v_mfma_f32_16x16x32_bf16 v[52:55], v[124:127], v[20:23], v[52:55]
    s_nop 7
    v_mov_b32_dpp v48, v48 quad_perm:[0,0,2,2] row_mask:0xf bank_mask:0xf
    v_mov_b32_dpp v50, v50 quad_perm:[0,0,2,2] row_mask:0xf bank_mask:0xf
    v_mov_b32_dpp v52, v52 quad_perm:[0,0,2,2] row_mask:0xf bank_mask:0xf
    v_mov_b32_dpp v54, v54 quad_perm:[0,0,2,2] row_mask:0xf bank_mask:0xf
    v_add_f32_dpp v48, v49, v48 quad_perm:[1,1,3,3] row_mask:0xf bank_mask:0xf
    v_add_f32_dpp v50, v51, v50 quad_perm:[1,1,3,3] row_mask:0xf bank_mask:0xf
    v_add_f32_dpp v52, v53, v52 quad_perm:[1,1,3,3] row_mask:0xf bank_mask:0xf
    v_add_f32_dpp v54, v55, v54 quad_perm:[1,1,3,3] row_mask:0xf bank_mask:0xf
    v_max3_f32 v12, v48, v50, v52
    v_max_f32 v12, v12, v54
    v_cmp_gt_f32 vcc, v12, v36
    s_cbranch_vccnz RS_101
RC_102:
    v_fma_f32 v48, v48, s27, -v37
    v_fma_f32 v50, v50, s27, -v37
    v_fma_f32 v52, v52, s27, -v37
    v_fma_f32 v54, v54, s27, -v37
    v_exp_f32 v48, v48
    v_exp_f32 v50, v50
    v_exp_f32 v52, v52
    v_exp_f32 v54, v54
    v_cvt_pk_bf16_f32 v13, v48, v48
    v_and_b32 v56, v13, v4
    v_and_b32 v57, v13, v5
    v_and_b32 v58, v13, v6
    v_and_b32 v59, v13, v7
    v_add_f32 v38, v38, v48
    v_cvt_pk_bf16_f32 v13, v50, v50
    v_mfma_f32_16x16x32_bf16 v[32:35], v[128:131], v[56:59], v[32:35]
    v_and_b32 v56, v13, v4
    v_and_b32 v57, v13, v5
    v_and_b32 v58, v13, v6
    v_and_b32 v59, v13, v7
    v_add_f32 v38, v38, v50
    v_cvt_pk_bf16_f32 v13, v52, v52
    v_mfma_f32_16x16x32_bf16 v[32:35], v[132:135], v[56:59], v[32:35]
    v_and_b32 v56, v13, v4
    v_and_b32 v57, v13, v5
    v_and_b32 v58, v13, v6
    v_and_b32 v59, v13, v7
    v_add_f32 v38, v38, v52
    v_cvt_pk_bf16_f32 v13, v54, v54
    v_mfma_f32_16x16x32_bf16 v[32:35], v[136:139], v[56:59], v[32:35]
    v_and_b32 v56, v13, v4
    v_and_b32 v57, v13, v5
    v_and_b32 v58, v13, v6
    v_and_b32 v59, v13, v7
    v_add_f32 v38, v38, v54
    s_nop 0
    v_mfma_f32_16x16x32_bf16 v[32:35], v[140:143], v[56:59], v[32:35]
    s_setpc_b64 s[30:31]
RESCALE:
    v_mul_f32 v12, s27, v12
    v_max_f32 v12, v12, v37
    v_mov_b32 v13, v12
    s_nop 1
    v_permlane16_swap_b32 v12, v13
    v_max_f32 v12, v12, v13
    v_mov_b32 v13, v12
    s_nop 1
    v_permlane32_swap_b32 v12, v13
    v_max_f32 v12, v12, v13
    v_add_f32 v36, 0x41000000, v12
    v_mul_f32 v36, 0x40faf233, v36
    v_sub_f32 v13, v37, v12
    v_exp_f32 v13, v13
    v_mov_b32 v37, v12
    v_mul_f32 v38, v38, v13
    v_mul_f32 v32, v32, v13
    v_mul_f32 v33, v33, v13
    v_mul_f32 v34, v34, v13
    v_mul_f32 v35, v35, v13
    s_setpc_b64 s[94:95]
FS_2:
    buffer_store_dwordx4 v[244:247], v248, s[12:15], s59 offen sc1
    s_branch FS_3
RT_5:
    s_cmp_eq_u32 s28, 0
    s_cbranch_scc1 CT_6
    s_sub_u32 s28, s28, 1
    buffer_load_dwordx4 v[80:83], v8, s[12:15], s69 offen sc1
    buffer_load_dwordx4 v[84:87], v8, s[12:15], s69 offen offset:1024 sc1
    buffer_load_dword v88, v3, s[12:15], s69 offen offset:2048 sc1
    s_waitcnt vmcnt(0)
    s_branch CK_4
FS_7:
    buffer_store_dword v100, v3, s[12:15], s29 offen sc1
    s_branch FS_8
RT_11:
    s_cmp_eq_u32 s28, 0
    s_cbranch_scc1 CT_12
    s_sub_u32 s28, s28, 1
    global_load_dwordx2 v[48:49], v50, s[54:55] sc1
    s_waitcnt vmcnt(0)
    s_branch CK_10
RT_14:
    s_cmp_eq_u32 s28, 0
    s_cbranch_scc1 CT_15
    s_sub_u32 s28, s28, 1
    buffer_load_dwordx4 v[128:131], v8, s[12:15], s69 offen offset:0 sc1
    buffer_load_dwordx4 v[132:135], v8, s[12:15], s69 offen offset:1024 sc1
    buffer_load_dwordx4 v[136:139], v8, s[12:15], s69 offen offset:2048 sc1
    s_waitcnt vmcnt(0)
    s_branch CK_13
RS_16:
    s_call_b64 s[94:95], RESCALE
    s_branch RC_17
RS_18:
    s_call_b64 s[94:95], RESCALE
    s_branch RC_19
RS_20:
    s_call_b64 s[94:95], RESCALE
    s_branch RC_21
RS_22:
    s_call_b64 s[94:95], RESCALE
    s_branch RC_23
RS_24:
    s_call_b64 s[94:95], RESCALE
    s_branch RC_25
RS_26:
    s_call_b64 s[94:95], RESCALE
    s_branch RC_27
RS_28:
    s_call_b64 s[94:95], RESCALE
    s_branch RC_29
RS_30:
    s_call_b64 s[94:95], RESCALE
    s_branch RC_31
RS_32:
    s_call_b64 s[94:95], RESCALE
    s_branch RC_33
RT_35:
    s_cmp_eq_u32 s28, 0
    s_cbranch_scc1 CT_36
    s_sub_u32 s28, s28, 1
    global_load_dwordx2 v[96:97], v98, s[54:55] sc1
    s_waitcnt vmcnt(0)
    s_branch CK_34
RS_37:
    s_call_b64 s[94:95], RESCALE
    s_branch RC_38
RS_39:
    s_call_b64 s[94:95], RESCALE
    s_branch RC_40
RS_41:
    s_call_b64 s[94:95], RESCALE
    s_branch RC_42
FS_43:
    buffer_store_dwordx2 v[92:93], v3, s[12:15], s59 offen sc1
    s_branch FS_44
FS_45:
    buffer_store_dword v96, v3, s[12:15], s29 offen sc1
    s_branch FS_46
RT_49:
    s_cmp_eq_u32 s28, 0
    s_cbranch_scc1 CT_50
    s_sub_u32 s28, s28, 1
    buffer_load_dwordx2 v[96:97], v108, s[12:15], s70 offen sc1
    s_mov_b32 s29, s69
    buffer_load_dwordx4 v[80:83], v111, s[12:15], s29 offen sc1
    s_add_u32 s29, s29, 4096
    buffer_load_dwordx4 v[84:87], v111, s[12:15], s29 offen sc1
    s_add_u32 s29, s29, 4096
    buffer_load_dwordx4 v[88:91], v111, s[12:15], s29 offen sc1
    s_add_u32 s29, s29, 4096
    buffer_load_dwordx4 v[92:95], v111, s[12:15], s29 offen sc1
    s_waitcnt vmcnt(0)
    s_branch CK_48
FS_52:
    buffer_store_dwordx4 v[48:51], v52, s[12:15], s59 offen sc1
    s_branch FS_53
RT_55:
    s_cmp_eq_u32 s28, 0
    s_cbranch_scc1 CT_56
    s_sub_u32 s28, s28, 1
    s_mov_b32 s29, s69
    buffer_load_dwordx4 v[80:83], v8, s[12:15], s29 offen sc1
    buffer_load_dwordx4 v[84:87], v8, s[12:15], s29 offen offset:1024 sc1
    buffer_load_dword v112, v3, s[12:15], s29 offen offset:2048 sc1
    s_add_u32 s29, s29, 2304
    buffer_load_dwordx4 v[88:91], v8, s[12:15], s29 offen sc1
    buffer_load_dwordx4 v[92:95], v8, s[12:15], s29 offen offset:1024 sc1
    buffer_load_dword v113, v3, s[12:15], s29 offen offset:2048 sc1
    s_add_u32 s29, s29, 2304
    buffer_load_dwordx4 v[96:99], v8, s[12:15], s29 offen sc1
    buffer_load_dwordx4 v[100:103], v8, s[12:15], s29 offen offset:1024 sc1
    buffer_load_dword v114, v3, s[12:15], s29 offen offset:2048 sc1
    s_add_u32 s29, s29, 2304
    buffer_load_dwordx4 v[104:107], v8, s[12:15], s29 offen sc1
    buffer_load_dwordx4 v[108:111], v8, s[12:15], s29 offen offset:1024 sc1
    buffer_load_dword v115, v3, s[12:15], s29 offen offset:2048 sc1
    s_waitcnt vmcnt(0)
    s_branch CK_54
RS_60:
    s_call_b64 s[94:95], RESCALE
    s_branch RC_61
RS_62:
    s_call_b64 s[94:95], RESCALE
    s_branch RC_63
RS_64:
    s_call_b64 s[94:95], RESCALE
    s_branch RC_65
RS_66:
    s_call_b64 s[94:95], RESCALE
    s_branch RC_67
RS_68:
    s_call_b64 s[94:95], RESCALE
    s_branch RC_69
RS_70:
    s_call_b64 s[94:95], RESCALE
    s_branch RC_71
RS_72:
    s_call_b64 s[94:95], RESCALE
    s_branch RC_73
RS_74:
    s_call_b64 s[94:95], RESCALE
    s_branch RC_75
RS_76:
    s_call_b64 s[94:95], RESCALE
    s_branch RC_77
RS_78:
    s_call_b64 s[94:95], RESCALE
    s_branch RC_79
RS_80:
    s_call_b64 s[94:95], RESCALE
    s_branch RC_81
RS_82:
    s_call_b64 s[94:95], RESCALE
    s_branch RC_83
RS_84:
    s_call_b64 s[94:95], RESCALE
    s_branch RC_85
RS_86:
    s_call_b64 s[94:95], RESCALE
    s_branch RC_87
RS_88:
    s_call_b64 s[94:95], RESCALE
    s_branch RC_89
RS_90:
    s_call_b64 s[94:95], RESCALE
    s_branch RC_91
FS_92:
    buffer_store_dwordx2 v[92:93], v3, s[12:15], s59 offen sc1
    s_branch FS_93
FS_94:
    buffer_store_dword v96, v3, s[12:15], s29 offen sc1
    s_branch FS_95
RS_96:
    s_call_b64 s[94:95], RESCALE
    s_branch RC_97
RS_101:
    s_call_b64 s[94:95], RESCALE
    s_branch RC_102
L_free:
    ds_read_b128 v[16:19], v9 offset:14336
    ds_read_b128 v[20:23], v9 offset:14464
    v_mov_b32 v32, 0
    v_mov_b32 v33, 0
    v_mov_b32 v34, 0
    v_mov_b32 v35, 0
    v_mov_b32 v36, 0xff800000
    v_mov_b32 v37, 0xff800000
    v_mov_b32 v38, 0
    s_waitcnt lgkmcnt(0)
    s_add_u32 s29, s58, 0x4000000
    buffer_load_dwordx4 v[144:147], v1, s[4:7], s29 offen offset:0 nt
    buffer_load_dwordx4 v[148:151], v1, s[4:7], s29 offen offset:128 nt
    buffer_load_dwordx4 v[152:155], v1, s[4:7], s29 offen offset:2048 nt
    buffer_load_dwordx4 v[156:159], v1, s[4:7], s29 offen offset:2176 nt
    buffer_load_dwordx4 v[160:163], v2, s[8:11], s29 offen offset:0 nt
    buffer_load_dwordx4 v[164:167], v2, s[8:11], s29 offen offset:256 nt
    buffer_load_dwordx4 v[168:171], v2, s[8:11], s29 offen offset:2048 nt
    buffer_load_dwordx4 v[172:175], v2, s[8:11], s29 offen offset:2304 nt
    s_add_u32 s29, s58, 0x4004000
    buffer_load_dwordx4 v[80:83], v1, s[4:7], s29 offen offset:0 nt
    buffer_load_dwordx4 v[84:87], v1, s[4:7], s29 offen offset:128 nt
    buffer_load_dwordx4 v[88:91], v1, s[4:7], s29 offen offset:2048 nt
    buffer_load_dwordx4 v[92:95], v1, s[4:7], s29 offen offset:2176 nt
    buffer_load_dwordx4 v[96:99], v2, s[8:11], s29 offen offset:0 nt
    buffer_load_dwordx4 v[100:103], v2, s[8:11], s29 offen offset:256 nt
    buffer_load_dwordx4 v[104:107], v2, s[8:11], s29 offen offset:2048 nt
    buffer_load_dwordx4 v[108:111], v2, s[8:11], s29 offen offset:2304 nt
    s_add_u32 s29, s58, 0x4008000
    buffer_load_dwordx4 v[112:115], v1, s[4:7], s29 offen offset:0 nt
    buffer_load_dwordx4 v[116:119], v1, s[4:7], s29 offen offset:128 nt
    buffer_load_dwordx4 v[120:123], v1, s[4:7], s29 offen offset:2048 nt
    buffer_load_dwordx4 v[124:127], v1, s[4:7], s29 offen offset:2176 nt
    buffer_load_dwordx4 v[128:131], v2, s[8:11], s29 offen offset:0 nt
    buffer_load_dwordx4 v[132:135], v2, s[8:11], s29 offen offset:256 nt
    buffer_load_dwordx4 v[136:139], v2, s[8:11], s29 offen offset:2048 nt
    buffer_load_dwordx4 v[140:143], v2, s[8:11], s29 offen offset:2304 nt
    s_waitcnt vmcnt(16)
    s_call_b64 s[30:31], U_v144_v160
    s_add_u32 s29, s58, 0x400c000
    buffer_load_dwordx4 v[144:147], v1, s[4:7], s29 offen offset:0 nt
    buffer_load_dwordx4 v[148:151], v1, s[4:7], s29 offen offset:128 nt
    buffer_load_dwordx4 v[152:155], v1, s[4:7], s29 offen offset:2048 nt
    buffer_load_dwordx4 v[156:159], v1, s[4:7], s29 offen offset:2176 nt
    buffer_load_dwordx4 v[160:163], v2, s[8:11], s29 offen offset:0 nt
    buffer_load_dwordx4 v[164:167], v2, s[8:11], s29 offen offset:256 nt
    buffer_load_dwordx4 v[168:171], v2, s[8:11], s29 offen offset:2048 nt
    buffer_load_dwordx4 v[172:175], v2, s[8:11], s29 offen offset:2304 nt
    s_waitcnt vmcnt(16)
    s_call_b64 s[30:31], U_v80_v96
    s_add_u32 s29, s58, 0x4010000
    buffer_load_dwordx4 v[80:83], v1, s[4:7], s29 offen offset:0 nt
    buffer_load_dwordx4 v[84:87], v1, s[4:7], s29 offen offset:128 nt
    buffer_load_dwordx4 v[88:91], v1, s[4:7], s29 offen offset:2048 nt
    buffer_load_dwordx4 v[92:95], v1, s[4:7], s29 offen offset:2176 nt
    buffer_load_dwordx4 v[96:99], v2, s[8:11], s29 offen offset:0 nt
    buffer_load_dwordx4 v[100:103], v2, s[8:11], s29 offen offset:256 nt
    buffer_load_dwordx4 v[104:107], v2, s[8:11], s29 offen offset:2048 nt
    buffer_load_dwordx4 v[108:111], v2, s[8:11], s29 offen offset:2304 nt
    s_waitcnt vmcnt(16)
    s_call_b64 s[30:31], U_v112_v128
    s_add_u32 s29, s58, 0x4014000
    buffer_load_dwordx4 v[112:115], v1, s[4:7], s29 offen offset:0 nt
    buffer_load_dwordx4 v[116:119], v1, s[4:7], s29 offen offset:128 nt
    buffer_load_dwordx4 v[120:123], v1, s[4:7], s29 offen offset:2048 nt
    buffer_load_dwordx4 v[124:127], v1, s[4:7], s29 offen offset:2176 nt
    buffer_load_dwordx4 v[128:131], v2, s[8:11], s29 offen offset:0 nt
    buffer_load_dwordx4 v[132:135], v2, s[8:11], s29 offen offset:256 nt
    buffer_load_dwordx4 v[136:139], v2, s[8:11], s29 offen offset:2048 nt
    buffer_load_dwordx4 v[140:143], v2, s[8:11], s29 offen offset:2304 nt
    s_waitcnt vmcnt(16)
    s_call_b64 s[30:31], U_v144_v160
    s_add_u32 s29, s58, 0x4018000
    buffer_load_dwordx4 v[144:147], v1, s[4:7], s29 offen offset:0 nt
    buffer_load_dwordx4 v[148:151], v1, s[4:7], s29 offen offset:128 nt
    buffer_load_dwordx4 v[152:155], v1, s[4:7], s29 offen offset:2048 nt
    buffer_load_dwordx4 v[156:159], v1, s[4:7], s29 offen offset:2176 nt
    buffer_load_dwordx4 v[160:163], v2, s[8:11], s29 offen offset:0 nt
    buffer_load_dwordx4 v[164:167], v2, s[8:11], s29 offen offset:256 nt
    buffer_load_dwordx4 v[168:171], v2, s[8:11], s29 offen offset:2048 nt
    buffer_load_dwordx4 v[172:175], v2, s[8:11], s29 offen offset:2304 nt
    s_waitcnt vmcnt(16)
    s_call_b64 s[30:31], U_v80_v96
    s_add_u32 s29, s58, 0x401c000
    buffer_load_dwordx4 v[80:83], v1, s[4:7], s29 offen offset:0 nt
    buffer_load_dwordx4 v[84:87], v1, s[4:7], s29 offen offset:128 nt
    buffer_load_dwordx4 v[88:91], v1, s[4:7], s29 offen offset:2048 nt
    buffer_load_dwordx4 v[92:95], v1, s[4:7], s29 offen offset:2176 nt
    buffer_load_dwordx4 v[96:99], v2, s[8:11], s29 offen offset:0 nt
    buffer_load_dwordx4 v[100:103], v2, s[8:11], s29 offen offset:256 nt
    buffer_load_dwordx4 v[104:107], v2, s[8:11], s29 offen offset:2048 nt
    buffer_load_dwordx4 v[108:111], v2, s[8:11], s29 offen offset:2304 nt
    s_waitcnt vmcnt(16)
    s_call_b64 s[30:31], U_v112_v128
    s_add_u32 s29, s58, 0x4020000
    buffer_load_dwordx4 v[112:115], v1, s[4:7], s29 offen offset:0 nt
    buffer_load_dwordx4 v[116:119], v1, s[4:7], s29 offen offset:128 nt
    buffer_load_dwordx4 v[120:123], v1, s[4:7], s29 offen offset:2048 nt
    buffer_load_dwordx4 v[124:127], v1, s[4:7], s29 offen offset:2176 nt
    buffer_load_dwordx4 v[128:131], v2, s[8:11], s29 offen offset:0 nt
    buffer_load_dwordx4 v[132:135], v2, s[8:11], s29 offen offset:256 nt
    buffer_load_dwordx4 v[136:139], v2, s[8:11], s29 offen offset:2048 nt
    buffer_load_dwordx4 v[140:143], v2, s[8:11], s29 offen offset:2304 nt
    s_waitcnt vmcnt(16)
    s_call_b64 s[30:31], U_v144_v160
    s_add_u32 s29, s58, 0x4024000
    buffer_load_dwordx4 v[144:147], v1, s[4:7], s29 offen offset:0 nt
    buffer_load_dwordx4 v[148:151], v1, s[4:7], s29 offen offset:128 nt
    buffer_load_dwordx4 v[152:155], v1, s[4:7], s29 offen offset:2048 nt
    buffer_load_dwordx4 v[156:159], v1, s[4:7], s29 offen offset:2176 nt
    buffer_load_dwordx4 v[160:163], v2, s[8:11], s29 offen offset:0 nt
    buffer_load_dwordx4 v[164:167], v2, s[8:11], s29 offen offset:256 nt
    buffer_load_dwordx4 v[168:171], v2, s[8:11], s29 offen offset:2048 nt
    buffer_load_dwordx4 v[172:175], v2, s[8:11], s29 offen offset:2304 nt
    s_waitcnt vmcnt(16)
    s_call_b64 s[30:31], U_v80_v96
    s_waitcnt vmcnt(8)
    s_call_b64 s[30:31], U_v112_v128
    s_waitcnt vmcnt(0)
    s_call_b64 s[30:31], U_v144_v160
    s_call_b64 s[30:31], F_qgi
    s_add_u32 s29, s58, 0x34000
    buffer_load_dwordx4 v[80:83], v1, s[4:7], s29 offen offset:0 nt
    buffer_load_dwordx4 v[84:87], v1, s[4:7], s29 offen offset:128 nt
    buffer_load_dwordx4 v[88:91], v1, s[4:7], s29 offen offset:2048 nt
    buffer_load_dwordx4 v[92:95], v1, s[4:7], s29 offen offset:2176 nt
    buffer_load_dwordx4 v[96:99], v2, s[8:11], s29 offen offset:0 nt
    buffer_load_dwordx4 v[100:103], v2, s[8:11], s29 offen offset:256 nt
    buffer_load_dwordx4 v[104:107], v2, s[8:11], s29 offen offset:2048 nt
    buffer_load_dwordx4 v[108:111], v2, s[8:11], s29 offen offset:2304 nt
    s_nop 7
    v_mov_b32 v60, v32
    v_mov_b32 v61, v33
    v_mov_b32 v62, v34
    v_mov_b32 v63, v35
    v_mov_b32 v64, v36
    v_mov_b32 v65, v37
    v_mov_b32 v66, v38
    s_waitcnt vmcnt(8)
    s_call_b64 s[30:31], F_qgf
    s_call_b64 s[30:31], U_a224_a240
    s_call_b64 s[30:31], U_a192_a208
    ds_read_b128 a[224:227], v10 offset:0
    ds_read_b128 a[228:231], v10 offset:1024
    ds_read_b128 a[232:235], v10 offset:2048
    ds_read_b128 a[236:239], v10 offset:3072
    ds_read_b128 a[240:243], v10 offset:4096
    ds_read_b128 a[244:247], v10 offset:5120
    ds_read_b128 a[248:251], v10 offset:6144
    ds_read_b128 a[252:255], v10 offset:7168
    s_waitcnt lgkmcnt(0)
    s_call_b64 s[30:31], U_a224_a240
    s_add_u32 s29, s58, 0x4028000
    s_add_u32 m0, s71, 0
    s_nop 0
    buffer_load_dwordx4 v1, s[4:7], s29 offen offset:0 nt lds
    s_add_u32 m0, s71, 896
    s_nop 0
    buffer_load_dwordx4 v1, s[4:7], s29 offen offset:128 nt lds
    s_add_u32 m0, s71, 0
    s_nop 0
    buffer_load_dwordx4 v1, s[4:7], s29 offen offset:2048 nt lds
    s_add_u32 m0, s71, 896
    s_nop 0
    buffer_load_dwordx4 v1, s[4:7], s29 offen offset:2176 nt lds
    s_add_u32 m0, s71, 4096
    s_nop 0
    buffer_load_dwordx4 v2, s[8:11], s29 offen offset:0 nt lds
    s_add_u32 m0, s71, 4864
    s_nop 0
    buffer_load_dwordx4 v2, s[8:11], s29 offen offset:256 nt lds
    s_add_u32 m0, s71, 4096
    s_nop 0
    buffer_load_dwordx4 v2, s[8:11], s29 offen offset:2048 nt lds
    s_add_u32 m0, s71, 4864
    s_nop 0
    buffer_load_dwordx4 v2, s[8:11], s29 offen offset:2304 nt lds
    ds_read_b128 a[192:195], v10 offset:8192
    ds_read_b128 a[196:199], v10 offset:9216
    ds_read_b128 a[200:203], v10 offset:10240
    ds_read_b128 a[204:207], v10 offset:11264
    ds_read_b128 a[208:211], v10 offset:12288
    ds_read_b128 a[212:215], v10 offset:13312
    ds_read_b128 a[216:219], v10 offset:14336
    ds_read_b128 a[220:223], v10 offset:15360
    s_waitcnt lgkmcnt(0)
    s_call_b64 s[30:31], U_a192_a208
    ds_read_b128 a[224:227], v10 offset:16384
    ds_read_b128 a[228:231], v10 offset:17408
    ds_read_b128 a[232:235], v10 offset:18432
    ds_read_b128 a[236:239], v10 offset:19456
    ds_read_b128 a[240:243], v10 offset:20480
    ds_read_b128 a[244:247], v10 offset:21504
    ds_read_b128 a[248:251], v10 offset:22528
    ds_read_b128 a[252:255], v10 offset:23552
    s_waitcnt lgkmcnt(0)
    s_call_b64 s[30:31], U_a224_a240
    ds_read_b128 a[192:195], v10 offset:24576
    ds_read_b128 a[196:199], v10 offset:25600
    ds_read_b128 a[200:203], v10 offset:26624
    ds_read_b128 a[204:207], v10 offset:27648
    ds_read_b128 a[208:211], v10 offset:28672
    ds_read_b128 a[212:215], v10 offset:29696
    ds_read_b128 a[216:219], v10 offset:30720
    ds_read_b128 a[220:223], v10 offset:31744
    s_waitcnt lgkmcnt(0)
    s_call_b64 s[30:31], U_a192_a208
    s_add_u32 s29, s58, 0x402c000
    s_add_u32 m0, s71, 8192
    s_nop 0
    buffer_load_dwordx4 v1, s[4:7], s29 offen offset:0 nt lds
    s_add_u32 m0, s71, 9088
    s_nop 0
    buffer_load_dwordx4 v1, s[4:7], s29 offen offset:128 nt lds
    s_add_u32 m0, s71, 8192
    s_nop 0
    buffer_load_dwordx4 v1, s[4:7], s29 offen offset:2048 nt lds
    s_add_u32 m0, s71, 9088
    s_nop 0
    buffer_load_dwordx4 v1, s[4:7], s29 offen offset:2176 nt lds
    s_add_u32 m0, s71, 12288
    s_nop 0
    buffer_load_dwordx4 v2, s[8:11], s29 offen offset:0 nt lds
    s_add_u32 m0, s71, 13056
    s_nop 0
    buffer_load_dwordx4 v2, s[8:11], s29 offen offset:256 nt lds
    s_add_u32 m0, s71, 12288
    s_nop 0
    buffer_load_dwordx4 v2, s[8:11], s29 offen offset:2048 nt lds
    s_add_u32 m0, s71, 13056
    s_nop 0
    buffer_load_dwordx4 v2, s[8:11], s29 offen offset:2304 nt lds
    ds_read_b128 a[224:227], v10 offset:32768
    ds_read_b128 a[228:231], v10 offset:33792
    ds_read_b128 a[232:235], v10 offset:34816
    ds_read_b128 a[236:239], v10 offset:35840
    s_waitcnt lgkmcnt(0)
    s_call_b64 s[30:31], U_a224_v240
    s_call_b64 s[30:31], U_a160_a176
    s_call_b64 s[30:31], U_a128_a144
    s_add_u32 s29, s58, 0x4030000
    s_add_u32 m0, s71, 16384
    s_nop 0
    buffer_load_dwordx4 v1, s[4:7], s29 offen offset:0 nt lds
    s_add_u32 m0, s71, 17280
    s_nop 0
    buffer_load_dwordx4 v1, s[4:7], s29 offen offset:128 nt lds
    s_add_u32 m0, s71, 16384
    s_nop 0
    buffer_load_dwordx4 v1, s[4:7], s29 offen offset:2048 nt lds
    s_add_u32 m0, s71, 17280
    s_nop 0
    buffer_load_dwordx4 v1, s[4:7], s29 offen offset:2176 nt lds
    s_add_u32 m0, s71, 20480
    s_nop 0
    buffer_load_dwordx4 v2, s[8:11], s29 offen offset:0 nt lds
    s_add_u32 m0, s71, 21248
    s_nop 0
    buffer_load_dwordx4 v2, s[8:11], s29 offen offset:256 nt lds
    s_add_u32 m0, s71, 20480
    s_nop 0
    buffer_load_dwordx4 v2, s[8:11], s29 offen offset:2048 nt lds
    s_add_u32 m0, s71, 21248
    s_nop 0
    buffer_load_dwordx4 v2, s[8:11], s29 offen offset:2304 nt lds
    s_call_b64 s[30:31], U_a96_a112
    s_call_b64 s[30:31], U_a64_a80
    s_call_b64 s[30:31], U_a32_a48
    s_add_u32 s29, s58, 0x4034000
    s_add_u32 m0, s71, 24576
    s_nop 0
    buffer_load_dwordx4 v1, s[4:7], s29 offen offset:0 nt lds
    s_add_u32 m0, s71, 25472
    s_nop 0
    buffer_load_dwordx4 v1, s[4:7], s29 offen offset:128 nt lds
    s_add_u32 m0, s71, 24576
    s_nop 0
    buffer_load_dwordx4 v1, s[4:7], s29 offen offset:2048 nt lds
    s_add_u32 m0, s71, 25472
    s_nop 0
    buffer_load_dwordx4 v1, s[4:7], s29 offen offset:2176 nt lds
    s_add_u32 m0, s71, 28672
    s_nop 0
    buffer_load_dwordx4 v2, s[8:11], s29 offen offset:0 nt lds
    s_add_u32 m0, s71, 29440
    s_nop 0
    buffer_load_dwordx4 v2, s[8:11], s29 offen offset:256 nt lds
    s_add_u32 m0, s71, 28672
    s_nop 0
    buffer_load_dwordx4 v2, s[8:11], s29 offen offset:2048 nt lds
    s_add_u32 m0, s71, 29440
    s_nop 0
    buffer_load_dwordx4 v2, s[8:11], s29 offen offset:2304 nt lds
    s_call_b64 s[30:31], U_a0_a16
    s_call_b64 s[30:31], U_v176_v192
    s_call_b64 s[30:31], U_v208_v224
    s_add_u32 s29, s58, 0x4038000
    s_add_u32 m0, s71, 32768
    s_nop 0
    buffer_load_dwordx4 v1, s[4:7], s29 offen offset:0 nt lds
    s_add_u32 m0, s71, 33664
    s_nop 0
    buffer_load_dwordx4 v1, s[4:7], s29 offen offset:128 nt lds
    s_add_u32 m0, s71, 32768
    s_nop 0
    buffer_load_dwordx4 v1, s[4:7], s29 offen offset:2048 nt lds
    s_add_u32 m0, s71, 33664
    s_nop 0
    buffer_load_dwordx4 v1, s[4:7], s29 offen offset:2176 nt lds
    buffer_load_dwordx4 v[240:243], v2, s[8:11], s29 offen offset:0 nt
    buffer_load_dwordx4 v[244:247], v2, s[8:11], s29 offen offset:256 nt
    buffer_load_dwordx4 v[248:251], v2, s[8:11], s29 offen offset:2048 nt
    buffer_load_dwordx4 v[252:255], v2, s[8:11], s29 offen offset:2304 nt
    s_waitcnt vmcnt(40)
    s_call_b64 s[30:31], U_v80_v96
    s_mov_b32 s81, 2
    s_mov_b32 s82, 0
    s_mov_b32 s83, 9216
    s_mov_b32 s84, 0x20000
    s_mov_b32 s85, 14848
    s_mov_b32 s101, 13824
    s_call_b64 s[30:31], F_comb
    v_lshrrev_b32 v45, 4, v0
    v_min_u32 v45, 2, v45
    v_lshlrev_b32 v45, 18, v45
    v_and_b32 v44, 0xf0, v8
    v_add_u32 v45, v45, v44
    s_lshl_b32 s59, s26, 10
    s_add_u32 s59, s59, s78
    s_add_u32 s59, s59, 0x40000
    buffer_load_dword v44, v45, s[12:15], s59 offen sc1
    ds_read_b128 v[16:19], v9 offset:14336
    ds_read_b128 v[20:23], v9 offset:14464
    v_mov_b32 v32, v60
    v_mov_b32 v33, v61
    v_mov_b32 v34, v62
    v_mov_b32 v35, v63
    v_mov_b32 v36, v64
    v_mov_b32 v37, v65
    v_mov_b32 v38, v66
    s_waitcnt lgkmcnt(0)
    s_waitcnt vmcnt(35)
    ds_read_b128 a[224:227], v10 offset:0
    ds_read_b128 a[228:231], v10 offset:1024
    ds_read_b128 a[232:235], v10 offset:2048
    ds_read_b128 a[236:239], v10 offset:3072
    ds_read_b128 a[240:243], v10 offset:4096
    ds_read_b128 a[244:247], v10 offset:5120
    ds_read_b128 a[248:251], v10 offset:6144
    ds_read_b128 a[252:255], v10 offset:7168
    s_waitcnt lgkmcnt(0)
    s_call_b64 s[30:31], U_a224_a240
    s_waitcnt vmcnt(27)
    ds_read_b128 a[192:195], v10 offset:8192
    ds_read_b128 a[196:199], v10 offset:9216
    ds_read_b128 a[200:203], v10 offset:10240
    ds_read_b128 a[204:207], v10 offset:11264
    ds_read_b128 a[208:211], v10 offset:12288
    ds_read_b128 a[212:215], v10 offset:13312
    ds_read_b128 a[216:219], v10 offset:14336
    ds_read_b128 a[220:223], v10 offset:15360
    s_waitcnt lgkmcnt(0)
    s_call_b64 s[30:31], U_a192_a208
    s_waitcnt vmcnt(19)
    ds_read_b128 a[224:227], v10 offset:16384
    ds_read_b128 a[228:231], v10 offset:17408
    ds_read_b128 a[232:235], v10 offset:18432
    ds_read_b128 a[236:239], v10 offset:19456
    ds_read_b128 a[240:243], v10 offset:20480
    ds_read_b128 a[244:247], v10 offset:21504
    ds_read_b128 a[248:251], v10 offset:22528
    ds_read_b128 a[252:255], v10 offset:23552
    s_waitcnt lgkmcnt(0)
    s_call_b64 s[30:31], U_a224_a240
    s_add_u32 s29, s58, 0x403c000
    buffer_load_dwordx4 v[208:211], v1, s[4:7], s29 offen offset:0 nt
    buffer_load_dwordx4 v[212:215], v1, s[4:7], s29 offen offset:128 nt
    buffer_load_dwordx4 v[216:219], v1, s[4:7], s29 offen offset:2048 nt
    buffer_load_dwordx4 v[220:223], v1, s[4:7], s29 offen offset:2176 nt
    buffer_load_dwordx4 v[224:227], v2, s[8:11], s29 offen offset:0 nt
    buffer_load_dwordx4 v[228:231], v2, s[8:11], s29 offen offset:256 nt
    buffer_load_dwordx4 v[232:235], v2, s[8:11], s29 offen offset:2048 nt
    buffer_load_dwordx4 v[236:239], v2, s[8:11], s29 offen offset:2304 nt
    s_waitcnt vmcnt(19)
    ds_read_b128 a[192:195], v10 offset:24576
    ds_read_b128 a[196:199], v10 offset:25600
    ds_read_b128 a[200:203], v10 offset:26624
    ds_read_b128 a[204:207], v10 offset:27648
    ds_read_b128 a[208:211], v10 offset:28672
    ds_read_b128 a[212:215], v10 offset:29696
    ds_read_b128 a[216:219], v10 offset:30720
    ds_read_b128 a[220:223], v10 offset:31744
    s_waitcnt lgkmcnt(0)
    s_call_b64 s[30:31], U_a192_a208
    s_call_b64 s[30:31], F_yi
    s_waitcnt vmcnt(0)
    v_add_u32 v12, s83, v8
    v_add_u32 v13, s83, v3
    ds_write_b128 v12, v[80:83]
    ds_write_b128 v12, v[84:87] offset:1024
    ds_write_b32 v13, v88 offset:2048
    s_add_u32 s60, s26, 4294967284
    s_lshl_b32 s80, s25, 8
    s_lshl_b32 s29, s24, 6
    s_add_u32 s80, s80, s29
    s_mul_i32 s80, s80, 1152
    s_lshl_b32 s29, s60, 7
    s_add_u32 s80, s80, s29
    s_cmp_ge_u32 s60, 9
    s_cselect_b32 s80, 0x40000000, s80
    s_lshl_b32 s69, s81, 18
    s_add_u32 s69, s69, s78
    s_lshl_b32 s70, s81, 12
    s_add_u32 s70, s70, s79
    s_call_b64 s[30:31], F_wow
    s_call_b64 s[30:31], F_woi
    s_waitcnt vmcnt(0)
    s_call_b64 s[30:31], F_wof
    s_barrier
    s_add_u32 s60, s26, 4294967288
    s_lshl_b32 s80, s25, 8
    s_lshl_b32 s29, s24, 6
    s_add_u32 s80, s80, s29
    s_mul_i32 s80, s80, 1152
    s_lshl_b32 s29, s60, 7
    s_add_u32 s80, s80, s29
    s_cmp_ge_u32 s60, 9
    s_cselect_b32 s80, 0x40000000, s80
    s_lshl_b32 s69, s81, 18
    s_add_u32 s69, s69, s78
    s_lshl_b32 s70, s81, 12
    s_add_u32 s70, s70, s79
    s_call_b64 s[30:31], F_wow
    s_call_b64 s[30:31], F_woi
    s_waitcnt vmcnt(0)
    s_call_b64 s[30:31], F_wof
    s_barrier
    s_add_u32 s60, s26, 4294967292
    s_lshl_b32 s80, s25, 8
    s_lshl_b32 s29, s24, 6
    s_add_u32 s80, s80, s29
    s_mul_i32 s80, s80, 1152
    s_lshl_b32 s29, s60, 7
    s_add_u32 s80, s80, s29
    s_cmp_ge_u32 s60, 9
    s_cselect_b32 s80, 0x40000000, s80
    s_lshl_b32 s69, s81, 18
    s_add_u32 s69, s69, s78
    s_lshl_b32 s70, s81, 12
    s_add_u32 s70, s70, s79
    s_call_b64 s[30:31], F_wow
    s_call_b64 s[30:31], F_woi
    s_waitcnt vmcnt(0)
    s_call_b64 s[30:31], F_wof
    s_barrier
    s_mov_b32 s60, s26
    s_lshl_b32 s80, s25, 8
    s_lshl_b32 s29, s24, 6
    s_add_u32 s80, s80, s29
    s_mul_i32 s80, s80, 1152
    s_lshl_b32 s29, s60, 7
    s_add_u32 s80, s80, s29
    s_cmp_ge_u32 s60, 9
    s_cselect_b32 s80, 0x40000000, s80
    ds_read_b128 a[224:227], v10 offset:32768
    ds_read_b128 a[228:231], v10 offset:33792
    ds_read_b128 a[232:235], v10 offset:34816
    ds_read_b128 a[236:239], v10 offset:35840
    s_waitcnt lgkmcnt(0)
    s_call_b64 s[30:31], U_a224_v240
    s_call_b64 s[30:31], U_v208_v224
    s_mov_b32 s81, 1
    s_mov_b32 s82, 1
    s_mov_b32 s83, 11520
    s_mov_b32 s84, 0x30000
    s_mov_b32 s85, 14848
    s_mov_b32 s101, 13824
    s_call_b64 s[30:31], F_comb
    s_mov_b32 s81, 2
    s_mov_b32 s82, 0
    s_mov_b32 s83, 9216
    s_mov_b32 s84, 0x20000
    s_mov_b32 s85, 14848
    s_mov_b32 s101, 13824
    s_mul_i32 s70, s81, 36864
    s_add_u32 s70, s70, 0x44000
    s_mul_i32 s69, s24, 9216
    s_add_u32 s69, s69, s70
    s_barrier
    s_mov_b32 s62, 1
    s_sub_u32 s61, s2, 192
    s_mul_i32 s61, s61, 3
    s_call_b64 s[30:31], F_g4i
    s_waitcnt vmcnt(14)
    s_call_b64 s[30:31], F_up
    s_waitcnt vmcnt(0)
    s_call_b64 s[30:31], F_xc
    s_mul_i32 s73, s61, 12
    s_add_u32 s91, s58, 0x4000000
    buffer_load_dwordx4 a[192:195], v1, s[4:7], s91 offen offset:0 nt
    buffer_load_dwordx4 a[196:199], v1, s[4:7], s91 offen offset:128 nt
    buffer_load_dwordx4 a[200:203], v1, s[4:7], s91 offen offset:2048 nt
    buffer_load_dwordx4 a[204:207], v1, s[4:7], s91 offen offset:2176 nt
    buffer_load_dwordx4 a[208:211], v2, s[8:11], s91 offen offset:0 nt
    buffer_load_dwordx4 a[212:215], v2, s[8:11], s91 offen offset:256 nt
    buffer_load_dwordx4 a[216:219], v2, s[8:11], s91 offen offset:2048 nt
    buffer_load_dwordx4 a[220:223], v2, s[8:11], s91 offen offset:2304 nt
    v_and_b32 v14, 12, v3
    v_add_u32 v14, s73, v14
    v_add_u32 v15, s83, v14
    ds_read_b32 v58, v15
    s_waitcnt lgkmcnt(0)
    s_barrier
    ds_read_b32 v143, v14 offset:0
    ds_read_b32 v12, v14 offset:2304
    ds_read_b32 v13, v14 offset:4608
    ds_read_b32 v15, v14 offset:6912
    ds_read_b128 v[80:83], v8 offset:0
    ds_read_b128 v[84:87], v8 offset:1024
    ds_read_b32 v112, v3 offset:2048
    ds_read_b128 v[88:91], v8 offset:2304
    ds_read_b128 v[92:95], v8 offset:3328
    ds_read_b32 v113, v3 offset:4352
    ds_read_b128 v[96:99], v8 offset:4608
    ds_read_b128 v[100:103], v8 offset:5632
    ds_read_b32 v114, v3 offset:6656
    ds_read_b128 v[104:107], v8 offset:6912
    ds_read_b128 v[108:111], v8 offset:7936
    ds_read_b32 v115, v3 offset:8960
    s_waitcnt lgkmcnt(12)
    v_add_f32 v143, v143, v12
    v_add_f32 v13, v13, v15
    v_add_f32 v143, v143, v13
    v_cvt_pk_bf16_f32 v12, v143, v143
    v_lshlrev_b32 v143, 16, v12
    v_add_f32 v143, v143, v58
    v_cvt_pk_bf16_f32 v12, v143, v143
    v_lshlrev_b32 v143, 16, v12
    s_waitcnt lgkmcnt(6)
    v_pk_add_f32 v[48:49], v[48:49], v[80:81]
    v_pk_add_f32 v[50:51], v[50:51], v[82:83]
    v_pk_add_f32 v[52:53], v[52:53], v[84:85]
    v_pk_add_f32 v[54:55], v[54:55], v[86:87]
    v_pk_add_f32 v[48:49], v[48:49], v[88:89]
    v_pk_add_f32 v[50:51], v[50:51], v[90:91]
    v_pk_add_f32 v[52:53], v[52:53], v[92:93]
    v_pk_add_f32 v[54:55], v[54:55], v[94:95]
    s_waitcnt lgkmcnt(0)
    v_pk_add_f32 v[96:97], v[96:97], v[104:105]
    v_pk_add_f32 v[98:99], v[98:99], v[106:107]
    v_pk_add_f32 v[100:101], v[100:101], v[108:109]
    v_pk_add_f32 v[102:103], v[102:103], v[110:111]
    v_pk_add_f32 v[112:113], v[112:113], v[114:115]
    v_pk_add_f32 v[48:49], v[48:49], v[96:97]
    v_pk_add_f32 v[50:51], v[50:51], v[98:99]
    v_pk_add_f32 v[52:53], v[52:53], v[100:101]
    v_pk_add_f32 v[54:55], v[54:55], v[102:103]
    v_add_f32 v56, v56, v112
    v_add_f32 v56, v56, v113
    v_pk_add_f32 v[100:101], v[48:49], v[50:51]
    v_pk_add_f32 v[80:81], v[52:53], v[54:55]
    v_pk_add_f32 v[100:101], v[100:101], v[80:81]
    v_add_f32 v100, v100, v56
    v_add_f32 v100, v100, v101
    s_nop 1
    v_add_f32_dpp v100, v100, v100 row_ror:8 row_mask:0xf bank_mask:0xf
    s_nop 1
    v_add_f32_dpp v100, v100, v100 row_ror:4 row_mask:0xf bank_mask:0xf
    s_nop 1
    v_add_f32_dpp v100, v100, v100 row_ror:2 row_mask:0xf bank_mask:0xf
    s_nop 1
    v_add_f32_dpp v100, v100, v100 row_ror:1 row_mask:0xf bank_mask:0xf
    v_mov_b32 v12, v100
    s_nop 1
    v_permlane16_swap_b32 v100, v12
    v_add_f32 v100, v100, v12
    v_mov_b32 v12, v100
    s_nop 1
    v_permlane32_swap_b32 v100, v12
    v_add_f32 v100, v100, v12
    v_mul_f32 v100, 0x3ae38e39, v100
    v_pk_add_f32 v[80:81], v[48:49], v[100:101] op_sel_hi:[1,0] neg_lo:[0,1] neg_hi:[0,1]
    v_pk_add_f32 v[82:83], v[50:51], v[100:101] op_sel_hi:[1,0] neg_lo:[0,1] neg_hi:[0,1]
    v_pk_add_f32 v[84:85], v[52:53], v[100:101] op_sel_hi:[1,0] neg_lo:[0,1] neg_hi:[0,1]
    v_pk_add_f32 v[86:87], v[54:55], v[100:101] op_sel_hi:[1,0] neg_lo:[0,1] neg_hi:[0,1]
    v_sub_f32 v88, v56, v100
    v_pk_mul_f32 v[80:81], v[80:81], v[80:81]
    v_mul_f32 v101, v88, v88
    v_pk_fma_f32 v[80:81], v[82:83], v[82:83], v[80:81]
    v_pk_fma_f32 v[80:81], v[84:85], v[84:85], v[80:81]
    v_pk_fma_f32 v[80:81], v[86:87], v[86:87], v[80:81]
    v_add_f32 v101, v101, v80
    v_add_f32 v101, v101, v81
    s_nop 1
    v_add_f32_dpp v101, v101, v101 row_ror:8 row_mask:0xf bank_mask:0xf
    s_nop 1
    v_add_f32_dpp v101, v101, v101 row_ror:4 row_mask:0xf bank_mask:0xf
    s_nop 1
    v_add_f32_dpp v101, v101, v101 row_ror:2 row_mask:0xf bank_mask:0xf
    s_nop 1
    v_add_f32_dpp v101, v101, v101 row_ror:1 row_mask:0xf bank_mask:0xf
    v_mov_b32 v12, v101
    s_nop 1
    v_permlane16_swap_b32 v101, v12
    v_add_f32 v101, v101, v12
    v_mov_b32 v12, v101
    s_nop 1
    v_permlane32_swap_b32 v101, v12
    v_add_f32 v101, v101, v12
    v_mul_f32 v101, 0x3ae38e39, v101
    v_cvt_pk_bf16_f32 v12, v100, v101
    v_lshlrev_b32 v80, 16, v12
    v_and_b32 v81, 0xffff0000, v12
    v_add_f32 v81, s90, v81
    v_sub_f32 v13, v143, v80
    v_cvt_pk_bf16_f32 v12, v81, v13
    v_lshlrev_b32 v81, 16, v12
    v_and_b32 v13, 0xffff0000, v12
    v_sqrt_f32 v81, v81
    v_sub_f32 v82, v100, v80
    v_cvt_pk_bf16_f32 v12, v81, v81
    v_lshlrev_b32 v81, 16, v12
    v_rcp_f32 v81, v81
    s_nop 0
    v_mul_f32 v101, v101, v81
    v_mul_f32 v82, v82, v81
    v_mul_f32 v101, v101, v81
    v_mul_f32 v13, v13, v81
    v_cvt_pk_bf16_f32 v12, v82, v101
    v_lshlrev_b32 v82, 16, v12
    v_and_b32 v101, 0xffff0000, v12
    v_add_f32 v101, s90, v101
    v_cvt_pk_bf16_f32 v12, v13, v101
    v_lshlrev_b32 v13, 16, v12
    v_and_b32 v101, 0xffff0000, v12
    v_sqrt_f32 v101, v101
    v_sub_f32 v13, v13, v82
    v_cvt_pk_bf16_f32 v12, v13, v101
    v_lshlrev_b32 v13, 16, v12
    v_and_b32 v101, 0xffff0000, v12
    v_rcp_f32 v101, v101
    s_nop 0
    v_mul_f32 v13, v13, v101
    v_cvt_pk_bf16_f32 v12, v13, v13
    v_lshlrev_b32 v13, 16, v12
    v_mov_b32 v108, 0xc0135761
    s_nop 0
    v_mov_b32_dpp v102, v13 quad_perm:[0,0,0,0] row_mask:0xf bank_mask:0xf
    v_mov_b32_dpp v104, v13 quad_perm:[1,1,1,1] row_mask:0xf bank_mask:0xf
    v_mov_b32_dpp v106, v13 quad_perm:[2,2,2,2] row_mask:0xf bank_mask:0xf
    v_pk_fma_f32 v[86:87], v[102:103], v[116:117], v[124:125] op_sel_hi:[0,1,1]
    v_pk_fma_f32 v[88:89], v[104:105], v[116:117], v[124:125] op_sel_hi:[0,1,1]
    v_pk_fma_f32 v[90:91], v[106:107], v[116:117], v[124:125] op_sel_hi:[0,1,1]
    v_pk_mul_f32 v[92:93], v[86:87], v[86:87]
    v_pk_mul_f32 v[94:95], v[88:89], v[88:89]
    v_pk_mul_f32 v[96:97], v[90:91], v[90:91]
    v_pk_fma_f32 v[92:93], v[92:93], s[66:67], v[108:109] op_sel_hi:[1,1,0]
    v_pk_fma_f32 v[94:95], v[94:95], s[66:67], v[108:109] op_sel_hi:[1,1,0]
    v_pk_fma_f32 v[96:97], v[96:97], s[66:67], v[108:109] op_sel_hi:[1,1,0]
    v_pk_mul_f32 v[92:93], v[92:93], v[86:87]
    v_pk_mul_f32 v[94:95], v[94:95], v[88:89]
    v_pk_mul_f32 v[96:97], v[96:97], v[90:91]
    v_exp_f32 v92, v92
    v_exp_f32 v93, v93
    v_exp_f32 v94, v94
    v_exp_f32 v95, v95
    v_exp_f32 v96, v96
    v_exp_f32 v97, v97
    v_pk_mul_f32 v[86:87], v[86:87], v[132:133]
    v_pk_mul_f32 v[88:89], v[88:89], v[132:133]
    v_pk_mul_f32 v[90:91], v[90:91], v[132:133]
    v_pk_add_f32 v[92:93], v[92:93], 1.0 op_sel_hi:[1,0]
    v_pk_add_f32 v[94:95], v[94:95], 1.0 op_sel_hi:[1,0]
    v_pk_add_f32 v[96:97], v[96:97], 1.0 op_sel_hi:[1,0]
    v_rcp_f32 v92, v92
    v_rcp_f32 v93, v93
    v_rcp_f32 v94, v94
    s_add_u32 s92, s58, 0x4004000
    buffer_load_dwordx4 a[224:227], v1, s[4:7], s92 offen offset:0 nt
    buffer_load_dwordx4 a[228:231], v1, s[4:7], s92 offen offset:128 nt
    buffer_load_dwordx4 a[232:235], v1, s[4:7], s92 offen offset:2048 nt
    buffer_load_dwordx4 a[236:239], v1, s[4:7], s92 offen offset:2176 nt
    buffer_load_dwordx4 a[240:243], v2, s[8:11], s92 offen offset:0 nt
    buffer_load_dwordx4 a[244:247], v2, s[8:11], s92 offen offset:256 nt
    buffer_load_dwordx4 a[248:251], v2, s[8:11], s92 offen offset:2048 nt
    buffer_load_dwordx4 a[252:255], v2, s[8:11], s92 offen offset:2304 nt
    v_rcp_f32 v95, v95
    v_rcp_f32 v96, v96
    v_rcp_f32 v97, v97
    v_pk_mul_f32 v[110:111], v[86:87], v[92:93]
    v_pk_mul_f32 v[112:113], v[88:89], v[94:95]
    v_pk_mul_f32 v[114:115], v[90:91], v[96:97]
    v_pk_fma_f32 v[86:87], v[102:103], v[118:119], v[126:127] op_sel_hi:[0,1,1]
    v_pk_fma_f32 v[88:89], v[104:105], v[118:119], v[126:127] op_sel_hi:[0,1,1]
    v_pk_fma_f32 v[90:91], v[106:107], v[118:119], v[126:127] op_sel_hi:[0,1,1]
    v_pk_mul_f32 v[92:93], v[86:87], v[86:87]
    v_pk_mul_f32 v[94:95], v[88:89], v[88:89]
    v_pk_mul_f32 v[96:97], v[90:91], v[90:91]
    v_pk_fma_f32 v[92:93], v[92:93], s[66:67], v[108:109] op_sel_hi:[1,1,0]
    v_pk_fma_f32 v[94:95], v[94:95], s[66:67], v[108:109] op_sel_hi:[1,1,0]
    v_pk_fma_f32 v[96:97], v[96:97], s[66:67], v[108:109] op_sel_hi:[1,1,0]
    v_pk_mul_f32 v[92:93], v[92:93], v[86:87]
    v_pk_mul_f32 v[94:95], v[94:95], v[88:89]
    v_pk_mul_f32 v[96:97], v[96:97], v[90:91]
    v_exp_f32 v92, v92
    v_exp_f32 v93, v93
    v_exp_f32 v94, v94
    v_exp_f32 v95, v95
    v_exp_f32 v96, v96
    v_exp_f32 v97, v97
    v_pk_mul_f32 v[86:87], v[86:87], v[134:135]
    v_pk_mul_f32 v[88:89], v[88:89], v[134:135]
    v_pk_mul_f32 v[90:91], v[90:91], v[134:135]
    v_pk_add_f32 v[92:93], v[92:93], 1.0 op_sel_hi:[1,0]
    v_pk_add_f32 v[94:95], v[94:95], 1.0 op_sel_hi:[1,0]
    v_pk_add_f32 v[96:97], v[96:97], 1.0 op_sel_hi:[1,0]
    v_rcp_f32 v92, v92
    v_rcp_f32 v93, v93
    v_rcp_f32 v94, v94
    v_rcp_f32 v95, v95
    v_rcp_f32 v96, v96
    v_rcp_f32 v97, v97
    v_pk_fma_f32 v[110:111], v[86:87], v[92:93], v[110:111]
    v_pk_fma_f32 v[112:113], v[88:89], v[94:95], v[112:113]
    v_pk_fma_f32 v[114:115], v[90:91], v[96:97], v[114:115]
    v_and_b32 v84, 0xffff0000, v136
    v_and_b32 v85, 0xffff0000, v137
    v_pk_fma_f32 v[86:87], v[102:103], v[120:121], v[128:129] op_sel_hi:[0,1,1]
    v_pk_fma_f32 v[88:89], v[104:105], v[120:121], v[128:129] op_sel_hi:[0,1,1]
    v_pk_fma_f32 v[90:91], v[106:107], v[120:121], v[128:129] op_sel_hi:[0,1,1]
    v_pk_mul_f32 v[92:93], v[86:87], v[86:87]
    v_pk_mul_f32 v[94:95], v[88:89], v[88:89]
    v_pk_mul_f32 v[96:97], v[90:91], v[90:91]
    v_pk_fma_f32 v[92:93], v[92:93], s[66:67], v[108:109] op_sel_hi:[1,1,0]
    v_pk_fma_f32 v[94:95], v[94:95], s[66:67], v[108:109] op_sel_hi:[1,1,0]
    v_pk_fma_f32 v[96:97], v[96:97], s[66:67], v[108:109] op_sel_hi:[1,1,0]
    v_pk_mul_f32 v[92:93], v[92:93], v[86:87]
    v_pk_mul_f32 v[94:95], v[94:95], v[88:89]
    v_pk_mul_f32 v[96:97], v[96:97], v[90:91]
    v_exp_f32 v92, v92
    v_exp_f32 v93, v93
    v_exp_f32 v94, v94
    v_exp_f32 v95, v95
    v_exp_f32 v96, v96
    v_exp_f32 v97, v97
    v_pk_mul_f32 v[86:87], v[86:87], v[84:85]
    v_pk_mul_f32 v[88:89], v[88:89], v[84:85]
    v_pk_mul_f32 v[90:91], v[90:91], v[84:85]
    v_pk_add_f32 v[92:93], v[92:93], 1.0 op_sel_hi:[1,0]
    v_pk_add_f32 v[94:95], v[94:95], 1.0 op_sel_hi:[1,0]
    v_pk_add_f32 v[96:97], v[96:97], 1.0 op_sel_hi:[1,0]
    v_rcp_f32 v92, v92
    v_rcp_f32 v93, v93
    v_rcp_f32 v94, v94
    v_rcp_f32 v95, v95
    v_rcp_f32 v96, v96
    v_rcp_f32 v97, v97
    v_pk_fma_f32 v[110:111], v[86:87], v[92:93], v[110:111]
    v_pk_fma_f32 v[112:113], v[88:89], v[94:95], v[112:113]
    v_pk_fma_f32 v[114:115], v[90:91], v[96:97], v[114:115]
    v_and_b32 v84, 0xffff0000, v138
    v_and_b32 v85, 0xffff0000, v139
    v_pk_fma_f32 v[86:87], v[102:103], v[122:123], v[130:131] op_sel_hi:[0,1,1]
    v_pk_fma_f32 v[88:89], v[104:105], v[122:123], v[130:131] op_sel_hi:[0,1,1]
    v_pk_fma_f32 v[90:91], v[106:107], v[122:123], v[130:131] op_sel_hi:[0,1,1]
    v_pk_mul_f32 v[92:93], v[86:87], v[86:87]
    v_pk_mul_f32 v[94:95], v[88:89], v[88:89]
    v_pk_mul_f32 v[96:97], v[90:91], v[90:91]
    v_pk_fma_f32 v[92:93], v[92:93], s[66:67], v[108:109] op_sel_hi:[1,1,0]
    v_pk_fma_f32 v[94:95], v[94:95], s[66:67], v[108:109] op_sel_hi:[1,1,0]
    v_pk_fma_f32 v[96:97], v[96:97], s[66:67], v[108:109] op_sel_hi:[1,1,0]
    v_pk_mul_f32 v[92:93], v[92:93], v[86:87]
    v_pk_mul_f32 v[94:95], v[94:95], v[88:89]
    v_pk_mul_f32 v[96:97], v[96:97], v[90:91]
    v_exp_f32 v92, v92
    v_exp_f32 v93, v93
    v_exp_f32 v94, v94
    v_exp_f32 v95, v95
    v_exp_f32 v96, v96
    v_exp_f32 v97, v97
    v_pk_mul_f32 v[86:87], v[86:87], v[84:85]
    v_pk_mul_f32 v[88:89], v[88:89], v[84:85]
    v_pk_mul_f32 v[90:91], v[90:91], v[84:85]
    v_pk_add_f32 v[92:93], v[92:93], 1.0 op_sel_hi:[1,0]
    v_pk_add_f32 v[94:95], v[94:95], 1.0 op_sel_hi:[1,0]
    v_pk_add_f32 v[96:97], v[96:97], 1.0 op_sel_hi:[1,0]
    v_rcp_f32 v92, v92
    v_rcp_f32 v93, v93
    v_rcp_f32 v94, v94
    v_rcp_f32 v95, v95
    v_rcp_f32 v96, v96
    v_rcp_f32 v97, v97
    v_pk_fma_f32 v[110:111], v[86:87], v[92:93], v[110:111]
    v_pk_fma_f32 v[112:113], v[88:89], v[94:95], v[112:113]
    v_pk_fma_f32 v[114:115], v[90:91], v[96:97], v[114:115]
    v_pk_fma_f32 v[86:87], v[102:103], v[16:17], v[24:25] op_sel_hi:[0,1,1]
    v_pk_fma_f32 v[88:89], v[104:105], v[16:17], v[24:25] op_sel_hi:[0,1,1]
    v_pk_fma_f32 v[90:91], v[106:107], v[16:17], v[24:25] op_sel_hi:[0,1,1]
    v_pk_mul_f32 v[92:93], v[86:87], v[86:87]
    v_pk_mul_f32 v[94:95], v[88:89], v[88:89]
    v_pk_mul_f32 v[96:97], v[90:91], v[90:91]
    v_pk_fma_f32 v[92:93], v[92:93], s[66:67], v[108:109] op_sel_hi:[1,1,0]
    v_pk_fma_f32 v[94:95], v[94:95], s[66:67], v[108:109] op_sel_hi:[1,1,0]
    v_pk_fma_f32 v[96:97], v[96:97], s[66:67], v[108:109] op_sel_hi:[1,1,0]
    v_pk_mul_f32 v[92:93], v[92:93], v[86:87]
    v_pk_mul_f32 v[94:95], v[94:95], v[88:89]
    v_pk_mul_f32 v[96:97], v[96:97], v[90:91]
    v_exp_f32 v92, v92
    v_exp_f32 v93, v93
    v_exp_f32 v94, v94
    v_exp_f32 v95, v95
    v_exp_f32 v96, v96
    v_exp_f32 v97, v97
    v_pk_mul_f32 v[86:87], v[86:87], v[44:45]
    v_pk_mul_f32 v[88:89], v[88:89], v[44:45]
    v_pk_mul_f32 v[90:91], v[90:91], v[44:45]
    v_pk_add_f32 v[92:93], v[92:93], 1.0 op_sel_hi:[1,0]
    v_pk_add_f32 v[94:95], v[94:95], 1.0 op_sel_hi:[1,0]
    v_pk_add_f32 v[96:97], v[96:97], 1.0 op_sel_hi:[1,0]
    v_rcp_f32 v92, v92
    v_rcp_f32 v93, v93
    v_rcp_f32 v94, v94
    v_rcp_f32 v95, v95
    v_rcp_f32 v96, v96
    v_rcp_f32 v97, v97
    v_pk_fma_f32 v[110:111], v[86:87], v[92:93], v[110:111]
    v_pk_fma_f32 v[112:113], v[88:89], v[94:95], v[112:113]
    v_pk_fma_f32 v[114:115], v[90:91], v[96:97], v[114:115]
    v_pk_fma_f32 v[86:87], v[102:103], v[18:19], v[26:27] op_sel_hi:[0,1,1]
    v_pk_fma_f32 v[88:89], v[104:105], v[18:19], v[26:27] op_sel_hi:[0,1,1]
    v_pk_fma_f32 v[90:91], v[106:107], v[18:19], v[26:27] op_sel_hi:[0,1,1]
    v_pk_mul_f32 v[92:93], v[86:87], v[86:87]
    v_pk_mul_f32 v[94:95], v[88:89], v[88:89]
    v_pk_mul_f32 v[96:97], v[90:91], v[90:91]
    v_pk_fma_f32 v[92:93], v[92:93], s[66:67], v[108:109] op_sel_hi:[1,1,0]
    v_pk_fma_f32 v[94:95], v[94:95], s[66:67], v[108:109] op_sel_hi:[1,1,0]
    v_pk_fma_f32 v[96:97], v[96:97], s[66:67], v[108:109] op_sel_hi:[1,1,0]
    v_pk_mul_f32 v[92:93], v[92:93], v[86:87]
    v_pk_mul_f32 v[94:95], v[94:95], v[88:89]
    v_pk_mul_f32 v[96:97], v[96:97], v[90:91]
    v_exp_f32 v92, v92
    v_exp_f32 v93, v93
    v_exp_f32 v94, v94
    v_exp_f32 v95, v95
    v_exp_f32 v96, v96
    v_exp_f32 v97, v97
    v_pk_mul_f32 v[86:87], v[86:87], v[46:47]
    v_pk_mul_f32 v[88:89], v[88:89], v[46:47]
    v_pk_mul_f32 v[90:91], v[90:91], v[46:47]
    v_pk_add_f32 v[92:93], v[92:93], 1.0 op_sel_hi:[1,0]
    v_pk_add_f32 v[94:95], v[94:95], 1.0 op_sel_hi:[1,0]
    v_pk_add_f32 v[96:97], v[96:97], 1.0 op_sel_hi:[1,0]
    v_rcp_f32 v92, v92
    v_rcp_f32 v93, v93
    v_rcp_f32 v94, v94
    v_rcp_f32 v95, v95
    v_rcp_f32 v96, v96
    v_rcp_f32 v97, v97
    v_pk_fma_f32 v[110:111], v[86:87], v[92:93], v[110:111]
    s_add_u32 s93, s58, 0x4008000
    buffer_load_dwordx4 a[160:163], v1, s[4:7], s93 offen offset:0 nt
    buffer_load_dwordx4 a[164:167], v1, s[4:7], s93 offen offset:128 nt
    buffer_load_dwordx4 a[168:171], v1, s[4:7], s93 offen offset:2048 nt
    buffer_load_dwordx4 a[172:175], v1, s[4:7], s93 offen offset:2176 nt
    buffer_load_dwordx4 a[176:179], v2, s[8:11], s93 offen offset:0 nt
    buffer_load_dwordx4 a[180:183], v2, s[8:11], s93 offen offset:256 nt
    buffer_load_dwordx4 a[184:187], v2, s[8:11], s93 offen offset:2048 nt
    buffer_load_dwordx4 a[188:191], v2, s[8:11], s93 offen offset:2304 nt
    v_pk_fma_f32 v[112:113], v[88:89], v[94:95], v[112:113]
    v_pk_fma_f32 v[114:115], v[90:91], v[96:97], v[114:115]
    v_lshlrev_b32 v84, 16, v136
    v_lshlrev_b32 v85, 16, v137
    v_pk_fma_f32 v[86:87], v[102:103], v[20:21], v[28:29] op_sel_hi:[0,1,1]
    v_pk_fma_f32 v[88:89], v[104:105], v[20:21], v[28:29] op_sel_hi:[0,1,1]
    v_pk_fma_f32 v[90:91], v[106:107], v[20:21], v[28:29] op_sel_hi:[0,1,1]
    v_pk_mul_f32 v[92:93], v[86:87], v[86:87]
    v_pk_mul_f32 v[94:95], v[88:89], v[88:89]
    v_pk_mul_f32 v[96:97], v[90:91], v[90:91]
    v_pk_fma_f32 v[92:93], v[92:93], s[66:67], v[108:109] op_sel_hi:[1,1,0]
    v_pk_fma_f32 v[94:95], v[94:95], s[66:67], v[108:109] op_sel_hi:[1,1,0]
    v_pk_fma_f32 v[96:97], v[96:97], s[66:67], v[108:109] op_sel_hi:[1,1,0]
    v_pk_mul_f32 v[92:93], v[92:93], v[86:87]
    v_pk_mul_f32 v[94:95], v[94:95], v[88:89]
    v_pk_mul_f32 v[96:97], v[96:97], v[90:91]
    v_exp_f32 v92, v92
    v_exp_f32 v93, v93
    v_exp_f32 v94, v94
    v_exp_f32 v95, v95
    v_exp_f32 v96, v96
    v_exp_f32 v97, v97
    v_pk_mul_f32 v[86:87], v[86:87], v[84:85]
    v_pk_mul_f32 v[88:89], v[88:89], v[84:85]
    v_pk_mul_f32 v[90:91], v[90:91], v[84:85]
    v_pk_add_f32 v[92:93], v[92:93], 1.0 op_sel_hi:[1,0]
    v_pk_add_f32 v[94:95], v[94:95], 1.0 op_sel_hi:[1,0]
    v_pk_add_f32 v[96:97], v[96:97], 1.0 op_sel_hi:[1,0]
    v_rcp_f32 v92, v92
    v_rcp_f32 v93, v93
    v_rcp_f32 v94, v94
    v_rcp_f32 v95, v95
    v_rcp_f32 v96, v96
    v_rcp_f32 v97, v97
    v_pk_fma_f32 v[110:111], v[86:87], v[92:93], v[110:111]
    v_pk_fma_f32 v[112:113], v[88:89], v[94:95], v[112:113]
    v_pk_fma_f32 v[114:115], v[90:91], v[96:97], v[114:115]
    v_lshlrev_b32 v84, 16, v138
    v_lshlrev_b32 v85, 16, v139
    v_pk_fma_f32 v[86:87], v[102:103], v[22:23], v[30:31] op_sel_hi:[0,1,1]
    v_pk_fma_f32 v[88:89], v[104:105], v[22:23], v[30:31] op_sel_hi:[0,1,1]
    v_pk_fma_f32 v[90:91], v[106:107], v[22:23], v[30:31] op_sel_hi:[0,1,1]
    v_pk_mul_f32 v[92:93], v[86:87], v[86:87]
    v_pk_mul_f32 v[94:95], v[88:89], v[88:89]
    v_pk_mul_f32 v[96:97], v[90:91], v[90:91]
    v_pk_fma_f32 v[92:93], v[92:93], s[66:67], v[108:109] op_sel_hi:[1,1,0]
    v_pk_fma_f32 v[94:95], v[94:95], s[66:67], v[108:109] op_sel_hi:[1,1,0]
    v_pk_fma_f32 v[96:97], v[96:97], s[66:67], v[108:109] op_sel_hi:[1,1,0]
    v_pk_mul_f32 v[92:93], v[92:93], v[86:87]
    v_pk_mul_f32 v[94:95], v[94:95], v[88:89]
    v_pk_mul_f32 v[96:97], v[96:97], v[90:91]
    v_exp_f32 v92, v92
    v_exp_f32 v93, v93
    v_exp_f32 v94, v94
    v_exp_f32 v95, v95
    v_exp_f32 v96, v96
    v_exp_f32 v97, v97
    v_pk_mul_f32 v[86:87], v[86:87], v[84:85]
    v_pk_mul_f32 v[88:89], v[88:89], v[84:85]
    v_pk_mul_f32 v[90:91], v[90:91], v[84:85]
    v_pk_add_f32 v[92:93], v[92:93], 1.0 op_sel_hi:[1,0]
    v_pk_add_f32 v[94:95], v[94:95], 1.0 op_sel_hi:[1,0]
    v_pk_add_f32 v[96:97], v[96:97], 1.0 op_sel_hi:[1,0]
    v_rcp_f32 v92, v92
    v_rcp_f32 v93, v93
    v_rcp_f32 v94, v94
    v_rcp_f32 v95, v95
    v_rcp_f32 v96, v96
    v_rcp_f32 v97, v97
    v_pk_fma_f32 v[110:111], v[86:87], v[92:93], v[110:111]
    v_pk_fma_f32 v[112:113], v[88:89], v[94:95], v[112:113]
    v_pk_fma_f32 v[114:115], v[90:91], v[96:97], v[114:115]
    v_lshlrev_b32 v80, 16, v140
    v_and_b32 v81, 0xffff0000, v140
    v_lshlrev_b32 v82, 16, v141
    v_and_b32 v83, 0xffff0000, v141
    v_lshlrev_b32 v84, 16, v142
    v_and_b32 v85, 0xffff0000, v142
    v_pk_fma_f32 v[86:87], v[102:103], v[80:81], v[82:83] op_sel_hi:[0,1,1]
    v_pk_fma_f32 v[88:89], v[104:105], v[80:81], v[82:83] op_sel_hi:[0,1,1]
    v_pk_fma_f32 v[90:91], v[106:107], v[80:81], v[82:83] op_sel_hi:[0,1,1]
    v_pk_mul_f32 v[92:93], v[86:87], v[86:87]
    v_pk_mul_f32 v[94:95], v[88:89], v[88:89]
    v_pk_mul_f32 v[96:97], v[90:91], v[90:91]
    v_pk_fma_f32 v[92:93], v[92:93], s[66:67], v[108:109] op_sel_hi:[1,1,0]
    v_pk_fma_f32 v[94:95], v[94:95], s[66:67], v[108:109] op_sel_hi:[1,1,0]
    v_pk_fma_f32 v[96:97], v[96:97], s[66:67], v[108:109] op_sel_hi:[1,1,0]
    v_pk_mul_f32 v[92:93], v[92:93], v[86:87]
    v_pk_mul_f32 v[94:95], v[94:95], v[88:89]
    v_pk_mul_f32 v[96:97], v[96:97], v[90:91]
    v_exp_f32 v92, v92
    v_exp_f32 v93, v93
    v_exp_f32 v94, v94
    v_exp_f32 v95, v95
    v_exp_f32 v96, v96
    v_exp_f32 v97, v97
    v_pk_mul_f32 v[86:87], v[86:87], v[84:85]
    v_pk_mul_f32 v[88:89], v[88:89], v[84:85]
    v_pk_mul_f32 v[90:91], v[90:91], v[84:85]
    v_pk_add_f32 v[92:93], v[92:93], 1.0 op_sel_hi:[1,0]
    v_pk_add_f32 v[94:95], v[94:95], 1.0 op_sel_hi:[1,0]
    v_pk_add_f32 v[96:97], v[96:97], 1.0 op_sel_hi:[1,0]
    v_rcp_f32 v92, v92
    v_rcp_f32 v93, v93
    v_rcp_f32 v94, v94
    v_rcp_f32 v95, v95
    v_rcp_f32 v96, v96
    v_rcp_f32 v97, v97
    v_pk_fma_f32 v[110:111], v[86:87], v[92:93], v[110:111]
    v_pk_fma_f32 v[112:113], v[88:89], v[94:95], v[112:113]
    v_pk_fma_f32 v[114:115], v[90:91], v[96:97], v[114:115]
    v_add_f32 v110, v110, v111
    v_add_f32 v112, v112, v113
    v_add_f32 v114, v114, v115
    v_add_f32_dpp v110, v110, v110 row_ror:8 row_mask:0xf bank_mask:0xf
    v_add_f32_dpp v112, v112, v112 row_ror:8 row_mask:0xf bank_mask:0xf
    v_add_f32_dpp v114, v114, v114 row_ror:8 row_mask:0xf bank_mask:0xf
    v_add_f32_dpp v110, v110, v110 row_ror:4 row_mask:0xf bank_mask:0xf
    v_add_f32_dpp v112, v112, v112 row_ror:4 row_mask:0xf bank_mask:0xf
    v_add_f32_dpp v114, v114, v114 row_ror:4 row_mask:0xf bank_mask:0xf
    v_add_f32_dpp v110, v110, v110 row_ror:2 row_mask:0xf bank_mask:0xf
    v_add_f32_dpp v112, v112, v112 row_ror:2 row_mask:0xf bank_mask:0xf
    v_add_f32_dpp v114, v114, v114 row_ror:2 row_mask:0xf bank_mask:0xf
    v_add_f32_dpp v110, v110, v110 row_ror:1 row_mask:0xf bank_mask:0xf
    v_add_f32_dpp v112, v112, v112 row_ror:1 row_mask:0xf bank_mask:0xf
    v_add_f32_dpp v114, v114, v114 row_ror:1 row_mask:0xf bank_mask:0xf
    s_lshl_b32 s29, s24, 4
    v_lshrrev_b32 v12, 4, v0
    v_lshl_add_u32 v12, v12, 2, s29
    ds_write_b32 v12, v110 offset:14848
    ds_write_b32 v12, v112 offset:14912
    ds_write_b32 v12, v114 offset:14976
    v_and_b32 v13, 3, v0
    v_lshlrev_b32 v13, 6, v13
    s_waitcnt lgkmcnt(0)
    s_barrier
    s_cmp_lg_u32 s24, 0
    s_cbranch_scc1 XD_103
    s_cmp_eq_u32 s62, 0
    s_cbranch_scc1 XD_103
    ds_read_b128 v[80:83], v13 offset:14848
    ds_read_b128 v[84:87], v13 offset:14864
    ds_read_b128 v[88:91], v13 offset:14880
    ds_read_b128 v[92:95], v13 offset:14896
    s_mul_i32 s29, s82, 2304
    s_add_u32 s59, s29, 0x68000
    v_add_u32 v15, s29, v14
    v_lshrrev_b32 v15, 1, v15
    s_waitcnt lgkmcnt(0)
    v_pk_add_f32 v[80:81], v[80:81], v[88:89]
    v_pk_add_f32 v[82:83], v[82:83], v[90:91]
    v_pk_add_f32 v[84:85], v[84:85], v[92:93]
    v_pk_add_f32 v[86:87], v[86:87], v[94:95]
    v_pk_add_f32 v[80:81], v[80:81], v[84:85]
    v_pk_add_f32 v[82:83], v[82:83], v[86:87]
    v_pk_add_f32 v[80:81], v[80:81], v[82:83]
    v_add_f32 v80, v80, v81
    v_cvt_pk_bf16_f32 v12, v80, v80
    v_lshlrev_b32 v80, 16, v12
    v_add_f32 v80, s68, v80
    v_cvt_pk_bf16_f32 v12, v80, v80
    v_lshlrev_b32 v80, 16, v12
    v_add_f32 v80, v80, v143
    v_cvt_pk_bf16_f32 v80, v80, v80
    s_mov_b64 exec, 7
    s_cmp_ge_u32 s81, 2
    s_cbranch_scc1 XF_104
    v_and_b32 v80, 0xffff0000, v80
    buffer_store_dword v80, v14, s[12:15], s59 offen sc1
    s_branch XR_105
XF_104:
    global_store_short v15, v80, s[52:53]
XR_105:
    s_mov_b64 exec, -1
XD_103:
    s_add_u32 s61, s61, 1
    v_add_u32 v58, s83, v8
    v_add_u32 v59, s83, v3
    ds_read_b128 v[48:51], v58
    ds_read_b128 v[52:55], v58 offset:1024
    ds_read_b32 v56, v59 offset:2048
    s_mul_i32 s73, s61, 12
    v_and_b32 v14, 12, v3
    v_add_u32 v14, s73, v14
    v_add_u32 v15, s83, v14
    ds_read_b32 v58, v15
    s_waitcnt lgkmcnt(0)
    s_barrier
    ds_read_b32 v143, v14 offset:0
    ds_read_b32 v12, v14 offset:2304
    ds_read_b32 v13, v14 offset:4608
    ds_read_b32 v15, v14 offset:6912
    ds_read_b128 v[80:83], v8 offset:0
    ds_read_b128 v[84:87], v8 offset:1024
    ds_read_b32 v112, v3 offset:2048
    ds_read_b128 v[88:91], v8 offset:2304
    ds_read_b128 v[92:95], v8 offset:3328
    ds_read_b32 v113, v3 offset:4352
    ds_read_b128 v[96:99], v8 offset:4608
    ds_read_b128 v[100:103], v8 offset:5632
    ds_read_b32 v114, v3 offset:6656
    ds_read_b128 v[104:107], v8 offset:6912
    ds_read_b128 v[108:111], v8 offset:7936
    ds_read_b32 v115, v3 offset:8960
    s_waitcnt lgkmcnt(12)
    s_add_u32 s91, s58, 0x400c000
    buffer_load_dwordx4 a[128:131], v1, s[4:7], s91 offen offset:0 nt
    buffer_load_dwordx4 a[132:135], v1, s[4:7], s91 offen offset:128 nt
    buffer_load_dwordx4 a[136:139], v1, s[4:7], s91 offen offset:2048 nt
    buffer_load_dwordx4 a[140:143], v1, s[4:7], s91 offen offset:2176 nt
    buffer_load_dwordx4 a[144:147], v2, s[8:11], s91 offen offset:0 nt
    buffer_load_dwordx4 a[148:151], v2, s[8:11], s91 offen offset:256 nt
    buffer_load_dwordx4 a[152:155], v2, s[8:11], s91 offen offset:2048 nt
    buffer_load_dwordx4 a[156:159], v2, s[8:11], s91 offen offset:2304 nt
    v_add_f32 v143, v143, v12
    v_add_f32 v13, v13, v15
    v_add_f32 v143, v143, v13
    v_cvt_pk_bf16_f32 v12, v143, v143
    v_lshlrev_b32 v143, 16, v12
    v_add_f32 v143, v143, v58
    v_cvt_pk_bf16_f32 v12, v143, v143
    v_lshlrev_b32 v143, 16, v12
    s_waitcnt lgkmcnt(6)
    v_pk_add_f32 v[48:49], v[48:49], v[80:81]
    v_pk_add_f32 v[50:51], v[50:51], v[82:83]
    v_pk_add_f32 v[52:53], v[52:53], v[84:85]
    v_pk_add_f32 v[54:55], v[54:55], v[86:87]
    v_pk_add_f32 v[48:49], v[48:49], v[88:89]
    v_pk_add_f32 v[50:51], v[50:51], v[90:91]
    v_pk_add_f32 v[52:53], v[52:53], v[92:93]
    v_pk_add_f32 v[54:55], v[54:55], v[94:95]
    s_waitcnt lgkmcnt(0)
    v_pk_add_f32 v[96:97], v[96:97], v[104:105]
    v_pk_add_f32 v[98:99], v[98:99], v[106:107]
    v_pk_add_f32 v[100:101], v[100:101], v[108:109]
    v_pk_add_f32 v[102:103], v[102:103], v[110:111]
    v_pk_add_f32 v[112:113], v[112:113], v[114:115]
    v_pk_add_f32 v[48:49], v[48:49], v[96:97]
    v_pk_add_f32 v[50:51], v[50:51], v[98:99]
    v_pk_add_f32 v[52:53], v[52:53], v[100:101]
    v_pk_add_f32 v[54:55], v[54:55], v[102:103]
    v_add_f32 v56, v56, v112
    v_add_f32 v56, v56, v113
    v_pk_add_f32 v[100:101], v[48:49], v[50:51]
    v_pk_add_f32 v[80:81], v[52:53], v[54:55]
    v_pk_add_f32 v[100:101], v[100:101], v[80:81]
    v_add_f32 v100, v100, v56
    v_add_f32 v100, v100, v101
    s_nop 1
    v_add_f32_dpp v100, v100, v100 row_ror:8 row_mask:0xf bank_mask:0xf
    s_nop 1
    v_add_f32_dpp v100, v100, v100 row_ror:4 row_mask:0xf bank_mask:0xf
    s_nop 1
    v_add_f32_dpp v100, v100, v100 row_ror:2 row_mask:0xf bank_mask:0xf
    s_nop 1
    v_add_f32_dpp v100, v100, v100 row_ror:1 row_mask:0xf bank_mask:0xf
    v_mov_b32 v12, v100
    s_nop 1
    v_permlane16_swap_b32 v100, v12
    v_add_f32 v100, v100, v12
    v_mov_b32 v12, v100
    s_nop 1
    v_permlane32_swap_b32 v100, v12
    v_add_f32 v100, v100, v12
    v_mul_f32 v100, 0x3ae38e39, v100
    v_pk_add_f32 v[80:81], v[48:49], v[100:101] op_sel_hi:[1,0] neg_lo:[0,1] neg_hi:[0,1]
    v_pk_add_f32 v[82:83], v[50:51], v[100:101] op_sel_hi:[1,0] neg_lo:[0,1] neg_hi:[0,1]
    v_pk_add_f32 v[84:85], v[52:53], v[100:101] op_sel_hi:[1,0] neg_lo:[0,1] neg_hi:[0,1]
    v_pk_add_f32 v[86:87], v[54:55], v[100:101] op_sel_hi:[1,0] neg_lo:[0,1] neg_hi:[0,1]
    v_sub_f32 v88, v56, v100
    v_pk_mul_f32 v[80:81], v[80:81], v[80:81]
    v_mul_f32 v101, v88, v88
    v_pk_fma_f32 v[80:81], v[82:83], v[82:83], v[80:81]
    v_pk_fma_f32 v[80:81], v[84:85], v[84:85], v[80:81]
    v_pk_fma_f32 v[80:81], v[86:87], v[86:87], v[80:81]
    v_add_f32 v101, v101, v80
    v_add_f32 v101, v101, v81
    s_nop 1
    v_add_f32_dpp v101, v101, v101 row_ror:8 row_mask:0xf bank_mask:0xf
    s_nop 1
    v_add_f32_dpp v101, v101, v101 row_ror:4 row_mask:0xf bank_mask:0xf
    s_nop 1
    v_add_f32_dpp v101, v101, v101 row_ror:2 row_mask:0xf bank_mask:0xf
    s_nop 1
    v_add_f32_dpp v101, v101, v101 row_ror:1 row_mask:0xf bank_mask:0xf
    v_mov_b32 v12, v101
    s_nop 1
    v_permlane16_swap_b32 v101, v12
    v_add_f32 v101, v101, v12
    v_mov_b32 v12, v101
    s_nop 1
    v_permlane32_swap_b32 v101, v12
    v_add_f32 v101, v101, v12
    v_mul_f32 v101, 0x3ae38e39, v101
    v_cvt_pk_bf16_f32 v12, v100, v101
    v_lshlrev_b32 v80, 16, v12
    v_and_b32 v81, 0xffff0000, v12
    v_add_f32 v81, s90, v81
    v_sub_f32 v13, v143, v80
    v_cvt_pk_bf16_f32 v12, v81, v13
    v_lshlrev_b32 v81, 16, v12
    v_and_b32 v13, 0xffff0000, v12
    v_sqrt_f32 v81, v81
    v_sub_f32 v82, v100, v80
    v_cvt_pk_bf16_f32 v12, v81, v81
    v_lshlrev_b32 v81, 16, v12
    v_rcp_f32 v81, v81
    s_nop 0
    v_mul_f32 v101, v101, v81
    v_mul_f32 v82, v82, v81
    v_mul_f32 v101, v101, v81
    v_mul_f32 v13, v13, v81
    v_cvt_pk_bf16_f32 v12, v82, v101
    v_lshlrev_b32 v82, 16, v12
    v_and_b32 v101, 0xffff0000, v12
    v_add_f32 v101, s90, v101
    v_cvt_pk_bf16_f32 v12, v13, v101
    v_lshlrev_b32 v13, 16, v12
    v_and_b32 v101, 0xffff0000, v12
    v_sqrt_f32 v101, v101
    v_sub_f32 v13, v13, v82
    v_cvt_pk_bf16_f32 v12, v13, v101
    v_lshlrev_b32 v13, 16, v12
    v_and_b32 v101, 0xffff0000, v12
    v_rcp_f32 v101, v101
    s_nop 0
    v_mul_f32 v13, v13, v101
    v_cvt_pk_bf16_f32 v12, v13, v13
    v_lshlrev_b32 v13, 16, v12
    v_mov_b32 v108, 0xc0135761
    s_nop 0
    v_mov_b32_dpp v102, v13 quad_perm:[0,0,0,0] row_mask:0xf bank_mask:0xf
    v_mov_b32_dpp v104, v13 quad_perm:[1,1,1,1] row_mask:0xf bank_mask:0xf
    v_mov_b32_dpp v106, v13 quad_perm:[2,2,2,2] row_mask:0xf bank_mask:0xf
    v_pk_fma_f32 v[86:87], v[102:103], v[116:117], v[124:125] op_sel_hi:[0,1,1]
    v_pk_fma_f32 v[88:89], v[104:105], v[116:117], v[124:125] op_sel_hi:[0,1,1]
    v_pk_fma_f32 v[90:91], v[106:107], v[116:117], v[124:125] op_sel_hi:[0,1,1]
    v_pk_mul_f32 v[92:93], v[86:87], v[86:87]
    v_pk_mul_f32 v[94:95], v[88:89], v[88:89]
    v_pk_mul_f32 v[96:97], v[90:91], v[90:91]
    v_pk_fma_f32 v[92:93], v[92:93], s[66:67], v[108:109] op_sel_hi:[1,1,0]
    v_pk_fma_f32 v[94:95], v[94:95], s[66:67], v[108:109] op_sel_hi:[1,1,0]
    v_pk_fma_f32 v[96:97], v[96:97], s[66:67], v[108:109] op_sel_hi:[1,1,0]
    v_pk_mul_f32 v[92:93], v[92:93], v[86:87]
    v_pk_mul_f32 v[94:95], v[94:95], v[88:89]
    v_pk_mul_f32 v[96:97], v[96:97], v[90:91]
    v_exp_f32 v92, v92
    v_exp_f32 v93, v93
    v_exp_f32 v94, v94
    v_exp_f32 v95, v95
    v_exp_f32 v96, v96
    v_exp_f32 v97, v97
    v_pk_mul_f32 v[86:87], v[86:87], v[132:133]
    v_pk_mul_f32 v[88:89], v[88:89], v[132:133]
    v_pk_mul_f32 v[90:91], v[90:91], v[132:133]
    v_pk_add_f32 v[92:93], v[92:93], 1.0 op_sel_hi:[1,0]
    v_pk_add_f32 v[94:95], v[94:95], 1.0 op_sel_hi:[1,0]
    v_pk_add_f32 v[96:97], v[96:97], 1.0 op_sel_hi:[1,0]
    v_rcp_f32 v92, v92
    v_rcp_f32 v93, v93
    v_rcp_f32 v94, v94
    v_rcp_f32 v95, v95
    v_rcp_f32 v96, v96
    v_rcp_f32 v97, v97
    v_pk_mul_f32 v[110:111], v[86:87], v[92:93]
    v_pk_mul_f32 v[112:113], v[88:89], v[94:95]
    v_pk_mul_f32 v[114:115], v[90:91], v[96:97]
    v_pk_fma_f32 v[86:87], v[102:103], v[118:119], v[126:127] op_sel_hi:[0,1,1]
    v_pk_fma_f32 v[88:89], v[104:105], v[118:119], v[126:127] op_sel_hi:[0,1,1]
    v_pk_fma_f32 v[90:91], v[106:107], v[118:119], v[126:127] op_sel_hi:[0,1,1]
    v_pk_mul_f32 v[92:93], v[86:87], v[86:87]
    v_pk_mul_f32 v[94:95], v[88:89], v[88:89]
    v_pk_mul_f32 v[96:97], v[90:91], v[90:91]
    v_pk_fma_f32 v[92:93], v[92:93], s[66:67], v[108:109] op_sel_hi:[1,1,0]
    v_pk_fma_f32 v[94:95], v[94:95], s[66:67], v[108:109] op_sel_hi:[1,1,0]
    v_pk_fma_f32 v[96:97], v[96:97], s[66:67], v[108:109] op_sel_hi:[1,1,0]
    v_pk_mul_f32 v[92:93], v[92:93], v[86:87]
    v_pk_mul_f32 v[94:95], v[94:95], v[88:89]
    v_pk_mul_f32 v[96:97], v[96:97], v[90:91]
    v_exp_f32 v92, v92
    v_exp_f32 v93, v93
    v_exp_f32 v94, v94
    v_exp_f32 v95, v95
    v_exp_f32 v96, v96
    v_exp_f32 v97, v97
    v_pk_mul_f32 v[86:87], v[86:87], v[134:135]
    v_pk_mul_f32 v[88:89], v[88:89], v[134:135]
    v_pk_mul_f32 v[90:91], v[90:91], v[134:135]
    v_pk_add_f32 v[92:93], v[92:93], 1.0 op_sel_hi:[1,0]
    v_pk_add_f32 v[94:95], v[94:95], 1.0 op_sel_hi:[1,0]
    v_pk_add_f32 v[96:97], v[96:97], 1.0 op_sel_hi:[1,0]
    v_rcp_f32 v92, v92
    s_add_u32 s92, s58, 0x4010000
    buffer_load_dwordx4 a[96:99], v1, s[4:7], s92 offen offset:0 nt
    buffer_load_dwordx4 a[100:103], v1, s[4:7], s92 offen offset:128 nt
    buffer_load_dwordx4 a[104:107], v1, s[4:7], s92 offen offset:2048 nt
    buffer_load_dwordx4 a[108:111], v1, s[4:7], s92 offen offset:2176 nt
    buffer_load_dwordx4 a[112:115], v2, s[8:11], s92 offen offset:0 nt
    buffer_load_dwordx4 a[116:119], v2, s[8:11], s92 offen offset:256 nt
    buffer_load_dwordx4 a[120:123], v2, s[8:11], s92 offen offset:2048 nt
    buffer_load_dwordx4 a[124:127], v2, s[8:11], s92 offen offset:2304 nt
    v_rcp_f32 v93, v93
    v_rcp_f32 v94, v94
    v_rcp_f32 v95, v95
    v_rcp_f32 v96, v96
    v_rcp_f32 v97, v97
    v_pk_fma_f32 v[110:111], v[86:87], v[92:93], v[110:111]
    v_pk_fma_f32 v[112:113], v[88:89], v[94:95], v[112:113]
    v_pk_fma_f32 v[114:115], v[90:91], v[96:97], v[114:115]
    v_and_b32 v84, 0xffff0000, v136
    v_and_b32 v85, 0xffff0000, v137
    v_pk_fma_f32 v[86:87], v[102:103], v[120:121], v[128:129] op_sel_hi:[0,1,1]
    v_pk_fma_f32 v[88:89], v[104:105], v[120:121], v[128:129] op_sel_hi:[0,1,1]
    v_pk_fma_f32 v[90:91], v[106:107], v[120:121], v[128:129] op_sel_hi:[0,1,1]
    v_pk_mul_f32 v[92:93], v[86:87], v[86:87]
    v_pk_mul_f32 v[94:95], v[88:89], v[88:89]
    v_pk_mul_f32 v[96:97], v[90:91], v[90:91]
    v_pk_fma_f32 v[92:93], v[92:93], s[66:67], v[108:109] op_sel_hi:[1,1,0]
    v_pk_fma_f32 v[94:95], v[94:95], s[66:67], v[108:109] op_sel_hi:[1,1,0]
    v_pk_fma_f32 v[96:97], v[96:97], s[66:67], v[108:109] op_sel_hi:[1,1,0]
    v_pk_mul_f32 v[92:93], v[92:93], v[86:87]
    v_pk_mul_f32 v[94:95], v[94:95], v[88:89]
    v_pk_mul_f32 v[96:97], v[96:97], v[90:91]
    v_exp_f32 v92, v92
    v_exp_f32 v93, v93
    v_exp_f32 v94, v94
    v_exp_f32 v95, v95
    v_exp_f32 v96, v96
    v_exp_f32 v97, v97
    v_pk_mul_f32 v[86:87], v[86:87], v[84:85]
    v_pk_mul_f32 v[88:89], v[88:89], v[84:85]
    v_pk_mul_f32 v[90:91], v[90:91], v[84:85]
    v_pk_add_f32 v[92:93], v[92:93], 1.0 op_sel_hi:[1,0]
    v_pk_add_f32 v[94:95], v[94:95], 1.0 op_sel_hi:[1,0]
    v_pk_add_f32 v[96:97], v[96:97], 1.0 op_sel_hi:[1,0]
    v_rcp_f32 v92, v92
    v_rcp_f32 v93, v93
    v_rcp_f32 v94, v94
    v_rcp_f32 v95, v95
    v_rcp_f32 v96, v96
    v_rcp_f32 v97, v97
    v_pk_fma_f32 v[110:111], v[86:87], v[92:93], v[110:111]
    v_pk_fma_f32 v[112:113], v[88:89], v[94:95], v[112:113]
    v_pk_fma_f32 v[114:115], v[90:91], v[96:97], v[114:115]
    v_and_b32 v84, 0xffff0000, v138
    v_and_b32 v85, 0xffff0000, v139
    v_pk_fma_f32 v[86:87], v[102:103], v[122:123], v[130:131] op_sel_hi:[0,1,1]
    v_pk_fma_f32 v[88:89], v[104:105], v[122:123], v[130:131] op_sel_hi:[0,1,1]
    v_pk_fma_f32 v[90:91], v[106:107], v[122:123], v[130:131] op_sel_hi:[0,1,1]
    v_pk_mul_f32 v[92:93], v[86:87], v[86:87]
    v_pk_mul_f32 v[94:95], v[88:89], v[88:89]
    v_pk_mul_f32 v[96:97], v[90:91], v[90:91]
    v_pk_fma_f32 v[92:93], v[92:93], s[66:67], v[108:109] op_sel_hi:[1,1,0]
    v_pk_fma_f32 v[94:95], v[94:95], s[66:67], v[108:109] op_sel_hi:[1,1,0]
    v_pk_fma_f32 v[96:97], v[96:97], s[66:67], v[108:109] op_sel_hi:[1,1,0]
    v_pk_mul_f32 v[92:93], v[92:93], v[86:87]
    v_pk_mul_f32 v[94:95], v[94:95], v[88:89]
    v_pk_mul_f32 v[96:97], v[96:97], v[90:91]
    v_exp_f32 v92, v92
    v_exp_f32 v93, v93
    v_exp_f32 v94, v94
    v_exp_f32 v95, v95
    v_exp_f32 v96, v96
    v_exp_f32 v97, v97
    v_pk_mul_f32 v[86:87], v[86:87], v[84:85]
    v_pk_mul_f32 v[88:89], v[88:89], v[84:85]
    v_pk_mul_f32 v[90:91], v[90:91], v[84:85]
    v_pk_add_f32 v[92:93], v[92:93], 1.0 op_sel_hi:[1,0]
    v_pk_add_f32 v[94:95], v[94:95], 1.0 op_sel_hi:[1,0]
    v_pk_add_f32 v[96:97], v[96:97], 1.0 op_sel_hi:[1,0]
    v_rcp_f32 v92, v92
    v_rcp_f32 v93, v93
    v_rcp_f32 v94, v94
    v_rcp_f32 v95, v95
    v_rcp_f32 v96, v96
    v_rcp_f32 v97, v97
    v_pk_fma_f32 v[110:111], v[86:87], v[92:93], v[110:111]
    v_pk_fma_f32 v[112:113], v[88:89], v[94:95], v[112:113]
    v_pk_fma_f32 v[114:115], v[90:91], v[96:97], v[114:115]
    v_pk_fma_f32 v[86:87], v[102:103], v[16:17], v[24:25] op_sel_hi:[0,1,1]
    v_pk_fma_f32 v[88:89], v[104:105], v[16:17], v[24:25] op_sel_hi:[0,1,1]
    v_pk_fma_f32 v[90:91], v[106:107], v[16:17], v[24:25] op_sel_hi:[0,1,1]
    v_pk_mul_f32 v[92:93], v[86:87], v[86:87]
    v_pk_mul_f32 v[94:95], v[88:89], v[88:89]
    v_pk_mul_f32 v[96:97], v[90:91], v[90:91]
    v_pk_fma_f32 v[92:93], v[92:93], s[66:67], v[108:109] op_sel_hi:[1,1,0]
    v_pk_fma_f32 v[94:95], v[94:95], s[66:67], v[108:109] op_sel_hi:[1,1,0]
    v_pk_fma_f32 v[96:97], v[96:97], s[66:67], v[108:109] op_sel_hi:[1,1,0]
    v_pk_mul_f32 v[92:93], v[92:93], v[86:87]
    v_pk_mul_f32 v[94:95], v[94:95], v[88:89]
    v_pk_mul_f32 v[96:97], v[96:97], v[90:91]
    v_exp_f32 v92, v92
    v_exp_f32 v93, v93
    v_exp_f32 v94, v94
    v_exp_f32 v95, v95
    v_exp_f32 v96, v96
    v_exp_f32 v97, v97
    v_pk_mul_f32 v[86:87], v[86:87], v[44:45]
    v_pk_mul_f32 v[88:89], v[88:89], v[44:45]
    v_pk_mul_f32 v[90:91], v[90:91], v[44:45]
    v_pk_add_f32 v[92:93], v[92:93], 1.0 op_sel_hi:[1,0]
    v_pk_add_f32 v[94:95], v[94:95], 1.0 op_sel_hi:[1,0]
    v_pk_add_f32 v[96:97], v[96:97], 1.0 op_sel_hi:[1,0]
    v_rcp_f32 v92, v92
    v_rcp_f32 v93, v93
    v_rcp_f32 v94, v94
    v_rcp_f32 v95, v95
    v_rcp_f32 v96, v96
    v_rcp_f32 v97, v97
    v_pk_fma_f32 v[110:111], v[86:87], v[92:93], v[110:111]
    v_pk_fma_f32 v[112:113], v[88:89], v[94:95], v[112:113]
    v_pk_fma_f32 v[114:115], v[90:91], v[96:97], v[114:115]
    v_pk_fma_f32 v[86:87], v[102:103], v[18:19], v[26:27] op_sel_hi:[0,1,1]
    v_pk_fma_f32 v[88:89], v[104:105], v[18:19], v[26:27] op_sel_hi:[0,1,1]
    v_pk_fma_f32 v[90:91], v[106:107], v[18:19], v[26:27] op_sel_hi:[0,1,1]
    v_pk_mul_f32 v[92:93], v[86:87], v[86:87]
    v_pk_mul_f32 v[94:95], v[88:89], v[88:89]
    v_pk_mul_f32 v[96:97], v[90:91], v[90:91]
    v_pk_fma_f32 v[92:93], v[92:93], s[66:67], v[108:109] op_sel_hi:[1,1,0]
    v_pk_fma_f32 v[94:95], v[94:95], s[66:67], v[108:109] op_sel_hi:[1,1,0]
    v_pk_fma_f32 v[96:97], v[96:97], s[66:67], v[108:109] op_sel_hi:[1,1,0]
    v_pk_mul_f32 v[92:93], v[92:93], v[86:87]
    v_pk_mul_f32 v[94:95], v[94:95], v[88:89]
    v_pk_mul_f32 v[96:97], v[96:97], v[90:91]
    v_exp_f32 v92, v92
    v_exp_f32 v93, v93
    v_exp_f32 v94, v94
    v_exp_f32 v95, v95
    v_exp_f32 v96, v96
    v_exp_f32 v97, v97
    v_pk_mul_f32 v[86:87], v[86:87], v[46:47]
    v_pk_mul_f32 v[88:89], v[88:89], v[46:47]
    v_pk_mul_f32 v[90:91], v[90:91], v[46:47]
    v_pk_add_f32 v[92:93], v[92:93], 1.0 op_sel_hi:[1,0]
    v_pk_add_f32 v[94:95], v[94:95], 1.0 op_sel_hi:[1,0]
    v_pk_add_f32 v[96:97], v[96:97], 1.0 op_sel_hi:[1,0]
    v_rcp_f32 v92, v92
    v_rcp_f32 v93, v93
    v_rcp_f32 v94, v94
    v_rcp_f32 v95, v95
    v_rcp_f32 v96, v96
    v_rcp_f32 v97, v97
    v_pk_fma_f32 v[110:111], v[86:87], v[92:93], v[110:111]
    v_pk_fma_f32 v[112:113], v[88:89], v[94:95], v[112:113]
    v_pk_fma_f32 v[114:115], v[90:91], v[96:97], v[114:115]
    v_lshlrev_b32 v84, 16, v136
    v_lshlrev_b32 v85, 16, v137
    v_pk_fma_f32 v[86:87], v[102:103], v[20:21], v[28:29] op_sel_hi:[0,1,1]
    v_pk_fma_f32 v[88:89], v[104:105], v[20:21], v[28:29] op_sel_hi:[0,1,1]
    v_pk_fma_f32 v[90:91], v[106:107], v[20:21], v[28:29] op_sel_hi:[0,1,1]
    v_pk_mul_f32 v[92:93], v[86:87], v[86:87]
    v_pk_mul_f32 v[94:95], v[88:89], v[88:89]
    v_pk_mul_f32 v[96:97], v[90:91], v[90:91]
    v_pk_fma_f32 v[92:93], v[92:93], s[66:67], v[108:109] op_sel_hi:[1,1,0]
    v_pk_fma_f32 v[94:95], v[94:95], s[66:67], v[108:109] op_sel_hi:[1,1,0]
    v_pk_fma_f32 v[96:97], v[96:97], s[66:67], v[108:109] op_sel_hi:[1,1,0]
    v_pk_mul_f32 v[92:93], v[92:93], v[86:87]
    v_pk_mul_f32 v[94:95], v[94:95], v[88:89]
    v_pk_mul_f32 v[96:97], v[96:97], v[90:91]
    v_exp_f32 v92, v92
    v_exp_f32 v93, v93
    v_exp_f32 v94, v94
    v_exp_f32 v95, v95
    v_exp_f32 v96, v96
    v_exp_f32 v97, v97
    v_pk_mul_f32 v[86:87], v[86:87], v[84:85]
    v_pk_mul_f32 v[88:89], v[88:89], v[84:85]
    v_pk_mul_f32 v[90:91], v[90:91], v[84:85]
    v_pk_add_f32 v[92:93], v[92:93], 1.0 op_sel_hi:[1,0]
    v_pk_add_f32 v[94:95], v[94:95], 1.0 op_sel_hi:[1,0]
    v_pk_add_f32 v[96:97], v[96:97], 1.0 op_sel_hi:[1,0]
    v_rcp_f32 v92, v92
    v_rcp_f32 v93, v93
    v_rcp_f32 v94, v94
    v_rcp_f32 v95, v95
    s_add_u32 s93, s58, 0x4014000
    buffer_load_dwordx4 a[64:67], v1, s[4:7], s93 offen offset:0 nt
    buffer_load_dwordx4 a[68:71], v1, s[4:7], s93 offen offset:128 nt
    buffer_load_dwordx4 a[72:75], v1, s[4:7], s93 offen offset:2048 nt
    buffer_load_dwordx4 a[76:79], v1, s[4:7], s93 offen offset:2176 nt
    buffer_load_dwordx4 a[80:83], v2, s[8:11], s93 offen offset:0 nt
    buffer_load_dwordx4 a[84:87], v2, s[8:11], s93 offen offset:256 nt
    buffer_load_dwordx4 a[88:91], v2, s[8:11], s93 offen offset:2048 nt
    buffer_load_dwordx4 a[92:95], v2, s[8:11], s93 offen offset:2304 nt
    v_rcp_f32 v96, v96
    v_rcp_f32 v97, v97
    v_pk_fma_f32 v[110:111], v[86:87], v[92:93], v[110:111]
    v_pk_fma_f32 v[112:113], v[88:89], v[94:95], v[112:113]
    v_pk_fma_f32 v[114:115], v[90:91], v[96:97], v[114:115]
    v_lshlrev_b32 v84, 16, v138
    v_lshlrev_b32 v85, 16, v139
    v_pk_fma_f32 v[86:87], v[102:103], v[22:23], v[30:31] op_sel_hi:[0,1,1]
    v_pk_fma_f32 v[88:89], v[104:105], v[22:23], v[30:31] op_sel_hi:[0,1,1]
    v_pk_fma_f32 v[90:91], v[106:107], v[22:23], v[30:31] op_sel_hi:[0,1,1]
    v_pk_mul_f32 v[92:93], v[86:87], v[86:87]
    v_pk_mul_f32 v[94:95], v[88:89], v[88:89]
    v_pk_mul_f32 v[96:97], v[90:91], v[90:91]
    v_pk_fma_f32 v[92:93], v[92:93], s[66:67], v[108:109] op_sel_hi:[1,1,0]
    v_pk_fma_f32 v[94:95], v[94:95], s[66:67], v[108:109] op_sel_hi:[1,1,0]
    v_pk_fma_f32 v[96:97], v[96:97], s[66:67], v[108:109] op_sel_hi:[1,1,0]
    v_pk_mul_f32 v[92:93], v[92:93], v[86:87]
    v_pk_mul_f32 v[94:95], v[94:95], v[88:89]
    v_pk_mul_f32 v[96:97], v[96:97], v[90:91]
    v_exp_f32 v92, v92
    v_exp_f32 v93, v93
    v_exp_f32 v94, v94
    v_exp_f32 v95, v95
    v_exp_f32 v96, v96
    v_exp_f32 v97, v97
    v_pk_mul_f32 v[86:87], v[86:87], v[84:85]
    v_pk_mul_f32 v[88:89], v[88:89], v[84:85]
    v_pk_mul_f32 v[90:91], v[90:91], v[84:85]
    v_pk_add_f32 v[92:93], v[92:93], 1.0 op_sel_hi:[1,0]
    v_pk_add_f32 v[94:95], v[94:95], 1.0 op_sel_hi:[1,0]
    v_pk_add_f32 v[96:97], v[96:97], 1.0 op_sel_hi:[1,0]
    v_rcp_f32 v92, v92
    v_rcp_f32 v93, v93
    v_rcp_f32 v94, v94
    v_rcp_f32 v95, v95
    v_rcp_f32 v96, v96
    v_rcp_f32 v97, v97
    v_pk_fma_f32 v[110:111], v[86:87], v[92:93], v[110:111]
    v_pk_fma_f32 v[112:113], v[88:89], v[94:95], v[112:113]
    v_pk_fma_f32 v[114:115], v[90:91], v[96:97], v[114:115]
    v_lshlrev_b32 v80, 16, v140
    v_and_b32 v81, 0xffff0000, v140
    v_lshlrev_b32 v82, 16, v141
    v_and_b32 v83, 0xffff0000, v141
    v_lshlrev_b32 v84, 16, v142
    v_and_b32 v85, 0xffff0000, v142
    v_pk_fma_f32 v[86:87], v[102:103], v[80:81], v[82:83] op_sel_hi:[0,1,1]
    v_pk_fma_f32 v[88:89], v[104:105], v[80:81], v[82:83] op_sel_hi:[0,1,1]
    v_pk_fma_f32 v[90:91], v[106:107], v[80:81], v[82:83] op_sel_hi:[0,1,1]
    v_pk_mul_f32 v[92:93], v[86:87], v[86:87]
    v_pk_mul_f32 v[94:95], v[88:89], v[88:89]
    v_pk_mul_f32 v[96:97], v[90:91], v[90:91]
    v_pk_fma_f32 v[92:93], v[92:93], s[66:67], v[108:109] op_sel_hi:[1,1,0]
    v_pk_fma_f32 v[94:95], v[94:95], s[66:67], v[108:109] op_sel_hi:[1,1,0]
    v_pk_fma_f32 v[96:97], v[96:97], s[66:67], v[108:109] op_sel_hi:[1,1,0]
    v_pk_mul_f32 v[92:93], v[92:93], v[86:87]
    v_pk_mul_f32 v[94:95], v[94:95], v[88:89]
    v_pk_mul_f32 v[96:97], v[96:97], v[90:91]
    v_exp_f32 v92, v92
    v_exp_f32 v93, v93
    v_exp_f32 v94, v94
    v_exp_f32 v95, v95
    v_exp_f32 v96, v96
    v_exp_f32 v97, v97
    v_pk_mul_f32 v[86:87], v[86:87], v[84:85]
    v_pk_mul_f32 v[88:89], v[88:89], v[84:85]
    v_pk_mul_f32 v[90:91], v[90:91], v[84:85]
    v_pk_add_f32 v[92:93], v[92:93], 1.0 op_sel_hi:[1,0]
    v_pk_add_f32 v[94:95], v[94:95], 1.0 op_sel_hi:[1,0]
    v_pk_add_f32 v[96:97], v[96:97], 1.0 op_sel_hi:[1,0]
    v_rcp_f32 v92, v92
    v_rcp_f32 v93, v93
    v_rcp_f32 v94, v94
    v_rcp_f32 v95, v95
    v_rcp_f32 v96, v96
    v_rcp_f32 v97, v97
    v_pk_fma_f32 v[110:111], v[86:87], v[92:93], v[110:111]
    v_pk_fma_f32 v[112:113], v[88:89], v[94:95], v[112:113]
    v_pk_fma_f32 v[114:115], v[90:91], v[96:97], v[114:115]
    v_add_f32 v110, v110, v111
    v_add_f32 v112, v112, v113
    v_add_f32 v114, v114, v115
    v_add_f32_dpp v110, v110, v110 row_ror:8 row_mask:0xf bank_mask:0xf
    v_add_f32_dpp v112, v112, v112 row_ror:8 row_mask:0xf bank_mask:0xf
    v_add_f32_dpp v114, v114, v114 row_ror:8 row_mask:0xf bank_mask:0xf
    v_add_f32_dpp v110, v110, v110 row_ror:4 row_mask:0xf bank_mask:0xf
    v_add_f32_dpp v112, v112, v112 row_ror:4 row_mask:0xf bank_mask:0xf
    v_add_f32_dpp v114, v114, v114 row_ror:4 row_mask:0xf bank_mask:0xf
    v_add_f32_dpp v110, v110, v110 row_ror:2 row_mask:0xf bank_mask:0xf
    v_add_f32_dpp v112, v112, v112 row_ror:2 row_mask:0xf bank_mask:0xf
    v_add_f32_dpp v114, v114, v114 row_ror:2 row_mask:0xf bank_mask:0xf
    v_add_f32_dpp v110, v110, v110 row_ror:1 row_mask:0xf bank_mask:0xf
    v_add_f32_dpp v112, v112, v112 row_ror:1 row_mask:0xf bank_mask:0xf
    v_add_f32_dpp v114, v114, v114 row_ror:1 row_mask:0xf bank_mask:0xf
    s_lshl_b32 s29, s24, 4
    v_lshrrev_b32 v12, 4, v0
    v_lshl_add_u32 v12, v12, 2, s29
    ds_write_b32 v12, v110 offset:14848
    ds_write_b32 v12, v112 offset:14912
    ds_write_b32 v12, v114 offset:14976
    v_and_b32 v13, 3, v0
    v_lshlrev_b32 v13, 6, v13
    s_waitcnt lgkmcnt(0)
    s_barrier
    s_cmp_lg_u32 s24, 0
    s_cbranch_scc1 XD_106
    s_cmp_eq_u32 s62, 0
    s_cbranch_scc1 XD_106
    ds_read_b128 v[80:83], v13 offset:14848
    ds_read_b128 v[84:87], v13 offset:14864
    ds_read_b128 v[88:91], v13 offset:14880
    ds_read_b128 v[92:95], v13 offset:14896
    s_mul_i32 s29, s82, 2304
    s_add_u32 s59, s29, 0x68000
    v_add_u32 v15, s29, v14
    v_lshrrev_b32 v15, 1, v15
    s_waitcnt lgkmcnt(0)
    v_pk_add_f32 v[80:81], v[80:81], v[88:89]
    v_pk_add_f32 v[82:83], v[82:83], v[90:91]
    v_pk_add_f32 v[84:85], v[84:85], v[92:93]
    v_pk_add_f32 v[86:87], v[86:87], v[94:95]
    v_pk_add_f32 v[80:81], v[80:81], v[84:85]
    v_pk_add_f32 v[82:83], v[82:83], v[86:87]
    v_pk_add_f32 v[80:81], v[80:81], v[82:83]
    v_add_f32 v80, v80, v81
    v_cvt_pk_bf16_f32 v12, v80, v80
    v_lshlrev_b32 v80, 16, v12
    v_add_f32 v80, s68, v80
    v_cvt_pk_bf16_f32 v12, v80, v80
    v_lshlrev_b32 v80, 16, v12
    v_add_f32 v80, v80, v143
    v_cvt_pk_bf16_f32 v80, v80, v80
    s_mov_b64 exec, 7
    s_cmp_ge_u32 s81, 2
    s_cbranch_scc1 XF_107
    v_and_b32 v80, 0xffff0000, v80
    buffer_store_dword v80, v14, s[12:15], s59 offen sc1
    s_branch XR_108
XF_107:
    global_store_short v15, v80, s[52:53]
XR_108:
    s_mov_b64 exec, -1
XD_106:
    s_add_u32 s61, s61, 1
    v_add_u32 v58, s83, v8
    v_add_u32 v59, s83, v3
    ds_read_b128 v[48:51], v58
    ds_read_b128 v[52:55], v58 offset:1024
    ds_read_b32 v56, v59 offset:2048
    s_mul_i32 s73, s61, 12
    v_and_b32 v14, 12, v3
    v_add_u32 v14, s73, v14
    v_add_u32 v15, s83, v14
    ds_read_b32 v58, v15
    s_waitcnt lgkmcnt(0)
    s_barrier
    ds_read_b32 v143, v14 offset:0
    ds_read_b32 v12, v14 offset:2304
    ds_read_b32 v13, v14 offset:4608
    ds_read_b32 v15, v14 offset:6912
    ds_read_b128 v[80:83], v8 offset:0
    ds_read_b128 v[84:87], v8 offset:1024
    ds_read_b32 v112, v3 offset:2048
    ds_read_b128 v[88:91], v8 offset:2304
    ds_read_b128 v[92:95], v8 offset:3328
    ds_read_b32 v113, v3 offset:4352
    ds_read_b128 v[96:99], v8 offset:4608
    ds_read_b128 v[100:103], v8 offset:5632
    ds_read_b32 v114, v3 offset:6656
    ds_read_b128 v[104:107], v8 offset:6912
    ds_read_b128 v[108:111], v8 offset:7936
    ds_read_b32 v115, v3 offset:8960
    s_waitcnt lgkmcnt(12)
    v_add_f32 v143, v143, v12
    v_add_f32 v13, v13, v15
    v_add_f32 v143, v143, v13
    v_cvt_pk_bf16_f32 v12, v143, v143
    v_lshlrev_b32 v143, 16, v12
    v_add_f32 v143, v143, v58
    v_cvt_pk_bf16_f32 v12, v143, v143
    v_lshlrev_b32 v143, 16, v12
    s_waitcnt lgkmcnt(6)
    v_pk_add_f32 v[48:49], v[48:49], v[80:81]
    v_pk_add_f32 v[50:51], v[50:51], v[82:83]
    v_pk_add_f32 v[52:53], v[52:53], v[84:85]
    v_pk_add_f32 v[54:55], v[54:55], v[86:87]
    v_pk_add_f32 v[48:49], v[48:49], v[88:89]
    v_pk_add_f32 v[50:51], v[50:51], v[90:91]
    v_pk_add_f32 v[52:53], v[52:53], v[92:93]
    v_pk_add_f32 v[54:55], v[54:55], v[94:95]
    s_waitcnt lgkmcnt(0)
    s_add_u32 s91, s58, 0x4018000
    buffer_load_dwordx4 a[32:35], v1, s[4:7], s91 offen offset:0 nt
    buffer_load_dwordx4 a[36:39], v1, s[4:7], s91 offen offset:128 nt
    buffer_load_dwordx4 a[40:43], v1, s[4:7], s91 offen offset:2048 nt
    buffer_load_dwordx4 a[44:47], v1, s[4:7], s91 offen offset:2176 nt
    buffer_load_dwordx4 a[48:51], v2, s[8:11], s91 offen offset:0 nt
    buffer_load_dwordx4 a[52:55], v2, s[8:11], s91 offen offset:256 nt
    buffer_load_dwordx4 a[56:59], v2, s[8:11], s91 offen offset:2048 nt
    buffer_load_dwordx4 a[60:63], v2, s[8:11], s91 offen offset:2304 nt
    v_pk_add_f32 v[96:97], v[96:97], v[104:105]
    v_pk_add_f32 v[98:99], v[98:99], v[106:107]
    v_pk_add_f32 v[100:101], v[100:101], v[108:109]
    v_pk_add_f32 v[102:103], v[102:103], v[110:111]
    v_pk_add_f32 v[112:113], v[112:113], v[114:115]
    v_pk_add_f32 v[48:49], v[48:49], v[96:97]
    v_pk_add_f32 v[50:51], v[50:51], v[98:99]
    v_pk_add_f32 v[52:53], v[52:53], v[100:101]
    v_pk_add_f32 v[54:55], v[54:55], v[102:103]
    v_add_f32 v56, v56, v112
    v_add_f32 v56, v56, v113
    v_pk_add_f32 v[100:101], v[48:49], v[50:51]
    v_pk_add_f32 v[80:81], v[52:53], v[54:55]
    v_pk_add_f32 v[100:101], v[100:101], v[80:81]
    v_add_f32 v100, v100, v56
    v_add_f32 v100, v100, v101
    s_nop 1
    v_add_f32_dpp v100, v100, v100 row_ror:8 row_mask:0xf bank_mask:0xf
    s_nop 1
    v_add_f32_dpp v100, v100, v100 row_ror:4 row_mask:0xf bank_mask:0xf
    s_nop 1
    v_add_f32_dpp v100, v100, v100 row_ror:2 row_mask:0xf bank_mask:0xf
    s_nop 1
    v_add_f32_dpp v100, v100, v100 row_ror:1 row_mask:0xf bank_mask:0xf
    v_mov_b32 v12, v100
    s_nop 1
    v_permlane16_swap_b32 v100, v12
    v_add_f32 v100, v100, v12
    v_mov_b32 v12, v100
    s_nop 1
    v_permlane32_swap_b32 v100, v12
    v_add_f32 v100, v100, v12
    v_mul_f32 v100, 0x3ae38e39, v100
    v_pk_add_f32 v[80:81], v[48:49], v[100:101] op_sel_hi:[1,0] neg_lo:[0,1] neg_hi:[0,1]
    v_pk_add_f32 v[82:83], v[50:51], v[100:101] op_sel_hi:[1,0] neg_lo:[0,1] neg_hi:[0,1]
    v_pk_add_f32 v[84:85], v[52:53], v[100:101] op_sel_hi:[1,0] neg_lo:[0,1] neg_hi:[0,1]
    v_pk_add_f32 v[86:87], v[54:55], v[100:101] op_sel_hi:[1,0] neg_lo:[0,1] neg_hi:[0,1]
    v_sub_f32 v88, v56, v100
    v_pk_mul_f32 v[80:81], v[80:81], v[80:81]
    v_mul_f32 v101, v88, v88
    v_pk_fma_f32 v[80:81], v[82:83], v[82:83], v[80:81]
    v_pk_fma_f32 v[80:81], v[84:85], v[84:85], v[80:81]
    v_pk_fma_f32 v[80:81], v[86:87], v[86:87], v[80:81]
    v_add_f32 v101, v101, v80
    v_add_f32 v101, v101, v81
    s_nop 1
    v_add_f32_dpp v101, v101, v101 row_ror:8 row_mask:0xf bank_mask:0xf
    s_nop 1
    v_add_f32_dpp v101, v101, v101 row_ror:4 row_mask:0xf bank_mask:0xf
    s_nop 1
    v_add_f32_dpp v101, v101, v101 row_ror:2 row_mask:0xf bank_mask:0xf
    s_nop 1
    v_add_f32_dpp v101, v101, v101 row_ror:1 row_mask:0xf bank_mask:0xf
    v_mov_b32 v12, v101
    s_nop 1
    v_permlane16_swap_b32 v101, v12
    v_add_f32 v101, v101, v12
    v_mov_b32 v12, v101
    s_nop 1
    v_permlane32_swap_b32 v101, v12
    v_add_f32 v101, v101, v12
    v_mul_f32 v101, 0x3ae38e39, v101
    v_cvt_pk_bf16_f32 v12, v100, v101
    v_lshlrev_b32 v80, 16, v12
    v_and_b32 v81, 0xffff0000, v12
    v_add_f32 v81, s90, v81
    v_sub_f32 v13, v143, v80
    v_cvt_pk_bf16_f32 v12, v81, v13
    v_lshlrev_b32 v81, 16, v12
    v_and_b32 v13, 0xffff0000, v12
    v_sqrt_f32 v81, v81
    v_sub_f32 v82, v100, v80
    v_cvt_pk_bf16_f32 v12, v81, v81
    v_lshlrev_b32 v81, 16, v12
    v_rcp_f32 v81, v81
    s_nop 0
    v_mul_f32 v101, v101, v81
    v_mul_f32 v82, v82, v81
    v_mul_f32 v101, v101, v81
    v_mul_f32 v13, v13, v81
    v_cvt_pk_bf16_f32 v12, v82, v101
    v_lshlrev_b32 v82, 16, v12
    v_and_b32 v101, 0xffff0000, v12
    v_add_f32 v101, s90, v101
    v_cvt_pk_bf16_f32 v12, v13, v101
    v_lshlrev_b32 v13, 16, v12
    v_and_b32 v101, 0xffff0000, v12
    v_sqrt_f32 v101, v101
    v_sub_f32 v13, v13, v82
    v_cvt_pk_bf16_f32 v12, v13, v101
    v_lshlrev_b32 v13, 16, v12
    v_and_b32 v101, 0xffff0000, v12
    v_rcp_f32 v101, v101
    s_nop 0
    v_mul_f32 v13, v13, v101
    v_cvt_pk_bf16_f32 v12, v13, v13
    v_lshlrev_b32 v13, 16, v12
    v_mov_b32 v108, 0xc0135761
    s_nop 0
    v_mov_b32_dpp v102, v13 quad_perm:[0,0,0,0] row_mask:0xf bank_mask:0xf
    v_mov_b32_dpp v104, v13 quad_perm:[1,1,1,1] row_mask:0xf bank_mask:0xf
    v_mov_b32_dpp v106, v13 quad_perm:[2,2,2,2] row_mask:0xf bank_mask:0xf
    v_pk_fma_f32 v[86:87], v[102:103], v[116:117], v[124:125] op_sel_hi:[0,1,1]
    v_pk_fma_f32 v[88:89], v[104:105], v[116:117], v[124:125] op_sel_hi:[0,1,1]
    v_pk_fma_f32 v[90:91], v[106:107], v[116:117], v[124:125] op_sel_hi:[0,1,1]
    v_pk_mul_f32 v[92:93], v[86:87], v[86:87]
    v_pk_mul_f32 v[94:95], v[88:89], v[88:89]
    v_pk_mul_f32 v[96:97], v[90:91], v[90:91]
    v_pk_fma_f32 v[92:93], v[92:93], s[66:67], v[108:109] op_sel_hi:[1,1,0]
    v_pk_fma_f32 v[94:95], v[94:95], s[66:67], v[108:109] op_sel_hi:[1,1,0]
    v_pk_fma_f32 v[96:97], v[96:97], s[66:67], v[108:109] op_sel_hi:[1,1,0]
    v_pk_mul_f32 v[92:93], v[92:93], v[86:87]
    v_pk_mul_f32 v[94:95], v[94:95], v[88:89]
    v_pk_mul_f32 v[96:97], v[96:97], v[90:91]
    v_exp_f32 v92, v92
    v_exp_f32 v93, v93
    v_exp_f32 v94, v94
    v_exp_f32 v95, v95
    v_exp_f32 v96, v96
    v_exp_f32 v97, v97
    v_pk_mul_f32 v[86:87], v[86:87], v[132:133]
    v_pk_mul_f32 v[88:89], v[88:89], v[132:133]
    v_pk_mul_f32 v[90:91], v[90:91], v[132:133]
    v_pk_add_f32 v[92:93], v[92:93], 1.0 op_sel_hi:[1,0]
    v_pk_add_f32 v[94:95], v[94:95], 1.0 op_sel_hi:[1,0]
    v_pk_add_f32 v[96:97], v[96:97], 1.0 op_sel_hi:[1,0]
    v_rcp_f32 v92, v92
    v_rcp_f32 v93, v93
    v_rcp_f32 v94, v94
    v_rcp_f32 v95, v95
    v_rcp_f32 v96, v96
    v_rcp_f32 v97, v97
    v_pk_mul_f32 v[110:111], v[86:87], v[92:93]
    v_pk_mul_f32 v[112:113], v[88:89], v[94:95]
    v_pk_mul_f32 v[114:115], v[90:91], v[96:97]
    v_pk_fma_f32 v[86:87], v[102:103], v[118:119], v[126:127] op_sel_hi:[0,1,1]
    v_pk_fma_f32 v[88:89], v[104:105], v[118:119], v[126:127] op_sel_hi:[0,1,1]
    v_pk_fma_f32 v[90:91], v[106:107], v[118:119], v[126:127] op_sel_hi:[0,1,1]
    v_pk_mul_f32 v[92:93], v[86:87], v[86:87]
    v_pk_mul_f32 v[94:95], v[88:89], v[88:89]
    v_pk_mul_f32 v[96:97], v[90:91], v[90:91]
    v_pk_fma_f32 v[92:93], v[92:93], s[66:67], v[108:109] op_sel_hi:[1,1,0]
    v_pk_fma_f32 v[94:95], v[94:95], s[66:67], v[108:109] op_sel_hi:[1,1,0]
    v_pk_fma_f32 v[96:97], v[96:97], s[66:67], v[108:109] op_sel_hi:[1,1,0]
    v_pk_mul_f32 v[92:93], v[92:93], v[86:87]
    v_pk_mul_f32 v[94:95], v[94:95], v[88:89]
    v_pk_mul_f32 v[96:97], v[96:97], v[90:91]
    v_exp_f32 v92, v92
    v_exp_f32 v93, v93
    v_exp_f32 v94, v94
    v_exp_f32 v95, v95
    v_exp_f32 v96, v96
    v_exp_f32 v97, v97
    v_pk_mul_f32 v[86:87], v[86:87], v[134:135]
    v_pk_mul_f32 v[88:89], v[88:89], v[134:135]
    v_pk_mul_f32 v[90:91], v[90:91], v[134:135]
    v_pk_add_f32 v[92:93], v[92:93], 1.0 op_sel_hi:[1,0]
    v_pk_add_f32 v[94:95], v[94:95], 1.0 op_sel_hi:[1,0]
    v_pk_add_f32 v[96:97], v[96:97], 1.0 op_sel_hi:[1,0]
    v_rcp_f32 v92, v92
    v_rcp_f32 v93, v93
    v_rcp_f32 v94, v94
    v_rcp_f32 v95, v95
    v_rcp_f32 v96, v96
    v_rcp_f32 v97, v97
    v_pk_fma_f32 v[110:111], v[86:87], v[92:93], v[110:111]
    v_pk_fma_f32 v[112:113], v[88:89], v[94:95], v[112:113]
    v_pk_fma_f32 v[114:115], v[90:91], v[96:97], v[114:115]
    v_and_b32 v84, 0xffff0000, v136
    v_and_b32 v85, 0xffff0000, v137
    v_pk_fma_f32 v[86:87], v[102:103], v[120:121], v[128:129] op_sel_hi:[0,1,1]
    v_pk_fma_f32 v[88:89], v[104:105], v[120:121], v[128:129] op_sel_hi:[0,1,1]
    v_pk_fma_f32 v[90:91], v[106:107], v[120:121], v[128:129] op_sel_hi:[0,1,1]
    v_pk_mul_f32 v[92:93], v[86:87], v[86:87]
    v_pk_mul_f32 v[94:95], v[88:89], v[88:89]
    v_pk_mul_f32 v[96:97], v[90:91], v[90:91]
    v_pk_fma_f32 v[92:93], v[92:93], s[66:67], v[108:109] op_sel_hi:[1,1,0]
    v_pk_fma_f32 v[94:95], v[94:95], s[66:67], v[108:109] op_sel_hi:[1,1,0]
    v_pk_fma_f32 v[96:97], v[96:97], s[66:67], v[108:109] op_sel_hi:[1,1,0]
    v_pk_mul_f32 v[92:93], v[92:93], v[86:87]
    v_pk_mul_f32 v[94:95], v[94:95], v[88:89]
    v_pk_mul_f32 v[96:97], v[96:97], v[90:91]
    v_exp_f32 v92, v92
    v_exp_f32 v93, v93
    v_exp_f32 v94, v94
    v_exp_f32 v95, v95
    v_exp_f32 v96, v96
    v_exp_f32 v97, v97
    v_pk_mul_f32 v[86:87], v[86:87], v[84:85]
    v_pk_mul_f32 v[88:89], v[88:89], v[84:85]
    s_add_u32 s92, s58, 0x401c000
    buffer_load_dwordx4 a[0:3], v1, s[4:7], s92 offen offset:0 nt
    buffer_load_dwordx4 a[4:7], v1, s[4:7], s92 offen offset:128 nt
    buffer_load_dwordx4 a[8:11], v1, s[4:7], s92 offen offset:2048 nt
    buffer_load_dwordx4 a[12:15], v1, s[4:7], s92 offen offset:2176 nt
    buffer_load_dwordx4 a[16:19], v2, s[8:11], s92 offen offset:0 nt
    s_waitcnt vmcnt(60)
    buffer_load_dwordx4 a[20:23], v2, s[8:11], s92 offen offset:256 nt
    s_waitcnt vmcnt(60)
    buffer_load_dwordx4 a[24:27], v2, s[8:11], s92 offen offset:2048 nt
    s_waitcnt vmcnt(60)
    buffer_load_dwordx4 a[28:31], v2, s[8:11], s92 offen offset:2304 nt
    v_pk_mul_f32 v[90:91], v[90:91], v[84:85]
    v_pk_add_f32 v[92:93], v[92:93], 1.0 op_sel_hi:[1,0]
    v_pk_add_f32 v[94:95], v[94:95], 1.0 op_sel_hi:[1,0]
    v_pk_add_f32 v[96:97], v[96:97], 1.0 op_sel_hi:[1,0]
    v_rcp_f32 v92, v92
    v_rcp_f32 v93, v93
    v_rcp_f32 v94, v94
    v_rcp_f32 v95, v95
    v_rcp_f32 v96, v96
    v_rcp_f32 v97, v97
    v_pk_fma_f32 v[110:111], v[86:87], v[92:93], v[110:111]
    v_pk_fma_f32 v[112:113], v[88:89], v[94:95], v[112:113]
    v_pk_fma_f32 v[114:115], v[90:91], v[96:97], v[114:115]
    v_and_b32 v84, 0xffff0000, v138
    v_and_b32 v85, 0xffff0000, v139
    v_pk_fma_f32 v[86:87], v[102:103], v[122:123], v[130:131] op_sel_hi:[0,1,1]
    v_pk_fma_f32 v[88:89], v[104:105], v[122:123], v[130:131] op_sel_hi:[0,1,1]
    v_pk_fma_f32 v[90:91], v[106:107], v[122:123], v[130:131] op_sel_hi:[0,1,1]
    v_pk_mul_f32 v[92:93], v[86:87], v[86:87]
    v_pk_mul_f32 v[94:95], v[88:89], v[88:89]
    v_pk_mul_f32 v[96:97], v[90:91], v[90:91]
    v_pk_fma_f32 v[92:93], v[92:93], s[66:67], v[108:109] op_sel_hi:[1,1,0]
    v_pk_fma_f32 v[94:95], v[94:95], s[66:67], v[108:109] op_sel_hi:[1,1,0]
    v_pk_fma_f32 v[96:97], v[96:97], s[66:67], v[108:109] op_sel_hi:[1,1,0]
    v_pk_mul_f32 v[92:93], v[92:93], v[86:87]
    v_pk_mul_f32 v[94:95], v[94:95], v[88:89]
    v_pk_mul_f32 v[96:97], v[96:97], v[90:91]
    v_exp_f32 v92, v92
    v_exp_f32 v93, v93
    v_exp_f32 v94, v94
    v_exp_f32 v95, v95
    v_exp_f32 v96, v96
    v_exp_f32 v97, v97
    v_pk_mul_f32 v[86:87], v[86:87], v[84:85]
    v_pk_mul_f32 v[88:89], v[88:89], v[84:85]
    v_pk_mul_f32 v[90:91], v[90:91], v[84:85]
    v_pk_add_f32 v[92:93], v[92:93], 1.0 op_sel_hi:[1,0]
    v_pk_add_f32 v[94:95], v[94:95], 1.0 op_sel_hi:[1,0]
    v_pk_add_f32 v[96:97], v[96:97], 1.0 op_sel_hi:[1,0]
    v_rcp_f32 v92, v92
    v_rcp_f32 v93, v93
    v_rcp_f32 v94, v94
    v_rcp_f32 v95, v95
    v_rcp_f32 v96, v96
    v_rcp_f32 v97, v97
    v_pk_fma_f32 v[110:111], v[86:87], v[92:93], v[110:111]
    v_pk_fma_f32 v[112:113], v[88:89], v[94:95], v[112:113]
    v_pk_fma_f32 v[114:115], v[90:91], v[96:97], v[114:115]
    v_pk_fma_f32 v[86:87], v[102:103], v[16:17], v[24:25] op_sel_hi:[0,1,1]
    v_pk_fma_f32 v[88:89], v[104:105], v[16:17], v[24:25] op_sel_hi:[0,1,1]
    v_pk_fma_f32 v[90:91], v[106:107], v[16:17], v[24:25] op_sel_hi:[0,1,1]
    v_pk_mul_f32 v[92:93], v[86:87], v[86:87]
    v_pk_mul_f32 v[94:95], v[88:89], v[88:89]
    v_pk_mul_f32 v[96:97], v[90:91], v[90:91]
    v_pk_fma_f32 v[92:93], v[92:93], s[66:67], v[108:109] op_sel_hi:[1,1,0]
    v_pk_fma_f32 v[94:95], v[94:95], s[66:67], v[108:109] op_sel_hi:[1,1,0]
    v_pk_fma_f32 v[96:97], v[96:97], s[66:67], v[108:109] op_sel_hi:[1,1,0]
    v_pk_mul_f32 v[92:93], v[92:93], v[86:87]
    v_pk_mul_f32 v[94:95], v[94:95], v[88:89]
    v_pk_mul_f32 v[96:97], v[96:97], v[90:91]
    v_exp_f32 v92, v92
    v_exp_f32 v93, v93
    v_exp_f32 v94, v94
    v_exp_f32 v95, v95
    v_exp_f32 v96, v96
    v_exp_f32 v97, v97
    v_pk_mul_f32 v[86:87], v[86:87], v[44:45]
    v_pk_mul_f32 v[88:89], v[88:89], v[44:45]
    v_pk_mul_f32 v[90:91], v[90:91], v[44:45]
    v_pk_add_f32 v[92:93], v[92:93], 1.0 op_sel_hi:[1,0]
    v_pk_add_f32 v[94:95], v[94:95], 1.0 op_sel_hi:[1,0]
    v_pk_add_f32 v[96:97], v[96:97], 1.0 op_sel_hi:[1,0]
    v_rcp_f32 v92, v92
    v_rcp_f32 v93, v93
    v_rcp_f32 v94, v94
    v_rcp_f32 v95, v95
    v_rcp_f32 v96, v96
    v_rcp_f32 v97, v97
    v_pk_fma_f32 v[110:111], v[86:87], v[92:93], v[110:111]
    v_pk_fma_f32 v[112:113], v[88:89], v[94:95], v[112:113]
    v_pk_fma_f32 v[114:115], v[90:91], v[96:97], v[114:115]
    v_pk_fma_f32 v[86:87], v[102:103], v[18:19], v[26:27] op_sel_hi:[0,1,1]
    v_pk_fma_f32 v[88:89], v[104:105], v[18:19], v[26:27] op_sel_hi:[0,1,1]
    v_pk_fma_f32 v[90:91], v[106:107], v[18:19], v[26:27] op_sel_hi:[0,1,1]
    v_pk_mul_f32 v[92:93], v[86:87], v[86:87]
    v_pk_mul_f32 v[94:95], v[88:89], v[88:89]
    v_pk_mul_f32 v[96:97], v[90:91], v[90:91]
    v_pk_fma_f32 v[92:93], v[92:93], s[66:67], v[108:109] op_sel_hi:[1,1,0]
    v_pk_fma_f32 v[94:95], v[94:95], s[66:67], v[108:109] op_sel_hi:[1,1,0]
    v_pk_fma_f32 v[96:97], v[96:97], s[66:67], v[108:109] op_sel_hi:[1,1,0]
    v_pk_mul_f32 v[92:93], v[92:93], v[86:87]
    v_pk_mul_f32 v[94:95], v[94:95], v[88:89]
    v_pk_mul_f32 v[96:97], v[96:97], v[90:91]
    v_exp_f32 v92, v92
    v_exp_f32 v93, v93
    v_exp_f32 v94, v94
    v_exp_f32 v95, v95
    v_exp_f32 v96, v96
    v_exp_f32 v97, v97
    v_pk_mul_f32 v[86:87], v[86:87], v[46:47]
    v_pk_mul_f32 v[88:89], v[88:89], v[46:47]
    v_pk_mul_f32 v[90:91], v[90:91], v[46:47]
    v_pk_add_f32 v[92:93], v[92:93], 1.0 op_sel_hi:[1,0]
    v_pk_add_f32 v[94:95], v[94:95], 1.0 op_sel_hi:[1,0]
    v_pk_add_f32 v[96:97], v[96:97], 1.0 op_sel_hi:[1,0]
    v_rcp_f32 v92, v92
    v_rcp_f32 v93, v93
    v_rcp_f32 v94, v94
    v_rcp_f32 v95, v95
    v_rcp_f32 v96, v96
    v_rcp_f32 v97, v97
    v_pk_fma_f32 v[110:111], v[86:87], v[92:93], v[110:111]
    v_pk_fma_f32 v[112:113], v[88:89], v[94:95], v[112:113]
    v_pk_fma_f32 v[114:115], v[90:91], v[96:97], v[114:115]
    v_lshlrev_b32 v84, 16, v136
    v_lshlrev_b32 v85, 16, v137
    v_pk_fma_f32 v[86:87], v[102:103], v[20:21], v[28:29] op_sel_hi:[0,1,1]
    v_pk_fma_f32 v[88:89], v[104:105], v[20:21], v[28:29] op_sel_hi:[0,1,1]
    v_pk_fma_f32 v[90:91], v[106:107], v[20:21], v[28:29] op_sel_hi:[0,1,1]
    v_pk_mul_f32 v[92:93], v[86:87], v[86:87]
    v_pk_mul_f32 v[94:95], v[88:89], v[88:89]
    v_pk_mul_f32 v[96:97], v[90:91], v[90:91]
    v_pk_fma_f32 v[92:93], v[92:93], s[66:67], v[108:109] op_sel_hi:[1,1,0]
    v_pk_fma_f32 v[94:95], v[94:95], s[66:67], v[108:109] op_sel_hi:[1,1,0]
    v_pk_fma_f32 v[96:97], v[96:97], s[66:67], v[108:109] op_sel_hi:[1,1,0]
    v_pk_mul_f32 v[92:93], v[92:93], v[86:87]
    v_pk_mul_f32 v[94:95], v[94:95], v[88:89]
    v_pk_mul_f32 v[96:97], v[96:97], v[90:91]
    v_exp_f32 v92, v92
    v_exp_f32 v93, v93
    v_exp_f32 v94, v94
    v_exp_f32 v95, v95
    v_exp_f32 v96, v96
    v_exp_f32 v97, v97
    v_pk_mul_f32 v[86:87], v[86:87], v[84:85]
    v_pk_mul_f32 v[88:89], v[88:89], v[84:85]
    v_pk_mul_f32 v[90:91], v[90:91], v[84:85]
    v_pk_add_f32 v[92:93], v[92:93], 1.0 op_sel_hi:[1,0]
    v_pk_add_f32 v[94:95], v[94:95], 1.0 op_sel_hi:[1,0]
    v_pk_add_f32 v[96:97], v[96:97], 1.0 op_sel_hi:[1,0]
    v_rcp_f32 v92, v92
    v_rcp_f32 v93, v93
    v_rcp_f32 v94, v94
    v_rcp_f32 v95, v95
    v_rcp_f32 v96, v96
    v_rcp_f32 v97, v97
    v_pk_fma_f32 v[110:111], v[86:87], v[92:93], v[110:111]
    v_pk_fma_f32 v[112:113], v[88:89], v[94:95], v[112:113]
    v_pk_fma_f32 v[114:115], v[90:91], v[96:97], v[114:115]
    v_lshlrev_b32 v84, 16, v138
    v_lshlrev_b32 v85, 16, v139
    v_pk_fma_f32 v[86:87], v[102:103], v[22:23], v[30:31] op_sel_hi:[0,1,1]
    v_pk_fma_f32 v[88:89], v[104:105], v[22:23], v[30:31] op_sel_hi:[0,1,1]
    v_pk_fma_f32 v[90:91], v[106:107], v[22:23], v[30:31] op_sel_hi:[0,1,1]
    v_pk_mul_f32 v[92:93], v[86:87], v[86:87]
    v_pk_mul_f32 v[94:95], v[88:89], v[88:89]
    v_pk_mul_f32 v[96:97], v[90:91], v[90:91]
    v_pk_fma_f32 v[92:93], v[92:93], s[66:67], v[108:109] op_sel_hi:[1,1,0]
    v_pk_fma_f32 v[94:95], v[94:95], s[66:67], v[108:109] op_sel_hi:[1,1,0]
    v_pk_fma_f32 v[96:97], v[96:97], s[66:67], v[108:109] op_sel_hi:[1,1,0]
    v_pk_mul_f32 v[92:93], v[92:93], v[86:87]
    v_pk_mul_f32 v[94:95], v[94:95], v[88:89]
    v_pk_mul_f32 v[96:97], v[96:97], v[90:91]
    v_exp_f32 v92, v92
    v_exp_f32 v93, v93
    v_exp_f32 v94, v94
    v_exp_f32 v95, v95
    v_exp_f32 v96, v96
    v_exp_f32 v97, v97
    v_pk_mul_f32 v[86:87], v[86:87], v[84:85]
    v_pk_mul_f32 v[88:89], v[88:89], v[84:85]
    v_pk_mul_f32 v[90:91], v[90:91], v[84:85]
    v_pk_add_f32 v[92:93], v[92:93], 1.0 op_sel_hi:[1,0]
    v_pk_add_f32 v[94:95], v[94:95], 1.0 op_sel_hi:[1,0]
    v_pk_add_f32 v[96:97], v[96:97], 1.0 op_sel_hi:[1,0]
    v_rcp_f32 v92, v92
    s_add_u32 s93, s58, 0x4020000
    s_waitcnt vmcnt(60)
    buffer_load_dwordx4 v[176:179], v1, s[4:7], s93 offen offset:0 nt
    s_waitcnt vmcnt(60)
    buffer_load_dwordx4 v[180:183], v1, s[4:7], s93 offen offset:128 nt
    s_waitcnt vmcnt(60)
    buffer_load_dwordx4 v[184:187], v1, s[4:7], s93 offen offset:2048 nt
    s_waitcnt vmcnt(60)
    buffer_load_dwordx4 v[188:191], v1, s[4:7], s93 offen offset:2176 nt
    s_waitcnt vmcnt(60)
    buffer_load_dwordx4 v[192:195], v2, s[8:11], s93 offen offset:0 nt
    s_waitcnt vmcnt(60)
    buffer_load_dwordx4 v[196:199], v2, s[8:11], s93 offen offset:256 nt
    s_waitcnt vmcnt(60)
    buffer_load_dwordx4 v[200:203], v2, s[8:11], s93 offen offset:2048 nt
    s_waitcnt vmcnt(60)
    buffer_load_dwordx4 v[204:207], v2, s[8:11], s93 offen offset:2304 nt
    v_rcp_f32 v93, v93
    v_rcp_f32 v94, v94
    v_rcp_f32 v95, v95
    v_rcp_f32 v96, v96
    v_rcp_f32 v97, v97
    v_pk_fma_f32 v[110:111], v[86:87], v[92:93], v[110:111]
    v_pk_fma_f32 v[112:113], v[88:89], v[94:95], v[112:113]
    v_pk_fma_f32 v[114:115], v[90:91], v[96:97], v[114:115]
    v_lshlrev_b32 v80, 16, v140
    v_and_b32 v81, 0xffff0000, v140
    v_lshlrev_b32 v82, 16, v141
    v_and_b32 v83, 0xffff0000, v141
    v_lshlrev_b32 v84, 16, v142
    v_and_b32 v85, 0xffff0000, v142
    v_pk_fma_f32 v[86:87], v[102:103], v[80:81], v[82:83] op_sel_hi:[0,1,1]
    v_pk_fma_f32 v[88:89], v[104:105], v[80:81], v[82:83] op_sel_hi:[0,1,1]
    v_pk_fma_f32 v[90:91], v[106:107], v[80:81], v[82:83] op_sel_hi:[0,1,1]
    v_pk_mul_f32 v[92:93], v[86:87], v[86:87]
    v_pk_mul_f32 v[94:95], v[88:89], v[88:89]
    v_pk_mul_f32 v[96:97], v[90:91], v[90:91]
    v_pk_fma_f32 v[92:93], v[92:93], s[66:67], v[108:109] op_sel_hi:[1,1,0]
    v_pk_fma_f32 v[94:95], v[94:95], s[66:67], v[108:109] op_sel_hi:[1,1,0]
    v_pk_fma_f32 v[96:97], v[96:97], s[66:67], v[108:109] op_sel_hi:[1,1,0]
    v_pk_mul_f32 v[92:93], v[92:93], v[86:87]
    v_pk_mul_f32 v[94:95], v[94:95], v[88:89]
    v_pk_mul_f32 v[96:97], v[96:97], v[90:91]
    v_exp_f32 v92, v92
    v_exp_f32 v93, v93
    v_exp_f32 v94, v94
    v_exp_f32 v95, v95
    v_exp_f32 v96, v96
    v_exp_f32 v97, v97
    v_pk_mul_f32 v[86:87], v[86:87], v[84:85]
    v_pk_mul_f32 v[88:89], v[88:89], v[84:85]
    v_pk_mul_f32 v[90:91], v[90:91], v[84:85]
    v_pk_add_f32 v[92:93], v[92:93], 1.0 op_sel_hi:[1,0]
    v_pk_add_f32 v[94:95], v[94:95], 1.0 op_sel_hi:[1,0]
    v_pk_add_f32 v[96:97], v[96:97], 1.0 op_sel_hi:[1,0]
    v_rcp_f32 v92, v92
    v_rcp_f32 v93, v93
    v_rcp_f32 v94, v94
    v_rcp_f32 v95, v95
    v_rcp_f32 v96, v96
    v_rcp_f32 v97, v97
    v_pk_fma_f32 v[110:111], v[86:87], v[92:93], v[110:111]
    v_pk_fma_f32 v[112:113], v[88:89], v[94:95], v[112:113]
    v_pk_fma_f32 v[114:115], v[90:91], v[96:97], v[114:115]
    v_add_f32 v110, v110, v111
    v_add_f32 v112, v112, v113
    v_add_f32 v114, v114, v115
    v_add_f32_dpp v110, v110, v110 row_ror:8 row_mask:0xf bank_mask:0xf
    v_add_f32_dpp v112, v112, v112 row_ror:8 row_mask:0xf bank_mask:0xf
    v_add_f32_dpp v114, v114, v114 row_ror:8 row_mask:0xf bank_mask:0xf
    v_add_f32_dpp v110, v110, v110 row_ror:4 row_mask:0xf bank_mask:0xf
    v_add_f32_dpp v112, v112, v112 row_ror:4 row_mask:0xf bank_mask:0xf
    v_add_f32_dpp v114, v114, v114 row_ror:4 row_mask:0xf bank_mask:0xf
    v_add_f32_dpp v110, v110, v110 row_ror:2 row_mask:0xf bank_mask:0xf
    v_add_f32_dpp v112, v112, v112 row_ror:2 row_mask:0xf bank_mask:0xf
    v_add_f32_dpp v114, v114, v114 row_ror:2 row_mask:0xf bank_mask:0xf
    v_add_f32_dpp v110, v110, v110 row_ror:1 row_mask:0xf bank_mask:0xf
    v_add_f32_dpp v112, v112, v112 row_ror:1 row_mask:0xf bank_mask:0xf
    v_add_f32_dpp v114, v114, v114 row_ror:1 row_mask:0xf bank_mask:0xf
    s_lshl_b32 s29, s24, 4
    v_lshrrev_b32 v12, 4, v0
    v_lshl_add_u32 v12, v12, 2, s29
    ds_write_b32 v12, v110 offset:14848
    ds_write_b32 v12, v112 offset:14912
    ds_write_b32 v12, v114 offset:14976
    v_and_b32 v13, 3, v0
    v_lshlrev_b32 v13, 6, v13
    s_waitcnt lgkmcnt(0)
    s_barrier
    s_cmp_lg_u32 s24, 0
    s_cbranch_scc1 XD_109
    s_cmp_eq_u32 s62, 0
    s_cbranch_scc1 XD_109
    ds_read_b128 v[80:83], v13 offset:14848
    ds_read_b128 v[84:87], v13 offset:14864
    ds_read_b128 v[88:91], v13 offset:14880
    ds_read_b128 v[92:95], v13 offset:14896
    s_mul_i32 s29, s82, 2304
    s_add_u32 s59, s29, 0x68000
    v_add_u32 v15, s29, v14
    v_lshrrev_b32 v15, 1, v15
    s_waitcnt lgkmcnt(0)
    v_pk_add_f32 v[80:81], v[80:81], v[88:89]
    v_pk_add_f32 v[82:83], v[82:83], v[90:91]
    v_pk_add_f32 v[84:85], v[84:85], v[92:93]
    v_pk_add_f32 v[86:87], v[86:87], v[94:95]
    v_pk_add_f32 v[80:81], v[80:81], v[84:85]
    v_pk_add_f32 v[82:83], v[82:83], v[86:87]
    v_pk_add_f32 v[80:81], v[80:81], v[82:83]
    v_add_f32 v80, v80, v81
    v_cvt_pk_bf16_f32 v12, v80, v80
    v_lshlrev_b32 v80, 16, v12
    v_add_f32 v80, s68, v80
    v_cvt_pk_bf16_f32 v12, v80, v80
    v_lshlrev_b32 v80, 16, v12
    v_add_f32 v80, v80, v143
    v_cvt_pk_bf16_f32 v80, v80, v80
    s_mov_b64 exec, 7
    s_cmp_ge_u32 s81, 2
    s_cbranch_scc1 XF_110
    v_and_b32 v80, 0xffff0000, v80
    s_waitcnt vmcnt(60)
    buffer_store_dword v80, v14, s[12:15], s59 offen sc1
    s_branch XR_111
XF_110:
    s_waitcnt vmcnt(60)
    global_store_short v15, v80, s[52:53]
XR_111:
    s_mov_b64 exec, -1
XD_109:
    s_mov_b32 s62, 0
    s_mov_b32 s81, 1
    s_mov_b32 s82, 1
    s_mov_b32 s83, 11520
    s_mov_b32 s84, 0x30000
    s_mov_b32 s85, 14848
    s_mov_b32 s101, 13824
    s_lshl_b32 s69, s81, 18
    s_add_u32 s69, s69, s78
    s_lshl_b32 s70, s81, 12
    s_add_u32 s70, s70, s79
    s_waitcnt vmcnt(57)
    s_call_b64 s[30:31], F_qgi
    s_waitcnt vmcnt(0)
    s_call_b64 s[30:31], F_qgf
    s_waitcnt vmcnt(0)
    s_branch L_join
FB_112:
    s_waitcnt vmcnt(0)
    s_nop 7
    v_mov_b32 v32, 0
    v_mov_b32 v33, 0
    v_mov_b32 v34, 0
    v_mov_b32 v35, 0
    v_mov_b32 v36, 0xff800000
    v_mov_b32 v37, 0xff800000
    v_mov_b32 v38, 0
    s_add_u32 s29, s58, 0x4000000
    s_mov_b32 s59, 0
FL_114:
    buffer_load_dwordx4 v[144:147], v1, s[4:7], s29 offen offset:0 nt
    buffer_load_dwordx4 v[148:151], v1, s[4:7], s29 offen offset:128 nt
    buffer_load_dwordx4 v[152:155], v1, s[4:7], s29 offen offset:2048 nt
    buffer_load_dwordx4 v[156:159], v1, s[4:7], s29 offen offset:2176 nt
    buffer_load_dwordx4 v[160:163], v2, s[8:11], s29 offen offset:0 nt
    buffer_load_dwordx4 v[164:167], v2, s[8:11], s29 offen offset:256 nt
    buffer_load_dwordx4 v[168:171], v2, s[8:11], s29 offen offset:2048 nt
    buffer_load_dwordx4 v[172:175], v2, s[8:11], s29 offen offset:2304 nt
    s_waitcnt vmcnt(0)
    s_call_b64 s[30:31], U_v144_v160
    s_add_u32 s29, s29, 16384
    s_add_u32 s59, s59, 1
    s_cmp_lt_u32 s59, 16
    s_cbranch_scc1 FL_114
    s_branch FR_113
L_codeend:
.section .rodata,"a"
.p2align 6
.amdhsa_kernel interleave_layers__gqa_block_cached__mixer_token_mlp__decode_kernel
  .amdhsa_next_free_vgpr 512
  .amdhsa_next_free_sgpr 102
  .amdhsa_accum_offset 256
  .amdhsa_group_segment_fixed_size 0
  .amdhsa_kernarg_size 104
  .amdhsa_user_sgpr_count 2
  .amdhsa_user_sgpr_kernarg_segment_ptr 1
  .amdhsa_system_sgpr_workgroup_id_x 1
.end_amdhsa_kernel
```
